```python
import torch

def _softmax(x, axis=-1):
    return torch.softmax(x, dim=axis)
def _gelu(x):
    return torch.nn.functional.gelu(x, approximate="tanh")
def _silu(x):
    return torch.nn.functional.silu(x)
def _sigmoid(x):
    return torch.sigmoid(x)
def _layernorm(x, axis=-1, eps=1e-5):
    m = x.mean(dim=axis, keepdim=True)
    v = x.var(dim=axis, keepdim=True, unbiased=False)
    return (x - m) / torch.sqrt(v + eps)
def _scatter_add(tgt, idx, src, axis=0):
    return tgt.clone().index_add_(axis, idx, src)
def _segment_sum(src, seg, n):
    out = torch.zeros((n,) + src.shape[1:], dtype=src.dtype)
    return out.index_add_(0, seg, src)
def _pad(x, pw):
    flat = tuple(v for pair in reversed(pw) for v in pair)
    return torch.nn.functional.pad(x, flat)

kernel_name = 'interleave_layers__linear_kernel_hedgehog__glu_gated_reglu__prompt'

def setup_inputs():

    _w = (lambda a: (lambda t: t.to(torch.bfloat16) if t.is_floating_point() else t)(torch.as_tensor(a)))
    def _A_setup():
        B, S, D, H = 1, 2048, 512, 32
        Dh = D // H
        return {
            "x": _w((lambda *s: torch.randn(*s, dtype=torch.bfloat16) * 0.05)(B, S, D)),
            "wqkv": _w((lambda *s: torch.randn(*s, dtype=torch.bfloat16) * 0.4)(D, 3 * D)),
            "w_phi": _w((lambda *s: torch.randn(*s, dtype=torch.bfloat16) * 0.4)(H, Dh, Dh) * (Dh ** -0.5)),
            "wo": _w((lambda *s: torch.randn(*s, dtype=torch.bfloat16) * 0.05)(D, D)),
        }
    _A_in = _A_setup()

    def _B_setup():
        B, S, D, F = 1, 2048, 512, 1376
        return {
            "x": _w((lambda *s: torch.randn(*s, dtype=torch.bfloat16) * 0.05)(B, S, D)),
            "W_gate": _w((lambda *s: torch.randn(*s, dtype=torch.bfloat16) * 0.8)(D, F) * (2.0 / D) ** 0.5),
            "W_up": _w((lambda *s: torch.randn(*s, dtype=torch.bfloat16) * 0.8)(D, F) * (2.0 / D) ** 0.5),
            "W_down": _w((lambda *s: torch.randn(*s, dtype=torch.bfloat16) * 0.8)(F, D) * (1.0 / F) ** 0.5),
        }
    _B_in = _B_setup()

    return {
        "A_x": _A_in["x"],
        "A_wqkv": _A_in["wqkv"],
        "A_w_phi": _A_in["w_phi"],
        "A_wo": _A_in["wo"],
        "B_x": _B_in["x"],
        "B_W_gate": _B_in["W_gate"],
        "B_W_up": _B_in["W_up"],
        "B_W_down": _B_in["W_down"],
    }

def reference(A_x, A_wqkv, A_w_phi, A_wo, B_x, B_W_gate, B_W_up, B_W_down):
    def _A_ref(x, wqkv, w_phi, wo):
        B, S, D = x.shape
        H = 32; Dh = D // H
        qkv = (lambda x, *d: x.permute(*d))((x @ wqkv).reshape(B, S, 3, H, Dh), 2, 0, 3, 1, 4)
        q, k, v = qkv[0], qkv[1], qkv[2]
        pq = torch.einsum("bhsd,hdf->bhsf", q, w_phi)
        pk = torch.einsum("bhsd,hdf->bhsf", k, w_phi)
        phi_q = torch.concatenate([_softmax(pq, axis=-1), _softmax(-pq, axis=-1)], axis=-1)
        phi_k = torch.concatenate([_softmax(pk, axis=-1), _softmax(-pk, axis=-1)], axis=-1)
        kv = torch.einsum("bhsf,bhsd->bhfd", phi_k, v)
        z  = torch.einsum("bhsf->bhf", phi_k)
        num = torch.einsum("bhqf,bhfd->bhqd", phi_q, kv)
        den = torch.einsum("bhqf,bhf->bhq", phi_q, z)[..., None] + 1e-6
        o = num / den
        return (lambda x, *d: x.permute(*d))(o, 0, 2, 1, 3).reshape(B, S, D) @ wo

    def _B_ref(x, W_gate, W_up, W_down):
        gate = torch.einsum("bsd,df->bsf", x, W_gate)
        up = torch.einsum("bsd,df->bsf", x, W_up)
        gate = gate * (lambda x, dt: x.to(dt))(gate > 0, gate.dtype)
        h = gate * up
        return torch.einsum("bsf,fd->bsd", h, W_down)

    x = A_x
    x = x + _A_ref(_layernorm(x, axis=-1), A_wqkv, A_w_phi, A_wo)
    x = x + _B_ref(_layernorm(x, axis=-1), B_W_gate, B_W_up, B_W_down)
    x = x + _A_ref(_layernorm(x, axis=-1), A_wqkv, A_w_phi, A_wo)
    x = x + _B_ref(_layernorm(x, axis=-1), B_W_gate, B_W_up, B_W_down)
    return x
```

```asm
; @launch grid=(256,1,1) block=(256,1,1) lds=163840
.amdgcn_target "amdgcn-amd-amdhsa--gfx950"
.text
.globl interleave_layers__linear_kernel_hedgehog__glu_gated_reglu__prompt_kernel
.p2align 8
.type interleave_layers__linear_kernel_hedgehog__glu_gated_reglu__prompt_kernel,@function
interleave_layers__linear_kernel_hedgehog__glu_gated_reglu__prompt_kernel:
s_load_dwordx16 s[36:51], s[0:1], 0
s_cmpk_ge_u32 s2, 256
s_cbranch_scc1 L_END
s_load_dwordx2 s[52:53], s[0:1], 64
s_load_dwordx2 s[54:55], s[0:1], 80
v_lshrrev_b32 v1, 6, v0
v_and_b32 v240, 63, v0
v_readfirstlane_b32 s20, v1
s_and_b32 s30, s2, 7
s_lshr_b32 s31, s2, 3
s_and_b32 s22, s31, 15
s_lshr_b32 s32, s31, 4
s_lshl_b32 s21, s30, 1
s_add_u32 s21, s21, s32
v_lshlrev_b32 v239, 7, v240
s_getpc_b64 s[8:9]
L_PC:
s_lshl_b32 s31, s31, 2
s_add_u32 s31, s31, s20
s_lshl_b32 s31, s31, 9
v_add_u32 v2, s31, v239
v_min_u32 v2, L_WARM-L_PC, v2
v_mov_b32 v3, s9
v_add_co_u32 v2, vcc, s8, v2
s_nop 1
v_addc_co_u32 v3, vcc, 0, v3, vcc
s_mov_b64 exec, 15
global_load_dword v15, v[2:3], off
s_mov_b64 exec, -1
s_and_b32 s23, s22, 7
s_lshr_b32 s24, s22, 3
s_lshl_b32 s3, s21, 1
s_add_u32 s3, s3, s24
v_lshlrev_b32 v224, 4, v240
v_and_b32 v2, 31, v240
v_lshrrev_b32 v3, 5, v240
v_lshrrev_b32 v10, 2, v240
v_and_b32 v11, 48, v224
v_mul_u32_u24 v13, 3072, v10
v_add_u32 v13, v13, v11
s_lshl_b32 s34, s3, 16
s_lshl_b32 s32, s23, 7
s_add_u32 s34, s34, s32
s_lshl_b32 s31, s20, 5
s_add_u32 s34, s34, s31
s_add_u32 s30, s20, 1
s_cmp_eq_u32 s30, 3
s_cselect_b32 s30, 0, s30
s_lshl_b32 s30, s30, 10
s_mul_i32 s31, s21, 98304
s_add_u32 s30, s30, s31
s_lshl_b32 s31, s22, 6
s_add_u32 s30, s30, s31
s_cmp_eq_u32 s20, 3
s_cselect_b32 s30, 1073741824, s30
s_add_u32 s31, s30, 48128
s_lshl_b32 s35, s20, 11
s_mov_b32 m0, s35
s_mul_i32 s33, s20, 16352
s_add_u32 s33, s33, s34
v_lshrrev_b32 v5, 3, v240
v_xor_b32 v6, v224, v240
v_and_b32 v6, 0x70, v6
v_lshl_add_u32 v5, v5, 10, v6
v_xor_b32 v6, 64, v5
v_add_u32 v6, 7168, v6
s_mov_b32 s10, 0x200000
s_mov_b32 s11, 0x20000
s_mov_b32 s14, 0x180000
s_mov_b32 s15, 0x20000
s_waitcnt lgkmcnt(0)
s_mov_b64 s[8:9], s[36:37]
s_mov_b64 s[12:13], s[38:39]
buffer_load_dwordx4 v5, s[8:11], s33 offen nt lds
buffer_load_dwordx4 v6, s[8:11], s33 offen offset:1024 nt lds
s_add_u32 m0, s35, 131072
s_nop 0
buffer_load_dwordx4 v13, s[12:15], s30 offen nt lds
buffer_load_dwordx4 v13, s[12:15], s31 offen offset:1024 nt lds
s_load_dword s25, s[54:55], 0
s_mov_b32 s39, s34
s_and_b32 s30, s20, 1
s_mul_i32 s30, s30, 16352
s_add_u32 s39, s39, s30
v_and_b32 v4, 15, v240
v_and_b32 v5, 48, v240
v_lshl_add_u32 v244, v4, 10, v5
s_cmp_lt_u32 s20, 2
s_cselect_b32 s8, s46, s48
s_cselect_b32 s9, s47, s49
s_mov_b32 s10, 1409024
s_bfm_b32 s30, s22, 0
s_and_b32 s30, s30, 4437
s_bcnt1_i32_b32 s30, s30
s_mul_i32 s31, s22, 5
s_add_u32 s30, s30, s31
s_lshl_b32 s30, s30, 5
s_lshl_b32 s31, s21, 1
s_and_b32 s32, s20, 1
s_add_u32 s31, s31, s32
s_mul_i32 s31, s31, 44032
s_add_u32 s30, s30, s31
s_lshr_b32 s29, 13311, s22
s_and_b32 s29, s29, 1
s_and_b32 s57, s29, s22
s_lshl_b32 s57, s57, 4
s_sub_u32 s30, s30, s57
s_add_u32 s31, s29, 10
v_mov_b32 v9, 1073741824
v_add_u32 v5, 0, v240
v_mul_u32_u24 v6, 43691, v5
v_lshrrev_b32 v6, 19, v6
v_mul_u32_u24 v7, 12, v6
v_sub_u32 v7, v5, v7
v_cmp_gt_u32 vcc, s31, v7
v_mul_u32_u24 v6, 2752, v6
v_lshl_add_u32 v6, v7, 4, v6
v_cndmask_b32 v124, v9, v6, vcc
v_add_u32 v5, 64, v240
v_mul_u32_u24 v6, 43691, v5
v_lshrrev_b32 v6, 19, v6
v_mul_u32_u24 v7, 12, v6
v_sub_u32 v7, v5, v7
v_cmp_gt_u32 vcc, s31, v7
v_mul_u32_u24 v6, 2752, v6
v_lshl_add_u32 v6, v7, 4, v6
v_cndmask_b32 v125, v9, v6, vcc
v_add_u32 v5, 128, v240
v_mul_u32_u24 v6, 43691, v5
v_lshrrev_b32 v6, 19, v6
v_mul_u32_u24 v7, 12, v6
v_sub_u32 v7, v5, v7
v_cmp_gt_u32 vcc, s31, v7
v_mul_u32_u24 v6, 2752, v6
v_lshl_add_u32 v6, v7, 4, v6
v_cndmask_b32 v126, v9, v6, vcc
s_mov_b32 s58, s30
s_mul_i32 s32, s20, 3072
s_add_u32 m0, s32, 139264
s_nop 0
buffer_load_dwordx4 v124, s[8:11], s58 offen nt lds
s_add_u32 m0, s32, 140288
s_nop 0
buffer_load_dwordx4 v125, s[8:11], s58 offen nt lds
s_add_u32 m0, s32, 141312
s_nop 0
buffer_load_dwordx4 v126, s[8:11], s58 offen nt lds
s_mov_b32 s60, s50
s_mov_b32 s61, s51
s_mov_b32 s62, 1409024
s_mov_b32 s63, 0x20000
s_mov_b32 s64, s42
s_mov_b32 s65, s43
s_mov_b32 s66, 524288
s_mov_b32 s67, 0x20000
s_mov_b64 s[12:13], s[40:41]
s_mov_b32 s14, 16384
s_lshl_b32 s30, s20, 10
s_add_u32 m0, s30, 151552
s_lshl_b32 s31, s22, 10
buffer_load_dwordx4 v224, s[12:15], s31 offen lds
s_mov_b32 s4, s54
s_mov_b32 s5, s55
s_mov_b32 s6, 27262976
s_mov_b32 s7, 0x20000
s_mov_b32 s16, s52
s_mov_b32 s17, s53
s_mov_b32 s18, 2097152
s_mov_b32 s19, 0x20000
s_mul_i32 s27, s21, 1048576
s_add_u32 s27, s27, 10485760
s_mul_i32 s28, s22, 393216
s_add_u32 s28, s28, 2097152
s_mul_i32 s30, s20, 98304
s_mul_i32 s31, s22, 6144
s_add_u32 s30, s30, s31
s_add_u32 s30, s30, s27
s_add_u32 s45, s30, 139264
s_lshl_b32 s30, s24, 2
s_add_u32 s30, s30, s20
s_lshl_b32 s30, s30, 7
s_add_u32 s30, s30, s27
s_add_u32 s51, s30, 379904
s_lshl_b32 s30, s20, 7
s_add_u32 s30, s30, s27
s_add_u32 s52, s30, 379392
v_lshlrev_b32 v31, 2, v2
v_add_u32 v226, 161280, v31
s_add_u32 s30, s27, 540672
s_or_b32 s31, s22, s20
s_cselect_b32 s30, 1073741824, s30
s_mov_b64 exec, 0xfff
buffer_load_dword v15, v239, s[4:7], s30 offen sc1
s_mov_b64 exec, -1
s_mul_i32 s30, s24, 65536
s_lshl_b32 s31, s23, 12
s_add_u32 s30, s30, s31
s_and_b32 s31, s20, 3
s_lshl_b32 s31, s31, 10
s_add_u32 s30, s30, s31
s_add_u32 s37, s30, s27
s_lshl_b32 s30, s24, 12
s_lshl_b32 s31, s23, 8
s_add_u32 s30, s30, s31
s_add_u32 s30, s30, s27
s_add_u32 s38, s30, 376832
s_lshl_b32 s41, s20, 12
s_add_u32 s36, s28, s41
s_cmp_eq_u32 s29, 1
s_cselect_b32 s40, s36, 1073741824
s_mul_i32 s30, s20, 32768
s_add_u32 s44, s30, s27
s_lshl_b32 s30, s20, 15
s_lshl_b32 s31, s21, 11
s_add_u32 s30, s30, s31
s_add_u32 s26, s30, s28
s_mul_i32 s30, s21, 1280
s_add_u32 s30, s30, s28
s_lshl_b32 s31, s20, 7
s_add_u32 s30, s30, s31
s_add_u32 s15, s30, 368640
s_mul_i32 s30, s24, 196608
s_mul_i32 s31, s20, 24576
s_add_u32 s30, s30, s31
s_add_u32 s30, s30, s27
s_add_u32 s46, s30, 139264
s_lshl_b32 s30, s20, 13
s_add_u32 s30, s30, s28
s_add_u32 s47, s30, 294912
s_lshl_b32 s30, s20, 10
s_add_u32 s30, s30, s28
s_add_u32 s48, s30, 360448
s_lshr_b32 s31, s20, 1
s_lshl_b32 s31, s31, 2
s_lshr_b32 s32, s22, 2
s_add_u32 s31, s31, s32
s_lshl_b32 s31, s31, 7
s_and_b32 s32, s22, 3
s_lshl_b32 s32, s32, 3
s_add_u32 s31, s31, s32
s_and_b32 s32, s20, 1
s_lshl_b32 s32, s32, 2
s_add_u32 s31, s31, s32
s_add_u32 s31, s31, s27
s_add_u32 s49, s31, 541184
s_lshl_b32 s30, s24, 8
s_lshl_b32 s31, s23, 4
s_add_u32 s30, s30, s31
s_lshl_b32 s31, s20, 2
s_add_u32 s30, s30, s31
s_add_u32 s30, s30, s27
s_add_u32 s50, s30, 540672
s_getreg_b32 s59, hwreg(HW_REG_XCC_ID)
s_and_b32 s59, s59, 15
s_lshl_b32 s30, s20, 2
s_bfm_b32 s42, s30, 0
s_and_b32 s42, s42, 4437
s_bcnt1_i32_b32 s42, s42
s_mul_i32 s31, s30, 5
s_add_u32 s42, s42, s31
s_lshl_b32 s42, s42, 14
s_lshl_b32 s31, s23, 7
s_add_u32 s42, s42, s31
s_add_u32 s43, s42, 98304
s_add_u32 s54, s42, 180224
s_lshl_b32 s12, s20, 17
s_add_u32 s12, s12, s31
s_lshl_b32 s14, s20, 11
s_cmp_lt_u32 s20, 2
s_cselect_b32 s13, s54, 1073741824
s_cselect_b32 s31, 16384, 0
s_add_u32 s55, s54, s31
s_add_u32 s55, s55, 81920
v_add_u32 v225, 0x10000, v224
v_min_u32 v241, 1, v240
v_lshlrev_b32 v241, 30, v241
s_lshl_b32 s30, s20, 11
s_add_u32 s30, s30, 131072
v_add_u32 v242, s30, v224
s_lshl_b32 s30, s20, 9
s_add_u32 s30, s30, 155648
v_lshl_add_u32 v243, v240, 3, s30
s_lshl_b32 s30, s20, 11
s_add_u32 s30, s30, 532480
v_and_b32 v4, 30, v2
v_lshlrev_b32 v4, 3, v4
v_lshl_add_u32 v4, v3, 10, v4
v_and_b32 v5, 1, v2
v_lshl_add_u32 v4, v5, 8, v4
v_add_u32 v245, s30, v4
v_and_b32 v4, 15, v240
s_lshr_b32 s30, s20, 1
s_lshl_b32 s30, s30, 11
s_and_b32 s32, s20, 1
s_lshl_b32 s31, s32, 9
s_add_u32 s30, s30, s31
s_add_u32 s30, s30, 155648
v_lshl_add_u32 v237, v4, 3, s30
s_mul_i32 s31, s32, 384
s_sub_u32 s38, s38, s31
v_mov_b32 v233, 0
v_mov_b32 v234, 0
v_mov_b32 v235, 0
v_bfe_u32 v4, v240, 4, 1
v_bfe_u32 v5, v240, 2, 2
v_bfe_u32 v7, v240, 1, 1
v_lshl_add_u32 v8, v3, 3, v5
s_lshl_b32 s30, s20, 5
s_add_u32 s30, s30, 139264
v_lshrrev_b32 v122, 4, v240
v_lshl_add_u32 v122, v122, 3, v5
v_and_b32 v123, 3, v240
v_lshlrev_b32 v123, 3, v123
v_mul_u32_u24 v127, 192, v122
s_add_u32 s30, s30, s57
v_add3_u32 v121, v127, v123, s30
v_mul_u32_u24 v14, 6128, v7
v_add3_u32 v127, v127, v123, v14
s_cmp_eq_u32 s57, 0
s_cselect_b32 s30, 160, 0
s_add_u32 s30, s30, 139264
v_add_u32 v127, s30, v127
v_add_u32 v14, 128, v121
s_cmp_eq_u32 s20, 1
s_cselect_b64 vcc, -1, 0
v_cndmask_b32 v127, v14, v127, vcc
s_add_u32 s30, s35, 131072
v_lshl_add_u32 v120, v122, 6, v123
v_add_u32 v120, s30, v120
ds_write_b32 v226, v233 offset:1216
v_lshlrev_b32 v122, 5, v8
v_lshl_add_u32 v122, v4, 4, v122
v_lshl_add_u32 v122, v7, 3, v122
s_lshl_b32 s30, s20, 10
s_add_u32 s30, s30, 151552
v_add_u32 v122, s30, v122
s_lshr_b32 s30, s20, 1
s_lshl_b32 s30, s30, 6
s_add_u32 s30, s30, s14
v_lshl_add_u32 v123, v4, 3, v5
v_lshlrev_b32 v123, 7, v123
v_lshl_add_u32 v123, v3, 13, v123
v_and_b32 v4, 48, v224
s_add_u32 s30, s30, 0x10000
v_add3_u32 v176, v123, v4, s30
v_and_b32 v4, 8, v240
v_lshlrev_b32 v4, 3, v4
v_xor_b32 v176, v4, v176
v_xor_b32 v177, 64, v176
v_lshrrev_b32 v29, 3, v240
v_and_b32 v30, 0x70, v224
v_and_b32 v4, 16, v240
v_lshlrev_b32 v4, 2, v4
v_xor_b32 v30, v4, v30
v_lshl_add_u32 v180, v29, 10, v30
v_add_u32 v181, 7168, v180
v_mov_b32 v44, 0x3f803f80
v_mov_b32 v40, -1
v_mov_b32 v45, 0x3f803f80
v_mov_b32 v41, -1
v_mov_b32 v46, 0x3f803f80
v_mov_b32 v42, -1
v_mov_b32 v47, 0x3f803f80
v_mov_b32 v43, -1
v_bfe_u32 v12, v240, 2, 1
v_mul_u32_u24 v12, 0x8000, v12
v_lshl_or_b32 v12, v12, 16, v12
s_lshl_b32 s30, s21, 4
s_add_u32 s31, s30, s22
s_lshl_b32 s31, s31, 7
s_add_u32 s31, s31, 4096
s_cmp_eq_u32 s20, 0
s_cselect_b32 s56, s31, 1073741824
v_add_u32 v10, s30, v240
v_and_b32 v11, 3, v240
s_lshl_b32 s32, s20, 2
v_add_u32 v11, s32, v11
v_lshl_add_u32 v11, v11, 4, s22
v_cmp_gt_u32 vcc, 16, v240
s_nop 1
v_cndmask_b32 v10, v11, v10, vcc
v_lshlrev_b32 v229, 7, v10
s_lshl_b32 s30, s2, 2
s_add_u32 s30, s30, s20
s_mul_i32 s31, s30, 1408
s_lshl_b32 s30, s30, 9
s_mov_b64 exec, 0x7ff
buffer_load_dword v227, v239, s[60:63], s31 offen
s_mov_b64 exec, 15
buffer_load_dword v227, v239, s[64:67], s30 offen
s_mov_b64 exec, -1
s_and_b32 s30, s20, 1
s_lshl_b32 s30, s30, 4
v_and_b32 v2, 15, v240
v_add_u32 v2, s30, v2
v_lshrrev_b32 v3, 4, v240
s_and_b32 s30, s20, 2
s_lshl_b32 s30, s30, 1
v_add_u32 v5, s30, v3
v_lshrrev_b32 v6, 1, v2
v_xor_b32 v5, v5, v6
v_and_b32_e64 v5, 7, v5
v_lshlrev_b32 v5, 4, v5
v_lshl_add_u32 v5, v2, 7, v5
s_waitcnt vmcnt(9)
s_barrier
ds_read_b128 v[16:19], v5
ds_read_b128 v[24:27], v5 offset:4096
s_waitcnt lgkmcnt(0)
s_add_u32 s31, s37, 0
buffer_store_dwordx4 v[16:19], v224, s[4:7], s31 offen sc1
s_add_u32 s31, s37, 32768
buffer_store_dwordx4 v[24:27], v224, s[4:7], s31 offen sc1
v_lshlrev_b32 v48, 16, v16
v_and_b32 v49, 0xffff0000, v16
v_lshlrev_b32 v50, 16, v17
v_and_b32 v51, 0xffff0000, v17
v_lshlrev_b32 v52, 16, v18
v_and_b32 v53, 0xffff0000, v18
v_lshlrev_b32 v54, 16, v19
v_and_b32 v55, 0xffff0000, v19
v_pk_add_f32 v[32:33], v[48:49], v[50:51]
v_pk_mul_f32 v[34:35], v[48:49], v[48:49]
v_pk_add_f32 v[32:33], v[32:33], v[52:53]
v_pk_fma_f32 v[34:35], v[50:51], v[50:51], v[34:35]
v_pk_add_f32 v[32:33], v[32:33], v[54:55]
v_pk_fma_f32 v[34:35], v[52:53], v[52:53], v[34:35]
v_add_f32 v32, v32, v33
v_pk_fma_f32 v[34:35], v[54:55], v[54:55], v[34:35]
v_add_f32 v33, v34, v35
ds_write_b64 v243, v[32:33] offset:0
v_accvgpr_write_b32 a249, v17
v_accvgpr_write_b32 a250, v18
v_accvgpr_write_b32 a251, v19
v_accvgpr_write_b32 a248, v16
v_lshlrev_b32 v48, 16, v24
v_and_b32 v49, 0xffff0000, v24
v_lshlrev_b32 v50, 16, v25
v_and_b32 v51, 0xffff0000, v25
v_lshlrev_b32 v52, 16, v26
v_and_b32 v53, 0xffff0000, v26
v_lshlrev_b32 v54, 16, v27
v_and_b32 v55, 0xffff0000, v27
v_pk_add_f32 v[36:37], v[48:49], v[50:51]
v_pk_mul_f32 v[38:39], v[48:49], v[48:49]
v_pk_add_f32 v[36:37], v[36:37], v[52:53]
v_pk_fma_f32 v[38:39], v[50:51], v[50:51], v[38:39]
v_pk_add_f32 v[36:37], v[36:37], v[54:55]
v_pk_fma_f32 v[38:39], v[52:53], v[52:53], v[38:39]
v_add_f32 v36, v36, v37
v_pk_fma_f32 v[38:39], v[54:55], v[54:55], v[38:39]
v_add_f32 v37, v38, v39
ds_write_b64 v243, v[36:37] offset:2048
v_accvgpr_write_b32 a253, v25
v_accvgpr_write_b32 a254, v26
v_accvgpr_write_b32 a255, v27
v_accvgpr_write_b32 a252, v24
s_cmp_eq_u32 s20, 3
s_cselect_b32 s30, 1073741824, s26
s_waitcnt vmcnt(9)
ds_read_b64_tr_b16 v[48:49], v120 offset:0
ds_read_b64_tr_b16 v[50:51], v120 offset:256
ds_read_b64_tr_b16 v[52:53], v120 offset:32
ds_read_b64_tr_b16 v[54:55], v120 offset:288
s_waitcnt lgkmcnt(0)
buffer_store_dwordx4 v[48:51], v224, s[4:7], s30 offen offset:0 sc1
buffer_store_dwordx4 v[52:55], v224, s[4:7], s30 offen offset:1024 sc1
v_mfma_f32_16x16x32_bf16 v[64:67], v[44:47], v[48:51], 0
v_mfma_f32_16x16x32_bf16 v[68:71], v[44:47], v[52:55], 0
s_mov_b32 vcc_lo, 0xffff0000
s_nop 6
v_cndmask_b32 v64, v64, v68, vcc
s_waitcnt vmcnt(7)
ds_read_b64_tr_b16 v[32:33], v122 offset:0
ds_read_b64_tr_b16 v[34:35], v122 offset:128
ds_read_b64_tr_b16 v[36:37], v122 offset:512
ds_read_b64_tr_b16 v[38:39], v122 offset:640
s_mov_b32 exec_hi, 0
buffer_store_dword v64, v31, s[4:7], s15 offen sc1
s_mov_b32 exec_hi, -1
s_waitcnt lgkmcnt(0)
v_xor_b32 v32, v12, v32
v_xor_b32 v33, v12, v33
v_xor_b32 v34, v12, v34
v_xor_b32 v35, v12, v35
v_xor_b32 v36, v12, v36
v_xor_b32 v37, v12, v37
v_xor_b32 v38, v12, v38
v_xor_b32 v39, v12, v39
v_accvgpr_write_b32 a240, v32
v_accvgpr_write_b32 a241, v33
v_accvgpr_write_b32 a242, v34
v_accvgpr_write_b32 a243, v35
v_accvgpr_write_b32 a244, v36
v_accvgpr_write_b32 a245, v37
v_accvgpr_write_b32 a246, v38
v_accvgpr_write_b32 a247, v39
s_and_b32 s25, s25, 0xffffff00
s_add_u32 s25, s25, 2654435584
s_add_u32 s53, s25, 16
s_add_u32 s57, s53, s59
s_mov_b32 s59, 16777216
v_mov_b32 v228, s57
s_branch L_PAGE0
.p2align 12
L_PAGE0:
s_barrier
s_add_u32 s30, s26, 98304
ds_read_b64_tr_b16 v[48:49], v121 offset:0
ds_read_b64_tr_b16 v[50:51], v121 offset:768
ds_read_b64_tr_b16 v[52:53], v121 offset:6144
ds_read_b64_tr_b16 v[54:55], v121 offset:6912
s_waitcnt lgkmcnt(0)
buffer_store_dwordx4 v[48:51], v224, s[4:7], s30 offen offset:0 sc1
buffer_store_dwordx4 v[52:55], v224, s[4:7], s30 offen offset:1024 sc1
v_mfma_f32_16x16x32_bf16 v[72:75], v[44:47], v[48:51], 0
v_mfma_f32_16x16x32_bf16 v[76:79], v[44:47], v[52:55], 0
s_mov_b32 vcc_lo, 0xffff0000
s_nop 6
v_cndmask_b32 v72, v72, v76, vcc
s_add_u32 s30, s26, 229376
s_lshl_b32 s31, s21, 10
s_mul_i32 s31, s31, s20
s_sub_u32 s30, s30, s31
s_cmp_le_u32 s20, s29
s_cselect_b32 s30, s30, 1073741824
s_cmp_eq_u32 s20, 0
s_cselect_b32 s31, s30, 1073741824
ds_read_b64_tr_b16 v[56:57], v127 offset:0
ds_read_b64_tr_b16 v[58:59], v127 offset:768
ds_read_b64_tr_b16 v[60:61], v127 offset:6144
ds_read_b64_tr_b16 v[62:63], v127 offset:6912
s_waitcnt lgkmcnt(0)
buffer_store_dwordx4 v[56:59], v224, s[4:7], s30 offen offset:0 sc1
buffer_store_dwordx4 v[60:63], v224, s[4:7], s31 offen offset:1024 sc1
v_mfma_f32_16x16x32_bf16 v[88:91], v[44:47], v[56:59], 0
v_mfma_f32_16x16x32_bf16 v[92:95], v[44:47], v[60:63], 0
s_cmp_eq_u32 s20, 1
s_cselect_b32 vcc_lo, 0, 0xffff0000
s_nop 5
v_cndmask_b32 v88, v88, v92, vcc
ds_read_b64 v[104:105], v237 offset:0
ds_read_b64 v[106:107], v237 offset:128
ds_read_b64 v[108:109], v237 offset:256
ds_read_b64 v[110:111], v237 offset:384
ds_read_b64 v[112:113], v237 offset:1024
ds_read_b64 v[114:115], v237 offset:1152
ds_read_b64 v[116:117], v237 offset:1280
ds_read_b64 v[118:119], v237 offset:1408
s_waitcnt lgkmcnt(6)
v_pk_add_f32 v[104:105], v[104:105], v[106:107]
s_waitcnt lgkmcnt(4)
v_pk_add_f32 v[108:109], v[108:109], v[110:111]
s_waitcnt lgkmcnt(2)
v_pk_add_f32 v[112:113], v[112:113], v[114:115]
s_waitcnt lgkmcnt(0)
v_pk_add_f32 v[116:117], v[116:117], v[118:119]
v_pk_add_f32 v[104:105], v[104:105], v[108:109]
v_pk_add_f32 v[112:113], v[112:113], v[116:117]
v_pk_add_f32 v[104:105], v[104:105], v[112:113]
v_and_or_b32 v105, v105, -4, 0
s_mov_b64 exec, 0xffff
buffer_store_dwordx2 v[104:105], v237, s[4:7], s38 offen sc1
s_mov_b64 exec, -1
s_lshl_b32 s30, s21, 9
s_add_u32 s30, s30, s47
s_add_u32 s30, s30, 0
s_mov_b32 exec_hi, 0
buffer_store_dwordx4 v[40:43], v224, s[4:7], s30 offen sc1
s_lshl_b32 s30, s21, 6
s_add_u32 s30, s30, s48
s_add_u32 s30, s30, 0
s_mov_b32 exec_lo, 15
buffer_store_dwordx4 v[40:43], v224, s[4:7], s30 offen sc1
s_mov_b64 exec, -1
s_cmp_lt_u32 s20, 2
s_cselect_b32 s30, s15, 1073741824
s_mov_b32 exec_hi, 0
buffer_store_dword v72, v31, s[4:7], s15 offen offset:512 sc1
buffer_store_dword v88, v31, s[4:7], s30 offen offset:1024 sc1
s_mov_b32 exec_hi, -1
s_add_u32 m0, s14, 65536
s_add_u32 s34, s12, 0
buffer_load_dwordx4 v180, s[64:67], s34 offen lds
buffer_load_dwordx4 v181, s[64:67], s34 offen offset:1024 lds
s_add_u32 m0, s14, 73728
s_add_u32 s34, s12, 16384
buffer_load_dwordx4 v180, s[64:67], s34 offen lds
buffer_load_dwordx4 v181, s[64:67], s34 offen offset:1024 lds
s_add_u32 m0, s14, 81920
s_add_u32 s34, s12, 32768
buffer_load_dwordx4 v180, s[64:67], s34 offen lds
buffer_load_dwordx4 v181, s[64:67], s34 offen offset:1024 lds
s_add_u32 m0, s14, 90112
s_add_u32 s34, s12, 49152
buffer_load_dwordx4 v180, s[64:67], s34 offen lds
buffer_load_dwordx4 v181, s[64:67], s34 offen offset:1024 lds
s_add_u32 m0, s14, 98304
s_add_u32 s34, s42, 0
buffer_load_dwordx4 v180, s[60:63], s34 offen lds
buffer_load_dwordx4 v181, s[60:63], s34 offen offset:1024 lds
s_add_u32 m0, s14, 106496
s_add_u32 s34, s54, 0
buffer_load_dwordx4 v180, s[60:63], s34 offen lds
buffer_load_dwordx4 v181, s[60:63], s34 offen offset:1024 lds
s_lshr_b32 s30, s2, 3
s_lshl_b32 s30, s30, 2
s_add_u32 s30, s30, s20
s_mul_i32 s31, s30, 11264
s_lshl_b32 s30, s30, 12
s_mov_b64 exec, 0x7ff
v_lshlrev_b32 v182, 3, v239
buffer_load_dword v184, v182, s[60:63], s31 offen offset:384
s_mov_b64 exec, 15
buffer_load_dword v184, v182, s[64:67], s30 offen offset:384
s_mov_b64 exec, -1
s_cmp_eq_u32 s20, 0
s_cbranch_scc0 L_NC0
s_call_b64 s[10:11], L_ST0
L_NC0:
s_cmp_eq_u32 s20, 1
s_cbranch_scc0 L_NC1
s_call_b64 s[10:11], L_GW0
L_NC1:
s_cmp_eq_u32 s20, 2
s_cbranch_scc0 L_NC2
s_call_b64 s[10:11], L_ST1
L_NC2:
s_cmp_eq_u32 s20, 3
s_cbranch_scc0 L_NC3
s_call_b64 s[10:11], L_ST2
L_NC3:
s_cmp_eq_u32 s20, 0
s_cbranch_scc0 L_NC4
s_call_b64 s[10:11], L_ST3
L_NC4:
s_cmp_eq_u32 s20, 1
s_cbranch_scc0 L_NC5
s_call_b64 s[10:11], L_ST4
L_NC5:
s_cmp_eq_u32 s20, 2
s_cbranch_scc0 L_NC6
s_call_b64 s[10:11], L_GW1
L_NC6:
s_cmp_eq_u32 s20, 3
s_cbranch_scc0 L_NC7
s_call_b64 s[10:11], L_ST5
L_NC7:
s_waitcnt vmcnt(14)
s_barrier
s_mov_b64 exec, 1
buffer_store_dword v228, off, s[4:7], s56 sc1
s_mov_b64 exec, -1
s_waitcnt vmcnt(11)
ds_read_b64_tr_b16 a[0:1], v176 offset:0
ds_read_b64_tr_b16 a[2:3], v176 offset:512
ds_read_b64_tr_b16 a[4:5], v176 offset:8
ds_read_b64_tr_b16 a[6:7], v176 offset:520
ds_read_b64_tr_b16 a[8:9], v177 offset:0
ds_read_b64_tr_b16 a[10:11], v177 offset:512
ds_read_b64_tr_b16 a[12:13], v177 offset:8
ds_read_b64_tr_b16 a[14:15], v177 offset:520
s_add_u32 m0, s14, 114688
s_add_u32 s34, s42, 16384
buffer_load_dwordx4 v180, s[60:63], s34 offen lds
buffer_load_dwordx4 v181, s[60:63], s34 offen offset:1024 lds
s_add_u32 m0, s14, 122880
s_add_u32 s34, s54, 16384
buffer_load_dwordx4 v180, s[60:63], s34 offen lds
buffer_load_dwordx4 v181, s[60:63], s34 offen offset:1024 lds
s_waitcnt vmcnt(11) lgkmcnt(0)
ds_read_b64_tr_b16 a[16:17], v176 offset:16384
ds_read_b64_tr_b16 a[18:19], v176 offset:16896
ds_read_b64_tr_b16 a[20:21], v176 offset:16392
ds_read_b64_tr_b16 a[22:23], v176 offset:16904
ds_read_b64_tr_b16 a[24:25], v177 offset:16384
ds_read_b64_tr_b16 a[26:27], v177 offset:16896
ds_read_b64_tr_b16 a[28:29], v177 offset:16392
ds_read_b64_tr_b16 a[30:31], v177 offset:16904
s_add_u32 m0, s14, 65536
s_add_u32 s34, s42, 32768
buffer_load_dwordx4 v180, s[60:63], s34 offen lds
buffer_load_dwordx4 v181, s[60:63], s34 offen offset:1024 lds
s_add_u32 m0, s14, 73728
s_add_u32 s34, s54, 32768
buffer_load_dwordx4 v180, s[60:63], s34 offen lds
buffer_load_dwordx4 v181, s[60:63], s34 offen offset:1024 lds
s_waitcnt vmcnt(11) lgkmcnt(0)
ds_read_b64_tr_b16 a[64:65], v176 offset:32768
ds_read_b64_tr_b16 a[66:67], v176 offset:33280
ds_read_b64_tr_b16 a[68:69], v176 offset:32776
ds_read_b64_tr_b16 a[70:71], v176 offset:33288
ds_read_b64_tr_b16 a[72:73], v177 offset:32768
ds_read_b64_tr_b16 a[74:75], v177 offset:33280
ds_read_b64_tr_b16 a[76:77], v177 offset:32776
ds_read_b64_tr_b16 a[78:79], v177 offset:33288
s_add_u32 m0, s14, 81920
s_add_u32 s34, s42, 49152
buffer_load_dwordx4 v180, s[60:63], s34 offen lds
buffer_load_dwordx4 v181, s[60:63], s34 offen offset:1024 lds
s_add_u32 m0, s14, 90112
s_add_u32 s34, s54, 49152
buffer_load_dwordx4 v180, s[60:63], s34 offen lds
buffer_load_dwordx4 v181, s[60:63], s34 offen offset:1024 lds
s_waitcnt vmcnt(8) lgkmcnt(0)
ds_read_b64_tr_b16 a[96:97], v176 offset:49152
ds_read_b64_tr_b16 a[98:99], v176 offset:49664
ds_read_b64_tr_b16 a[100:101], v176 offset:49160
ds_read_b64_tr_b16 a[102:103], v176 offset:49672
ds_read_b64_tr_b16 a[104:105], v177 offset:49152
ds_read_b64_tr_b16 a[106:107], v177 offset:49664
ds_read_b64_tr_b16 a[108:109], v177 offset:49160
ds_read_b64_tr_b16 a[110:111], v177 offset:49672
s_add_u32 m0, s14, 98304
s_add_u32 s34, s42, 65536
buffer_load_dwordx4 v180, s[60:63], s34 offen lds
buffer_load_dwordx4 v181, s[60:63], s34 offen offset:1024 lds
s_add_u32 m0, s14, 106496
s_add_u32 s34, s54, 65536
buffer_load_dwordx4 v180, s[60:63], s34 offen lds
buffer_load_dwordx4 v181, s[60:63], s34 offen offset:1024 lds
s_waitcnt vmcnt(8) lgkmcnt(0)
ds_read_b64_tr_b16 a[128:129], v176 offset:0
ds_read_b64_tr_b16 a[130:131], v176 offset:512
ds_read_b64_tr_b16 a[132:133], v176 offset:8
ds_read_b64_tr_b16 a[134:135], v176 offset:520
ds_read_b64_tr_b16 a[136:137], v177 offset:0
ds_read_b64_tr_b16 a[138:139], v177 offset:512
ds_read_b64_tr_b16 a[140:141], v177 offset:8
ds_read_b64_tr_b16 a[142:143], v177 offset:520
s_add_u32 m0, s14, 114688
s_add_u32 s34, s12, 65536
buffer_load_dwordx4 v180, s[64:67], s34 offen lds
buffer_load_dwordx4 v181, s[64:67], s34 offen offset:1024 lds
s_add_u32 m0, s14, 122880
s_add_u32 s34, s12, 81920
buffer_load_dwordx4 v180, s[64:67], s34 offen lds
buffer_load_dwordx4 v181, s[64:67], s34 offen offset:1024 lds
s_waitcnt vmcnt(8) lgkmcnt(0)
ds_read_b64_tr_b16 a[160:161], v176 offset:16384
ds_read_b64_tr_b16 a[162:163], v176 offset:16896
ds_read_b64_tr_b16 a[164:165], v176 offset:16392
ds_read_b64_tr_b16 a[166:167], v176 offset:16904
ds_read_b64_tr_b16 a[168:169], v177 offset:16384
ds_read_b64_tr_b16 a[170:171], v177 offset:16896
ds_read_b64_tr_b16 a[172:173], v177 offset:16392
ds_read_b64_tr_b16 a[174:175], v177 offset:16904
s_add_u32 m0, s14, 65536
s_add_u32 s34, s12, 98304
buffer_load_dwordx4 v180, s[64:67], s34 offen lds
buffer_load_dwordx4 v181, s[64:67], s34 offen offset:1024 lds
s_add_u32 m0, s14, 73728
s_add_u32 s34, s12, 114688
buffer_load_dwordx4 v180, s[64:67], s34 offen lds
buffer_load_dwordx4 v181, s[64:67], s34 offen offset:1024 lds
s_waitcnt vmcnt(8) lgkmcnt(0)
ds_read_b64_tr_b16 a[192:193], v176 offset:32768
ds_read_b64_tr_b16 a[194:195], v176 offset:33280
ds_read_b64_tr_b16 a[196:197], v176 offset:32776
ds_read_b64_tr_b16 a[198:199], v176 offset:33288
ds_read_b64_tr_b16 a[200:201], v177 offset:32768
ds_read_b64_tr_b16 a[202:203], v177 offset:33280
ds_read_b64_tr_b16 a[204:205], v177 offset:32776
ds_read_b64_tr_b16 a[206:207], v177 offset:33288
s_add_u32 m0, s14, 81920
s_add_u32 s34, s43, 0
buffer_load_dwordx4 v180, s[60:63], s34 offen lds
buffer_load_dwordx4 v181, s[60:63], s34 offen offset:1024 lds
s_add_u32 m0, s14, 90112
s_add_u32 s34, s55, 0
buffer_load_dwordx4 v180, s[60:63], s34 offen lds
buffer_load_dwordx4 v181, s[60:63], s34 offen offset:1024 lds
s_waitcnt vmcnt(8) lgkmcnt(0)
ds_read_b64_tr_b16 a[32:33], v176 offset:49152
ds_read_b64_tr_b16 a[34:35], v176 offset:49664
ds_read_b64_tr_b16 a[36:37], v176 offset:49160
ds_read_b64_tr_b16 a[38:39], v176 offset:49672
ds_read_b64_tr_b16 a[40:41], v177 offset:49152
ds_read_b64_tr_b16 a[42:43], v177 offset:49664
ds_read_b64_tr_b16 a[44:45], v177 offset:49160
ds_read_b64_tr_b16 a[46:47], v177 offset:49672
s_add_u32 m0, s14, 98304
s_add_u32 s34, s43, 16384
buffer_load_dwordx4 v180, s[60:63], s34 offen lds
buffer_load_dwordx4 v181, s[60:63], s34 offen offset:1024 lds
s_add_u32 m0, s14, 106496
s_add_u32 s34, s55, 16384
buffer_load_dwordx4 v180, s[60:63], s34 offen lds
buffer_load_dwordx4 v181, s[60:63], s34 offen offset:1024 lds
s_waitcnt vmcnt(8) lgkmcnt(0)
ds_read_b64_tr_b16 a[48:49], v176 offset:0
ds_read_b64_tr_b16 a[50:51], v176 offset:512
ds_read_b64_tr_b16 a[52:53], v176 offset:8
ds_read_b64_tr_b16 a[54:55], v176 offset:520
ds_read_b64_tr_b16 a[56:57], v177 offset:0
ds_read_b64_tr_b16 a[58:59], v177 offset:512
ds_read_b64_tr_b16 a[60:61], v177 offset:8
ds_read_b64_tr_b16 a[62:63], v177 offset:520
s_add_u32 m0, s14, 114688
s_add_u32 s34, s43, 32768
buffer_load_dwordx4 v180, s[60:63], s34 offen lds
buffer_load_dwordx4 v181, s[60:63], s34 offen offset:1024 lds
s_add_u32 m0, s14, 122880
s_add_u32 s34, s55, 32768
buffer_load_dwordx4 v180, s[60:63], s34 offen lds
buffer_load_dwordx4 v181, s[60:63], s34 offen offset:1024 lds
s_mov_b32 s32, 4096
s_mov_b64 exec, 0xfffff
buffer_load_dword v183, v229, s[4:7], s32 offen sc1
s_mov_b64 exec, -1
s_waitcnt vmcnt(9) lgkmcnt(0)
ds_read_b64_tr_b16 a[80:81], v176 offset:16384
ds_read_b64_tr_b16 a[82:83], v176 offset:16896
ds_read_b64_tr_b16 a[84:85], v176 offset:16392
ds_read_b64_tr_b16 a[86:87], v176 offset:16904
ds_read_b64_tr_b16 a[88:89], v177 offset:16384
ds_read_b64_tr_b16 a[90:91], v177 offset:16896
ds_read_b64_tr_b16 a[92:93], v177 offset:16392
ds_read_b64_tr_b16 a[94:95], v177 offset:16904
s_add_u32 m0, s14, 65536
s_add_u32 s34, s43, 49152
buffer_load_dwordx4 v180, s[60:63], s34 offen lds
buffer_load_dwordx4 v181, s[60:63], s34 offen offset:1024 lds
s_add_u32 m0, s14, 73728
s_add_u32 s34, s55, 49152
buffer_load_dwordx4 v180, s[60:63], s34 offen lds
buffer_load_dwordx4 v181, s[60:63], s34 offen offset:1024 lds
s_waitcnt vmcnt(9) lgkmcnt(0)
ds_read_b64_tr_b16 a[112:113], v176 offset:32768
ds_read_b64_tr_b16 a[114:115], v176 offset:33280
ds_read_b64_tr_b16 a[116:117], v176 offset:32776
ds_read_b64_tr_b16 a[118:119], v176 offset:33288
ds_read_b64_tr_b16 a[120:121], v177 offset:32768
ds_read_b64_tr_b16 a[122:123], v177 offset:33280
ds_read_b64_tr_b16 a[124:125], v177 offset:32776
ds_read_b64_tr_b16 a[126:127], v177 offset:33288
s_add_u32 m0, s14, 81920
s_add_u32 s34, s43, 65536
buffer_load_dwordx4 v180, s[60:63], s34 offen lds
buffer_load_dwordx4 v181, s[60:63], s34 offen offset:1024 lds
s_add_u32 m0, s14, 90112
s_add_u32 s34, s55, 65536
buffer_load_dwordx4 v180, s[60:63], s34 offen lds
buffer_load_dwordx4 v181, s[60:63], s34 offen offset:1024 lds
s_waitcnt vmcnt(9) lgkmcnt(0)
ds_read_b64_tr_b16 a[144:145], v176 offset:49152
ds_read_b64_tr_b16 a[146:147], v176 offset:49664
ds_read_b64_tr_b16 a[148:149], v176 offset:49160
ds_read_b64_tr_b16 a[150:151], v176 offset:49672
ds_read_b64_tr_b16 a[152:153], v177 offset:49152
ds_read_b64_tr_b16 a[154:155], v177 offset:49664
ds_read_b64_tr_b16 a[156:157], v177 offset:49160
ds_read_b64_tr_b16 a[158:159], v177 offset:49672
s_add_u32 m0, s14, 98304
s_add_u32 s34, s42, 81920
buffer_load_dwordx4 v180, s[60:63], s34 offen lds
buffer_load_dwordx4 v181, s[60:63], s34 offen offset:1024 lds
s_add_u32 m0, s14, 106496
s_add_u32 s34, s13, 81920
buffer_load_dwordx4 v180, s[60:63], s34 offen lds
buffer_load_dwordx4 v181, s[60:63], s34 offen offset:1024 lds
s_mov_b64 exec, 0xfffff
s_waitcnt vmcnt(12)
v_and_b32 v184, -16, v183
v_cmp_ne_u32 vcc, s53, v184
s_cbranch_vccnz L_F0R
L_F0X:
v_cmp_ne_u32 vcc, s57, v183
s_mov_b64 exec, -1
s_and_b32 s30, vcc_lo, 0xffff
s_cselect_b32 s26, 0, 1
s_barrier
s_mov_b32 s56, 0
s_mov_b32 s57, -1
s_lshr_b32 s8, s20, 1
s_lshl_b32 s8, s8, 15
s_and_b32 s31, s20, 1
s_lshl_b32 s31, s31, 12
s_add_u32 s8, s8, s31
s_add_u32 s9, s8, s28
v_lshrrev_b32 v230, 4, v240
v_mul_u32_u24 v230, 1280, v230
v_and_b32 v231, 0xf0, v224
v_add_u32 v230, v230, v231
s_lshl_b32 s30, s20, 8
s_add_u32 s31, s30, s28
s_add_u32 s31, s31, 368640
s_add_u32 s30, s30, 161280
s_cmp_lt_u32 s20, 2
s_cselect_b32 s31, s31, 1073741824
s_cselect_b32 s30, s30, 163136
v_add_u32 v231, s30, v231
buffer_load_dwordx4 v[160:163], v230, s[4:7], s31 offen sc1
s_add_u32 s31, s31, 5120
buffer_load_dwordx4 v[164:167], v230, s[4:7], s31 offen sc1
s_add_u32 s31, s31, 5120
buffer_load_dwordx4 v[168:171], v230, s[4:7], s31 offen sc1
s_add_u32 s31, s31, 5120
buffer_load_dwordx4 v[172:175], v230, s[4:7], s31 offen sc1
s_add_u32 m0, s8, 0
s_add_u32 s10, s9, 0
buffer_load_dwordx4 v224, s[4:7], s10 offen offset:0 sc1 lds
buffer_load_dwordx4 v224, s[4:7], s10 offen offset:1024 sc1 lds
s_waitcnt vmcnt(14) lgkmcnt(0)
ds_read_b64_tr_b16 a[176:177], v176 offset:0
ds_read_b64_tr_b16 a[178:179], v176 offset:512
ds_read_b64_tr_b16 a[180:181], v176 offset:8
ds_read_b64_tr_b16 a[182:183], v176 offset:520
ds_read_b64_tr_b16 a[184:185], v177 offset:0
ds_read_b64_tr_b16 a[186:187], v177 offset:512
ds_read_b64_tr_b16 a[188:189], v177 offset:8
ds_read_b64_tr_b16 a[190:191], v177 offset:520
buffer_load_dwordx4 v224, s[4:7], s10 offen offset:2048 sc1 lds
buffer_load_dwordx4 v224, s[4:7], s10 offen offset:3072 sc1 lds
buffer_load_dwordx4 v[0:3], v224, s[4:7], s44 offen offset:0 sc1
buffer_load_dwordx4 v[4:7], v224, s[4:7], s44 offen offset:1024 sc1
buffer_load_dwordx4 v[8:11], v224, s[4:7], s44 offen offset:2048 sc1
buffer_load_dwordx4 v[12:15], v224, s[4:7], s44 offen offset:3072 sc1
s_waitcnt vmcnt(16) lgkmcnt(0)
ds_read_b64_tr_b16 a[208:209], v176 offset:16384
ds_read_b64_tr_b16 a[210:211], v176 offset:16896
ds_read_b64_tr_b16 a[212:213], v176 offset:16392
ds_read_b64_tr_b16 a[214:215], v176 offset:16904
ds_read_b64_tr_b16 a[216:217], v177 offset:16384
ds_read_b64_tr_b16 a[218:219], v177 offset:16896
ds_read_b64_tr_b16 a[220:221], v177 offset:16392
ds_read_b64_tr_b16 a[222:223], v177 offset:16904
s_add_u32 s33, s44, 4096
buffer_load_dwordx4 v[16:19], v224, s[4:7], s33 offen offset:0 sc1
buffer_load_dwordx4 v[20:23], v224, s[4:7], s33 offen offset:1024 sc1
buffer_load_dwordx4 v[24:27], v224, s[4:7], s33 offen offset:2048 sc1
buffer_load_dwordx4 v[28:31], v224, s[4:7], s33 offen offset:3072 sc1
s_add_u32 m0, s8, 8192
s_add_u32 s10, s9, 8192
buffer_load_dwordx4 v224, s[4:7], s10 offen offset:0 sc1 lds
buffer_load_dwordx4 v224, s[4:7], s10 offen offset:1024 sc1 lds
s_waitcnt vmcnt(18) lgkmcnt(0)
ds_read_b64_tr_b16 a[224:225], v176 offset:32768
ds_read_b64_tr_b16 a[226:227], v176 offset:33280
ds_read_b64_tr_b16 a[228:229], v176 offset:32776
ds_read_b64_tr_b16 a[230:231], v176 offset:33288
ds_read_b64_tr_b16 a[232:233], v177 offset:32768
ds_read_b64_tr_b16 a[234:235], v177 offset:33280
ds_read_b64_tr_b16 a[236:237], v177 offset:32776
ds_read_b64_tr_b16 a[238:239], v177 offset:33288
buffer_load_dwordx4 v224, s[4:7], s10 offen offset:2048 sc1 lds
buffer_load_dwordx4 v224, s[4:7], s10 offen offset:3072 sc1 lds
s_add_u32 s33, s44, 8192
buffer_load_dwordx4 v[32:35], v224, s[4:7], s33 offen offset:0 sc1
s_waitcnt lgkmcnt(0)
s_mov_b32 s64, 0xaaaaaaaa
s_mov_b32 s65, 0xaaaaaaaa
buffer_load_dwordx4 v[36:39], v224, s[4:7], s33 offen offset:1024 sc1
s_waitcnt vmcnt(14)
s_barrier
ds_read_b128 v[192:195], v224 offset:0
ds_read_b128 v[196:199], v224 offset:32768
ds_read_b128 v[200:203], v224 offset:1024
ds_read_b128 v[204:207], v224 offset:33792
ds_read_b128 v[208:211], v224 offset:2048
ds_read_b128 v[212:215], v224 offset:34816
ds_read_b128 v[216:219], v224 offset:3072
s_waitcnt vmcnt(12) lgkmcnt(5)
v_mfma_f32_16x16x32_bf16 v[128:131], v[192:195], v[0:3], 0
ds_read_b128 v[220:223], v224 offset:35840
v_mfma_f32_16x16x32_bf16 v[132:135], v[192:195], v[4:7], 0
v_mfma_f32_16x16x32_bf16 v[148:151], v[196:199], v[4:7], 0
ds_read_b128 v[192:195], v224 offset:4096
v_mfma_f32_16x16x32_bf16 v[144:147], v[196:199], v[0:3], 0
buffer_load_dwordx4 v[40:43], v224, s[4:7], s33 offen offset:2048 sc1
v_add_f32 v160, v160, v164
v_add_f32 v161, v161, v165
s_waitcnt lgkmcnt(5)
v_mfma_f32_16x16x32_bf16 v[136:139], v[200:203], v[0:3], 0
ds_read_b128 v[196:199], v224 offset:36864
v_add_f32 v162, v162, v166
v_mfma_f32_16x16x32_bf16 v[140:143], v[200:203], v[4:7], 0
buffer_load_dwordx4 v[44:47], v224, s[4:7], s33 offen offset:3072 sc1
v_add_f32 v163, v163, v167
v_add_f32 v168, v168, v172
v_mfma_f32_16x16x32_bf16 v[156:159], v[204:207], v[4:7], 0
ds_read_b128 v[200:203], v224 offset:5120
v_add_f32 v169, v169, v173
v_mfma_f32_16x16x32_bf16 v[152:155], v[204:207], v[0:3], 0
s_add_u32 s33, s44, 12288
buffer_load_dwordx4 v[48:51], v224, s[4:7], s33 offen offset:0 sc1
v_add_f32 v170, v170, v174
v_add_f32 v171, v171, v175
s_waitcnt vmcnt(13) lgkmcnt(5)
v_mfma_f32_16x16x32_bf16 v[128:131], v[208:211], v[8:11], v[128:131]
ds_read_b128 v[204:207], v224 offset:37888
v_add_f32 v160, v160, v168
v_mfma_f32_16x16x32_bf16 v[132:135], v[208:211], v[12:15], v[132:135]
buffer_load_dwordx4 v[52:55], v224, s[4:7], s33 offen offset:1024 sc1
v_add_f32 v161, v161, v169
v_add_f32 v162, v162, v170
v_mfma_f32_16x16x32_bf16 v[148:151], v[212:215], v[12:15], v[148:151]
ds_read_b128 v[208:211], v224 offset:6144
v_add_f32 v163, v163, v171
v_mfma_f32_16x16x32_bf16 v[144:147], v[212:215], v[8:11], v[144:147]
buffer_load_dwordx4 v[56:59], v224, s[4:7], s33 offen offset:2048 sc1
v_mov_b32 v164, v160
v_mov_b32 v165, v161
s_waitcnt lgkmcnt(5)
v_mfma_f32_16x16x32_bf16 v[136:139], v[216:219], v[8:11], v[136:139]
ds_read_b128 v[212:215], v224 offset:38912
v_mov_b32 v166, v162
v_mfma_f32_16x16x32_bf16 v[140:143], v[216:219], v[12:15], v[140:143]
buffer_load_dwordx4 v[60:63], v224, s[4:7], s33 offen offset:3072 sc1
v_mov_b32 v167, v163
v_permlane16_swap_b32 v160, v164
v_mfma_f32_16x16x32_bf16 v[156:159], v[220:223], v[12:15], v[156:159]
ds_read_b128 v[216:219], v224 offset:7168
v_permlane16_swap_b32 v161, v165
v_mfma_f32_16x16x32_bf16 v[152:155], v[220:223], v[8:11], v[152:155]
s_add_u32 m0, s8, 16384
s_add_u32 s10, s9, 16384
buffer_load_dwordx4 v224, s[4:7], s10 offen offset:0 sc1 lds
v_permlane16_swap_b32 v162, v166
v_permlane16_swap_b32 v163, v167
s_waitcnt vmcnt(15) lgkmcnt(5)
v_mfma_f32_16x16x32_bf16 v[128:131], v[192:195], v[16:19], v[128:131]
ds_read_b128 v[220:223], v224 offset:39936
v_add_f32 v160, v160, v164
v_mfma_f32_16x16x32_bf16 v[132:135], v[192:195], v[20:23], v[132:135]
buffer_load_dwordx4 v224, s[4:7], s10 offen offset:1024 sc1 lds
v_add_f32 v161, v161, v165
v_add_f32 v162, v162, v166
v_mfma_f32_16x16x32_bf16 v[148:151], v[196:199], v[20:23], v[148:151]
s_waitcnt vmcnt(10)
s_barrier
ds_read_b128 v[192:195], v224 offset:8192
v_add_f32 v163, v163, v167
v_mfma_f32_16x16x32_bf16 v[144:147], v[196:199], v[16:19], v[144:147]
buffer_load_dwordx4 v224, s[4:7], s10 offen offset:2048 sc1 lds
v_mov_b32 v164, v160
v_mov_b32 v165, v161
s_waitcnt lgkmcnt(5)
v_mfma_f32_16x16x32_bf16 v[136:139], v[200:203], v[16:19], v[136:139]
ds_read_b128 v[196:199], v224 offset:40960
v_mov_b32 v166, v162
v_mfma_f32_16x16x32_bf16 v[140:143], v[200:203], v[20:23], v[140:143]
buffer_load_dwordx4 v224, s[4:7], s10 offen offset:3072 sc1 lds
v_mov_b32 v167, v163
v_permlane32_swap_b32 v160, v164
v_mfma_f32_16x16x32_bf16 v[156:159], v[204:207], v[20:23], v[156:159]
ds_read_b128 v[200:203], v224 offset:9216
v_permlane32_swap_b32 v161, v165
v_mfma_f32_16x16x32_bf16 v[152:155], v[204:207], v[16:19], v[152:155]
s_add_u32 s33, s44, 16384
buffer_load_dwordx4 v[64:67], v224, s[4:7], s33 offen offset:0 sc1
v_permlane32_swap_b32 v162, v166
v_permlane32_swap_b32 v163, v167
s_waitcnt lgkmcnt(5)
v_mfma_f32_16x16x32_bf16 v[128:131], v[208:211], v[24:27], v[128:131]
ds_read_b128 v[204:207], v224 offset:41984
v_add_f32 v160, v160, v164
v_mfma_f32_16x16x32_bf16 v[132:135], v[208:211], v[28:31], v[132:135]
buffer_load_dwordx4 v[68:71], v224, s[4:7], s33 offen offset:1024 sc1
v_add_f32 v161, v161, v165
v_add_f32 v162, v162, v166
v_mfma_f32_16x16x32_bf16 v[148:151], v[212:215], v[28:31], v[148:151]
ds_read_b128 v[208:211], v224 offset:10240
v_add_f32 v163, v163, v167
v_mfma_f32_16x16x32_bf16 v[144:147], v[212:215], v[24:27], v[144:147]
buffer_load_dwordx4 v[72:75], v224, s[4:7], s33 offen offset:2048 sc1
v_cvt_pk_bf16_f32 v164, v160, v161
v_cvt_pk_bf16_f32 v165, v162, v163
s_waitcnt lgkmcnt(5)
v_mfma_f32_16x16x32_bf16 v[136:139], v[216:219], v[24:27], v[136:139]
ds_read_b128 v[212:215], v224 offset:43008
v_lshlrev_b32 v168, 16, v164
v_mfma_f32_16x16x32_bf16 v[140:143], v[216:219], v[28:31], v[140:143]
buffer_load_dwordx4 v[76:79], v224, s[4:7], s33 offen offset:3072 sc1
v_and_b32 v169, 0xffff0000, v164
v_lshlrev_b32 v170, 16, v165
v_mfma_f32_16x16x32_bf16 v[156:159], v[220:223], v[28:31], v[156:159]
ds_read_b128 v[216:219], v224 offset:11264
v_and_b32 v171, 0xffff0000, v165
v_mfma_f32_16x16x32_bf16 v[152:155], v[220:223], v[24:27], v[152:155]
s_add_u32 s33, s44, 20480
buffer_load_dwordx4 v[80:83], v224, s[4:7], s33 offen offset:0 sc1
v_sub_f32 v160, v160, v168
v_sub_f32 v161, v161, v169
s_waitcnt vmcnt(15) lgkmcnt(5)
v_mfma_f32_16x16x32_bf16 v[128:131], v[192:195], v[32:35], v[128:131]
ds_read_b128 v[220:223], v224 offset:44032
v_sub_f32 v162, v162, v170
v_mfma_f32_16x16x32_bf16 v[132:135], v[192:195], v[36:39], v[132:135]
buffer_load_dwordx4 v[84:87], v224, s[4:7], s33 offen offset:1024 sc1
v_sub_f32 v163, v163, v171
v_cvt_pk_bf16_f32 v164, v168, v160
v_mfma_f32_16x16x32_bf16 v[148:151], v[196:199], v[36:39], v[148:151]
ds_read_b128 v[192:195], v224 offset:12288
v_cvt_pk_bf16_f32 v165, v169, v161
v_mfma_f32_16x16x32_bf16 v[144:147], v[196:199], v[32:35], v[144:147]
buffer_load_dwordx4 v[88:91], v224, s[4:7], s33 offen offset:2048 sc1
v_cvt_pk_bf16_f32 v166, v170, v162
v_cvt_pk_bf16_f32 v167, v171, v163
s_waitcnt lgkmcnt(5)
v_mfma_f32_16x16x32_bf16 v[136:139], v[200:203], v[32:35], v[136:139]
ds_read_b128 v[196:199], v224 offset:45056
ds_write_b128 v231, v[164:167]
v_mfma_f32_16x16x32_bf16 v[140:143], v[200:203], v[36:39], v[140:143]
buffer_load_dwordx4 v[92:95], v224, s[4:7], s33 offen offset:3072 sc1
v_and_b32 v246, 0x1f0, v224
s_lshl_b32 s32, s20, 9
v_mfma_f32_16x16x32_bf16 v[156:159], v[204:207], v[36:39], v[156:159]
ds_read_b128 v[200:203], v224 offset:13312
s_add_u32 s32, s32, 131072
v_mfma_f32_16x16x32_bf16 v[152:155], v[204:207], v[32:35], v[152:155]
buffer_load_dwordx4 v[176:179], v245, s[4:7], s27 offen offset:0 sc1
v_lshrrev_b32 v247, 5, v240
v_mul_u32_u24 v247, 2176, v247
s_branch L_SK0
L_ST0:
s_setpc_b64 s[10:11]
L_SK0:
s_waitcnt vmcnt(17) lgkmcnt(6)
v_mfma_f32_16x16x32_bf16 v[128:131], v[208:211], v[40:43], v[128:131]
ds_read_b128 v[204:207], v224 offset:46080
v_add3_u32 v246, v246, v247, s32
v_mfma_f32_16x16x32_bf16 v[132:135], v[208:211], v[44:47], v[132:135]
buffer_load_dwordx4 v[180:183], v245, s[4:7], s27 offen offset:512 sc1
v_add_u32 v247, v246, v247
v_lshrrev_b32 v248, 2, v240
v_mfma_f32_16x16x32_bf16 v[148:151], v[212:215], v[44:47], v[148:151]
ds_read_b128 v[208:211], v224 offset:14336
v_lshlrev_b32 v248, 4, v248
v_mfma_f32_16x16x32_bf16 v[144:147], v[212:215], v[40:43], v[144:147]
s_add_u32 m0, s8, 24576
s_add_u32 s10, s9, 24576
buffer_load_dwordx4 v224, s[4:7], s10 offen offset:0 sc1 lds
v_and_b32 v249, 1, v240
v_lshl_add_u32 v248, v249, 3, v248
s_waitcnt lgkmcnt(6)
v_mfma_f32_16x16x32_bf16 v[136:139], v[216:219], v[40:43], v[136:139]
ds_read_b128 v[212:215], v224 offset:47104
v_bfe_u32 v249, v240, 1, 1
v_mfma_f32_16x16x32_bf16 v[140:143], v[216:219], v[44:47], v[140:143]
buffer_load_dwordx4 v224, s[4:7], s10 offen offset:1024 sc1 lds
v_mul_u32_u24 v249, 2176, v249
v_add_u32 v248, v248, v249
v_mfma_f32_16x16x32_bf16 v[156:159], v[220:223], v[44:47], v[156:159]
ds_read_b128 v[216:219], v224 offset:15360
s_lshr_b32 s32, s20, 1
v_mfma_f32_16x16x32_bf16 v[152:155], v[220:223], v[40:43], v[152:155]
buffer_load_dwordx4 v224, s[4:7], s10 offen offset:2048 sc1 lds
s_mul_i32 s32, s32, 4352
s_add_u32 s32, s32, 148480
s_waitcnt vmcnt(19) lgkmcnt(6)
v_mfma_f32_16x16x32_bf16 v[128:131], v[192:195], v[48:51], v[128:131]
ds_read_b128 v[220:223], v224 offset:48128
v_add_u32 v249, s32, v248
v_mfma_f32_16x16x32_bf16 v[132:135], v[192:195], v[52:55], v[132:135]
buffer_load_dwordx4 v224, s[4:7], s10 offen offset:3072 sc1 lds
s_mul_i32 s32, s20, 4352
s_add_u32 s32, s32, 131072
v_mfma_f32_16x16x32_bf16 v[148:151], v[196:199], v[52:55], v[148:151]
s_waitcnt vmcnt(14)
s_barrier
ds_read_b128 v[192:195], v224 offset:16384
v_add_u32 v248, s32, v248
v_mfma_f32_16x16x32_bf16 v[144:147], v[196:199], v[48:51], v[144:147]
s_add_u32 s33, s44, 24576
buffer_load_dwordx4 v[96:99], v224, s[4:7], s33 offen offset:0 sc1
v_and_b32 v254, 0xf0, v224
v_bfe_u32 v255, v240, 4, 1
s_waitcnt lgkmcnt(5)
v_mfma_f32_16x16x32_bf16 v[136:139], v[200:203], v[48:51], v[136:139]
ds_read_b128 v[196:199], v224 offset:49152
v_lshl_add_u32 v254, v255, 3, v254
v_mfma_f32_16x16x32_bf16 v[140:143], v[200:203], v[52:55], v[140:143]
buffer_load_dwordx4 v[100:103], v224, s[4:7], s33 offen offset:1024 sc1
v_lshrrev_b32 v255, 5, v240
v_lshl_add_u32 v254, v255, 8, v254
v_mfma_f32_16x16x32_bf16 v[156:159], v[204:207], v[52:55], v[156:159]
ds_read_b128 v[200:203], v224 offset:17408
v_and_b32 v255, 48, v240
v_mfma_f32_16x16x32_bf16 v[152:155], v[204:207], v[48:51], v[152:155]
buffer_load_dwordx4 v[104:107], v224, s[4:7], s33 offen offset:2048 sc1
v_mov_b32 v250, 0x3f803f80
v_mov_b32 v251, 0x3f803f80
s_waitcnt lgkmcnt(5)
v_mfma_f32_16x16x32_bf16 v[128:131], v[208:211], v[56:59], v[128:131]
ds_read_b128 v[204:207], v224 offset:50176
v_mov_b32 v252, 0x3f803f80
v_mfma_f32_16x16x32_bf16 v[132:135], v[208:211], v[60:63], v[132:135]
buffer_load_dwordx4 v[108:111], v224, s[4:7], s33 offen offset:3072 sc1
v_mov_b32 v253, 0x3f803f80
v_mfma_f32_16x16x32_bf16 v[148:151], v[212:215], v[60:63], v[148:151]
ds_read_b128 v[208:211], v224 offset:18432
v_mfma_f32_16x16x32_bf16 v[144:147], v[212:215], v[56:59], v[144:147]
s_add_u32 s33, s44, 28672
buffer_load_dwordx4 v[112:115], v224, s[4:7], s33 offen offset:0 sc1
s_waitcnt lgkmcnt(5)
v_mfma_f32_16x16x32_bf16 v[136:139], v[216:219], v[56:59], v[136:139]
ds_read_b128 v[212:215], v224 offset:51200
v_mfma_f32_16x16x32_bf16 v[140:143], v[216:219], v[60:63], v[140:143]
buffer_load_dwordx4 v[116:119], v224, s[4:7], s33 offen offset:1024 sc1
v_mfma_f32_16x16x32_bf16 v[156:159], v[220:223], v[60:63], v[156:159]
ds_read_b128 v[216:219], v224 offset:19456
v_mfma_f32_16x16x32_bf16 v[152:155], v[220:223], v[56:59], v[152:155]
buffer_load_dwordx4 v[120:123], v224, s[4:7], s33 offen offset:2048 sc1
s_waitcnt vmcnt(19) lgkmcnt(5)
v_mfma_f32_16x16x32_bf16 v[128:131], v[192:195], v[64:67], v[128:131]
ds_read_b128 v[220:223], v224 offset:52224
v_mfma_f32_16x16x32_bf16 v[132:135], v[192:195], v[68:71], v[132:135]
buffer_load_dwordx4 v[124:127], v224, s[4:7], s33 offen offset:3072 sc1
v_mfma_f32_16x16x32_bf16 v[148:151], v[196:199], v[68:71], v[148:151]
ds_read_b128 v[192:195], v224 offset:20480
v_mfma_f32_16x16x32_bf16 v[144:147], v[196:199], v[64:67], v[144:147]
s_waitcnt lgkmcnt(5)
v_mfma_f32_16x16x32_bf16 v[136:139], v[200:203], v[64:67], v[136:139]
ds_read_b128 v[196:199], v224 offset:53248
v_mfma_f32_16x16x32_bf16 v[140:143], v[200:203], v[68:71], v[140:143]
v_mfma_f32_16x16x32_bf16 v[156:159], v[204:207], v[68:71], v[156:159]
ds_read_b128 v[200:203], v224 offset:21504
v_mfma_f32_16x16x32_bf16 v[152:155], v[204:207], v[64:67], v[152:155]
s_waitcnt vmcnt(18) lgkmcnt(5)
v_mfma_f32_16x16x32_bf16 v[128:131], v[208:211], v[72:75], v[128:131]
ds_read_b128 v[204:207], v224 offset:54272
v_mfma_f32_16x16x32_bf16 v[132:135], v[208:211], v[76:79], v[132:135]
v_mfma_f32_16x16x32_bf16 v[148:151], v[212:215], v[76:79], v[148:151]
ds_read_b128 v[208:211], v224 offset:22528
v_mfma_f32_16x16x32_bf16 v[144:147], v[212:215], v[72:75], v[144:147]
s_waitcnt lgkmcnt(5)
v_mfma_f32_16x16x32_bf16 v[136:139], v[216:219], v[72:75], v[136:139]
ds_read_b128 v[212:215], v224 offset:55296
v_mfma_f32_16x16x32_bf16 v[140:143], v[216:219], v[76:79], v[140:143]
v_mfma_f32_16x16x32_bf16 v[156:159], v[220:223], v[76:79], v[156:159]
ds_read_b128 v[216:219], v224 offset:23552
v_mfma_f32_16x16x32_bf16 v[152:155], v[220:223], v[72:75], v[152:155]
s_waitcnt vmcnt(16) lgkmcnt(5)
v_mfma_f32_16x16x32_bf16 v[128:131], v[192:195], v[80:83], v[128:131]
ds_read_b128 v[220:223], v224 offset:56320
v_mfma_f32_16x16x32_bf16 v[132:135], v[192:195], v[84:87], v[132:135]
s_add_u32 m0, s41, 65536
s_add_u32 s34, s36, 65536
buffer_load_dwordx4 v224, s[4:7], s34 offen offset:0 sc1 lds
v_mfma_f32_16x16x32_bf16 v[148:151], v[196:199], v[84:87], v[148:151]
s_waitcnt vmcnt(9)
s_barrier
ds_read_b128 v[192:195], v224 offset:24576
v_mfma_f32_16x16x32_bf16 v[144:147], v[196:199], v[80:83], v[144:147]
s_waitcnt lgkmcnt(5)
v_mfma_f32_16x16x32_bf16 v[136:139], v[200:203], v[80:83], v[136:139]
ds_read_b128 v[196:199], v224 offset:57344
v_mfma_f32_16x16x32_bf16 v[140:143], v[200:203], v[84:87], v[140:143]
v_mfma_f32_16x16x32_bf16 v[156:159], v[204:207], v[84:87], v[156:159]
ds_read_b128 v[200:203], v224 offset:25600
v_mfma_f32_16x16x32_bf16 v[152:155], v[204:207], v[80:83], v[152:155]
buffer_load_dwordx4 v224, s[4:7], s34 offen offset:1024 sc1 lds
s_waitcnt lgkmcnt(5)
v_mfma_f32_16x16x32_bf16 v[128:131], v[208:211], v[88:91], v[128:131]
ds_read_b128 v[204:207], v224 offset:58368
v_mfma_f32_16x16x32_bf16 v[132:135], v[208:211], v[92:95], v[132:135]
v_add_f32 v176, v176, v180
v_mfma_f32_16x16x32_bf16 v[148:151], v[212:215], v[92:95], v[148:151]
ds_read_b128 v[208:211], v224 offset:26624
v_add_f32 v177, v177, v181
v_mfma_f32_16x16x32_bf16 v[144:147], v[212:215], v[88:91], v[144:147]
v_add_f32 v178, v178, v182
s_waitcnt lgkmcnt(5)
v_mfma_f32_16x16x32_bf16 v[136:139], v[216:219], v[88:91], v[136:139]
ds_read_b128 v[212:215], v224 offset:59392
v_add_f32 v179, v179, v183
v_mfma_f32_16x16x32_bf16 v[140:143], v[216:219], v[92:95], v[140:143]
buffer_load_dwordx4 v224, s[4:7], s34 offen offset:2048 sc1 lds
v_add_f32_dpp v176, v176, v176 quad_perm:[1,0,3,2] row_mask:0xf bank_mask:0xf
v_mfma_f32_16x16x32_bf16 v[156:159], v[220:223], v[92:95], v[156:159]
ds_read_b128 v[216:219], v224 offset:27648
v_add_f32_dpp v177, v177, v177 quad_perm:[1,0,3,2] row_mask:0xf bank_mask:0xf
v_mfma_f32_16x16x32_bf16 v[152:155], v[220:223], v[88:91], v[152:155]
v_add_f32_dpp v178, v178, v178 quad_perm:[1,0,3,2] row_mask:0xf bank_mask:0xf
s_waitcnt vmcnt(9) lgkmcnt(5)
v_mfma_f32_16x16x32_bf16 v[128:131], v[192:195], v[96:99], v[128:131]
ds_read_b128 v[220:223], v224 offset:60416
v_add_f32_dpp v179, v179, v179 quad_perm:[1,0,3,2] row_mask:0xf bank_mask:0xf
v_mfma_f32_16x16x32_bf16 v[132:135], v[192:195], v[100:103], v[132:135]
v_cndmask_b32 v176, v176, v178, s[64:65]
v_mfma_f32_16x16x32_bf16 v[148:151], v[196:199], v[100:103], v[148:151]
ds_read_b128 v[192:195], v224 offset:28672
v_cndmask_b32 v177, v177, v179, s[64:65]
v_mfma_f32_16x16x32_bf16 v[144:147], v[196:199], v[96:99], v[144:147]
buffer_load_dwordx4 v224, s[4:7], s34 offen offset:3072 sc1 lds
v_mov_b32 v178, v176
s_waitcnt lgkmcnt(5)
v_mfma_f32_16x16x32_bf16 v[136:139], v[200:203], v[96:99], v[136:139]
ds_read_b128 v[196:199], v224 offset:61440
v_mov_b32 v179, v177
v_mfma_f32_16x16x32_bf16 v[140:143], v[200:203], v[100:103], v[140:143]
s_mov_b32 s35, 0x3b000000
v_mfma_f32_16x16x32_bf16 v[156:159], v[204:207], v[100:103], v[156:159]
ds_read_b128 v[200:203], v224 offset:29696
v_permlane32_swap_b32 v176, v178
v_mfma_f32_16x16x32_bf16 v[152:155], v[204:207], v[96:99], v[152:155]
v_permlane32_swap_b32 v177, v179
s_waitcnt vmcnt(8) lgkmcnt(5)
v_mfma_f32_16x16x32_bf16 v[128:131], v[208:211], v[104:107], v[128:131]
ds_read_b128 v[204:207], v224 offset:62464
v_add_f32 v176, v176, v178
v_mfma_f32_16x16x32_bf16 v[132:135], v[208:211], v[108:111], v[132:135]
s_add_u32 m0, s41, 81920
s_add_u32 s34, s36, 81920
buffer_load_dwordx4 v224, s[4:7], s34 offen offset:0 sc1 lds
v_add_f32 v177, v177, v179
v_mfma_f32_16x16x32_bf16 v[148:151], v[212:215], v[108:111], v[148:151]
ds_read_b128 v[208:211], v224 offset:30720
v_mul_f32 v176, 0xbb000000, v176
v_mfma_f32_16x16x32_bf16 v[144:147], v[212:215], v[104:107], v[144:147]
v_mul_f32 v178, v176, v176
s_waitcnt lgkmcnt(5)
v_mfma_f32_16x16x32_bf16 v[136:139], v[216:219], v[104:107], v[136:139]
ds_read_b128 v[212:215], v224 offset:63488
v_fma_f32 v177, v177, s35, -v178
v_mfma_f32_16x16x32_bf16 v[140:143], v[216:219], v[108:111], v[140:143]
v_cvt_pk_bf16_f32 v179, v176, v176
v_mfma_f32_16x16x32_bf16 v[156:159], v[220:223], v[108:111], v[156:159]
ds_read_b128 v[216:219], v224 offset:31744
v_max_f32 v177, 0, v177
v_mfma_f32_16x16x32_bf16 v[152:155], v[220:223], v[104:107], v[152:155]
buffer_load_dwordx4 v224, s[4:7], s34 offen offset:1024 sc1 lds
v_and_b32 v180, 0xffff0000, v179
s_waitcnt vmcnt(8) lgkmcnt(5)
v_mfma_f32_16x16x32_bf16 v[128:131], v[192:195], v[112:115], v[128:131]
ds_read_b128 v[220:223], v224 offset:64512
v_add_f32 v177, 0x3727c5ac, v177
v_mfma_f32_16x16x32_bf16 v[132:135], v[192:195], v[116:119], v[132:135]
v_sub_f32 v180, v176, v180
v_mfma_f32_16x16x32_bf16 v[148:151], v[196:199], v[116:119], v[148:151]
ds_read_b32 v192, v226 offset:0
v_rsq_f32 v236, v177
v_mfma_f32_16x16x32_bf16 v[144:147], v[196:199], v[112:115], v[144:147]
v_mov_b32 v229, 0
s_waitcnt lgkmcnt(5)
v_mfma_f32_16x16x32_bf16 v[136:139], v[200:203], v[112:115], v[136:139]
ds_read_b32 v196, v226 offset:128
v_cvt_pk_bf16_f32 v180, v180, v180
v_mfma_f32_16x16x32_bf16 v[140:143], v[200:203], v[116:119], v[140:143]
buffer_load_dwordx4 v224, s[4:7], s34 offen offset:2048 sc1 lds
v_mul_f32 v238, 0x3fb8aa3b, v236
v_mfma_f32_16x16x32_bf16 v[156:159], v[204:207], v[116:119], v[156:159]
ds_read_b32 v200, v226 offset:64
v_cndmask_b32 v232, v179, v180, s[56:57]
v_mfma_f32_16x16x32_bf16 v[152:155], v[204:207], v[112:115], v[152:155]
v_mov_b32 v230, v236
s_waitcnt vmcnt(7) lgkmcnt(5)
v_mfma_f32_16x16x32_bf16 v[128:131], v[208:211], v[120:123], v[128:131]
ds_read_b32 v204, v226 offset:192
v_mov_b32 v161, 0
v_mfma_f32_16x16x32_bf16 v[132:135], v[208:211], v[124:127], v[132:135]
v_mov_b32 v162, 0
v_mfma_f32_16x16x32_bf16 v[148:151], v[212:215], v[124:127], v[148:151]
v_mov_b32 v163, 0
v_mfma_f32_16x16x32_bf16 v[144:147], v[212:215], v[120:123], v[144:147]
buffer_load_dwordx4 v224, s[4:7], s34 offen offset:3072 sc1 lds
v_permlane16_swap_b32 v232, v229
v_permlane16_swap_b32 v236, v230
v_mov_b32 v160, v229
s_waitcnt lgkmcnt(4)
v_mfma_f32_16x16x32_bf16 v[136:139], v[216:219], v[120:123], v[136:139]
v_mfma_f32_16x16x32_bf16 v[140:143], v[216:219], v[124:127], v[140:143]
v_mfma_f32_16x16x32_bf16 v[156:159], v[220:223], v[124:127], v[156:159]
v_mfma_f32_16x16x32_bf16 v[152:155], v[220:223], v[120:123], v[152:155]
s_waitcnt lgkmcnt(2)
v_mfma_f32_16x16x32_bf16 v[128:131], v[192:195], v[232:235], v[128:131]
v_mfma_f32_16x16x32_bf16 v[132:135], v[192:195], v[160:163], v[132:135]
v_mfma_f32_16x16x32_bf16 v[148:151], v[196:199], v[160:163], v[148:151]
v_mfma_f32_16x16x32_bf16 v[144:147], v[196:199], v[232:235], v[144:147]
s_barrier
s_waitcnt lgkmcnt(0)
v_mfma_f32_16x16x32_bf16 v[136:139], v[200:203], v[232:235], v[136:139]
v_mfma_f32_16x16x32_bf16 v[140:143], v[200:203], v[160:163], v[140:143]
v_mfma_f32_16x16x32_bf16 v[156:159], v[204:207], v[160:163], v[156:159]
v_mfma_f32_16x16x32_bf16 v[152:155], v[204:207], v[232:235], v[152:155]
v_mov_b32 v220, -1
v_mov_b32 v221, -1
v_mov_b32 v222, -1
v_mov_b32_e64 v223, -1
s_lshl_b32 s30, s21, 9
s_add_u32 s30, s30, s47
s_add_u32 s30, s30, 32768
s_mov_b32 exec_hi, 0
buffer_store_dwordx4 v[220:223], v224, s[4:7], s30 offen sc1
s_lshl_b32 s30, s21, 6
s_add_u32 s30, s30, s48
s_add_u32 s30, s30, 4096
s_mov_b32 exec_lo, 15
buffer_store_dwordx4 v[220:223], v224, s[4:7], s30 offen sc1
s_mov_b64 exec, -1
s_lshl_b32 s30, s21, 9
s_add_u32 s35, s30, s47
s_lshl_b32 s31, s21, 6
s_add_u32 s31, s31, s48
s_and_b32 s32, s30, 0x1c00
v_cvt_pk_bf16_f32 v192, v128, v129
v_cvt_pk_bf16_f32 v193, v130, v131
v_cvt_pk_bf16_f32 v194, v132, v133
v_cvt_pk_bf16_f32 v195, v134, v135
v_cvt_pk_bf16_f32 v196, v136, v137
v_cvt_pk_bf16_f32 v197, v138, v139
s_add_u32 m0, s41, 98304
s_add_u32 s34, s36, 98304
buffer_load_dwordx4 v224, s[4:7], s34 offen offset:0 sc1 lds
v_cvt_pk_bf16_f32 v198, v140, v141
v_cvt_pk_bf16_f32 v199, v142, v143
v_permlane16_swap_b32 v192, v194
v_permlane16_swap_b32 v193, v195
v_permlane16_swap_b32 v196, v198
v_permlane16_swap_b32 v197, v199
v_mfma_f32_32x32x16_bf16 v[160:175], a[240:243], v[192:195], 0
s_nop 0
v_mfma_f32_32x32x16_bf16 v[176:191], a[244:247], v[196:199], 0
v_mul_f32 v144, v236, v144
v_mul_f32 v145, v236, v145
v_mul_f32 v146, v236, v146
v_mul_f32 v147, v236, v147
v_mul_f32 v148, v230, v148
v_mul_f32 v149, v230, v149
v_mul_f32 v150, v230, v150
v_mul_f32 v151, v230, v151
buffer_load_dwordx4 v224, s[4:7], s34 offen offset:1024 sc1 lds
v_mul_f32 v152, v236, v152
v_mul_f32 v153, v236, v153
v_mul_f32 v154, v236, v154
v_mul_f32 v155, v236, v155
v_mul_f32 v156, v230, v156
v_mul_f32 v157, v230, v157
v_mul_f32_e64 v158, v230, v158
v_mul_f32 v159, v230, v159
v_cvt_pk_bf16_f32 v200, v144, v145
v_cvt_pk_bf16_f32 v201, v146, v147
v_cvt_pk_bf16_f32 v202, v148, v149
v_cvt_pk_bf16_f32 v203, v150, v151
v_cvt_pk_bf16_f32 v204, v152, v153
v_cvt_pk_bf16_f32 v205, v154, v155
v_cvt_pk_bf16_f32 v206, v156, v157
v_cvt_pk_bf16_f32 v207, v158, v159
buffer_load_dwordx4 v224, s[4:7], s34 offen offset:2048 sc1 lds
v_permlane16_swap_b32 v200, v202
v_permlane16_swap_b32 v201, v203
v_permlane16_swap_b32 v204, v206
v_permlane16_swap_b32 v205, v207
ds_write_b128 v246, v[200:203] offset:17408
ds_write_b128 v246, v[204:207] offset:21760
v_max3_f32 v208, v160, v161, v162
v_max3_f32 v216, v176, v177, v178
v_max3_f32 v209, v163, v164, v165
v_max3_f32 v217, v179, v180, v181
v_max3_f32 v210, v166, v167, v168
v_max3_f32 v218, v182, v183, v184
v_max3_f32 v211, v169, v170, v171
v_max3_f32 v219, v185, v186, v187
v_max3_f32 v212, v172, v173, v174
v_max3_f32 v220, v188, v189, v190
buffer_load_dwordx4 v224, s[4:7], s34 offen offset:3072 sc1 lds
v_max3_f32 v208, v208, v209, v175
v_max3_f32 v216, v216, v217, v191
v_max3_f32 v210, v210, v211, v212
v_max3_f32 v218, v218, v219, v220
v_max_f32 v208, v208, v210
v_max_f32 v216, v216, v218
v_mul_f32 v208, v208, v238
v_mul_f32 v216, v216, v238
v_pk_fma_f32 v[160:161], v[160:161], v[238:239], v[208:209] op_sel_hi:[1,0,0] neg_lo:[0,0,1] neg_hi:[0,0,1]
v_pk_fma_f32 v[176:177], v[176:177], v[238:239], v[216:217] op_sel_hi:[1,0,0] neg_lo:[0,0,1] neg_hi:[0,0,1]
v_pk_fma_f32 v[162:163], v[162:163], v[238:239], v[208:209] op_sel_hi:[1,0,0] neg_lo:[0,0,1] neg_hi:[0,0,1]
v_pk_fma_f32 v[178:179], v[178:179], v[238:239], v[216:217] op_sel_hi:[1,0,0] neg_lo:[0,0,1] neg_hi:[0,0,1]
v_pk_fma_f32 v[164:165], v[164:165], v[238:239], v[208:209] op_sel_hi:[1,0,0] neg_lo:[0,0,1] neg_hi:[0,0,1]
v_pk_fma_f32 v[180:181], v[180:181], v[238:239], v[216:217] op_sel_hi:[1,0,0] neg_lo:[0,0,1] neg_hi:[0,0,1]
v_pk_fma_f32 v[166:167], v[166:167], v[238:239], v[208:209] op_sel_hi:[1,0,0] neg_lo:[0,0,1] neg_hi:[0,0,1]
v_pk_fma_f32 v[182:183], v[182:183], v[238:239], v[216:217] op_sel_hi:[1,0,0] neg_lo:[0,0,1] neg_hi:[0,0,1]
s_add_u32 m0, s41, 114688
s_add_u32 s34, s36, 114688
buffer_load_dwordx4 v224, s[4:7], s34 offen offset:0 sc1 lds
v_pk_fma_f32 v[168:169], v[168:169], v[238:239], v[208:209] op_sel_hi:[1,0,0] neg_lo:[0,0,1] neg_hi:[0,0,1]
v_pk_fma_f32 v[184:185], v[184:185], v[238:239], v[216:217] op_sel_hi:[1,0,0] neg_lo:[0,0,1] neg_hi:[0,0,1]
v_pk_fma_f32 v[170:171], v[170:171], v[238:239], v[208:209] op_sel_hi:[1,0,0] neg_lo:[0,0,1] neg_hi:[0,0,1]
v_pk_fma_f32 v[186:187], v[186:187], v[238:239], v[216:217] op_sel_hi:[1,0,0] neg_lo:[0,0,1] neg_hi:[0,0,1]
v_pk_fma_f32 v[172:173], v[172:173], v[238:239], v[208:209] op_sel_hi:[1,0,0] neg_lo:[0,0,1] neg_hi:[0,0,1]
v_pk_fma_f32 v[188:189], v[188:189], v[238:239], v[216:217] op_sel_hi:[1,0,0] neg_lo:[0,0,1] neg_hi:[0,0,1]
v_pk_fma_f32 v[174:175], v[174:175], v[238:239], v[208:209] op_sel_hi:[1,0,0] neg_lo:[0,0,1] neg_hi:[0,0,1]
v_pk_fma_f32 v[190:191], v[190:191], v[238:239], v[216:217] op_sel_hi:[1,0,0] neg_lo:[0,0,1] neg_hi:[0,0,1]
v_exp_f32 v160, v160
v_exp_f32 v176, v176
v_exp_f32 v161, v161
v_exp_f32 v177, v177
v_exp_f32 v162, v162
v_exp_f32 v178, v178
v_exp_f32 v163, v163
v_exp_f32 v179, v179
buffer_load_dwordx4 v224, s[4:7], s34 offen offset:1024 sc1 lds
v_exp_f32 v164, v164
v_exp_f32 v180, v180
v_exp_f32 v165, v165
v_exp_f32 v181, v181
v_exp_f32 v166, v166
v_exp_f32 v182, v182
v_exp_f32 v167, v167
v_exp_f32 v183, v183
v_exp_f32 v168, v168
v_exp_f32 v184, v184
v_exp_f32 v169, v169
v_exp_f32 v185, v185
v_exp_f32 v170, v170
v_exp_f32 v186, v186
v_exp_f32 v171, v171
v_exp_f32 v187, v187
buffer_load_dwordx4 v224, s[4:7], s34 offen offset:2048 sc1 lds
v_exp_f32 v172, v172
v_exp_f32 v188, v188
v_exp_f32 v173, v173
v_exp_f32 v189, v189
v_exp_f32 v174, v174
v_exp_f32 v190, v190
v_exp_f32 v175, v175
v_exp_f32 v191, v191
v_pk_add_f32 v[208:209], v[160:161], v[162:163]
v_pk_add_f32 v[216:217], v[176:177], v[178:179]
v_pk_add_f32 v[210:211], v[164:165], v[166:167]
v_pk_add_f32 v[218:219], v[180:181], v[182:183]
v_pk_add_f32 v[212:213], v[168:169], v[170:171]
v_pk_add_f32 v[220:221], v[184:185], v[186:187]
v_pk_add_f32 v[214:215], v[172:173], v[174:175]
v_pk_add_f32 v[222:223], v[188:189], v[190:191]
buffer_load_dwordx4 v224, s[4:7], s34 offen offset:3072 sc1 lds
v_pk_add_f32 v[208:209], v[208:209], v[210:211]
v_pk_add_f32 v[216:217], v[216:217], v[218:219]
v_pk_add_f32 v[212:213], v[212:213], v[214:215]
v_pk_add_f32 v[220:221], v[220:221], v[222:223]
v_pk_add_f32 v[208:209], v[208:209], v[212:213]
v_pk_add_f32 v[216:217], v[216:217], v[220:221]
v_add_f32 v208, v208, v209
v_add_f32 v216, v216, v217
v_rcp_f32 v208, v208
v_rcp_f32 v216, v216
v_pk_mul_f32 v[160:161], v[160:161], v[208:209] op_sel_hi:[1,0]
v_pk_mul_f32 v[176:177], v[176:177], v[216:217] op_sel_hi:[1,0]
v_pk_mul_f32 v[162:163], v[162:163], v[208:209] op_sel_hi:[1,0]
v_pk_mul_f32 v[178:179], v[178:179], v[216:217] op_sel_hi:[1,0]
v_pk_mul_f32 v[164:165], v[164:165], v[208:209] op_sel_hi:[1,0]
v_pk_mul_f32 v[180:181], v[180:181], v[216:217] op_sel_hi:[1,0]
s_mov_b32 exec_lo, 65535
s_mov_b32 exec_hi, 0
buffer_load_dword v227, v239, s[4:7], s45 offen
s_mov_b64 exec, -1
v_pk_mul_f32 v[166:167], v[166:167], v[208:209] op_sel_hi:[1,0]
v_pk_mul_f32 v[182:183], v[182:183], v[216:217] op_sel_hi:[1,0]
v_pk_mul_f32 v[168:169], v[168:169], v[208:209] op_sel_hi:[1,0]
v_pk_mul_f32 v[184:185], v[184:185], v[216:217] op_sel_hi:[1,0]
v_pk_mul_f32 v[170:171], v[170:171], v[208:209] op_sel_hi:[1,0]
v_pk_mul_f32 v[186:187], v[186:187], v[216:217] op_sel_hi:[1,0]
v_pk_mul_f32 v[172:173], v[172:173], v[208:209] op_sel_hi:[1,0]
v_pk_mul_f32 v[188:189], v[188:189], v[216:217] op_sel_hi:[1,0]
v_pk_mul_f32 v[174:175], v[174:175], v[208:209] op_sel_hi:[1,0]
v_pk_mul_f32 v[190:191], v[190:191], v[216:217] op_sel_hi:[1,0]
v_cvt_pk_bf16_f32 v128, v160, v161
v_cvt_pk_bf16_f32 v136, v176, v177
v_cvt_pk_bf16_f32 v129, v162, v163
v_cvt_pk_bf16_f32 v137, v178, v179
v_cvt_pk_bf16_f32 v130, v164, v165
v_cvt_pk_bf16_f32 v138, v180, v181
v_cvt_pk_bf16_f32 v131, v166, v167
v_cvt_pk_bf16_f32 v139, v182, v183
ds_write_b128 v247, v[128:131] offset:0
ds_write_b128 v247, v[136:139] offset:8704
v_cvt_pk_bf16_f32 v132, v168, v169
v_cvt_pk_bf16_f32 v140, v184, v185
v_cvt_pk_bf16_f32 v133, v170, v171
v_cvt_pk_bf16_f32 v141, v186, v187
v_cvt_pk_bf16_f32 v134, v172, v173
v_cvt_pk_bf16_f32 v142, v188, v189
v_cvt_pk_bf16_f32 v135, v174, v175
v_cvt_pk_bf16_f32 v143, v190, v191
ds_write_b128 v247, v[132:135] offset:2176
ds_write_b128 v247, v[140:143] offset:10880
s_waitcnt vmcnt(9) lgkmcnt(0)
s_barrier
ds_read_b64_tr_b16 v[160:161], v248 offset:0
ds_read_b64_tr_b16 v[162:163], v248 offset:256
ds_read_b64_tr_b16 v[176:177], v249 offset:0
ds_read_b64_tr_b16 v[178:179], v249 offset:256
ds_read_b64_tr_b16 v[164:165], v248 offset:512
ds_read_b64_tr_b16 v[166:167], v248 offset:768
ds_read_b64_tr_b16 v[180:181], v249 offset:512
ds_read_b64_tr_b16 v[182:183], v249 offset:768
ds_read_b64_tr_b16 v[168:169], v248 offset:1024
ds_read_b64_tr_b16 v[170:171], v248 offset:1280
ds_read_b64_tr_b16 v[184:185], v249 offset:1024
ds_read_b64_tr_b16 v[186:187], v249 offset:1280
s_waitcnt lgkmcnt(8)
v_mfma_f32_16x16x32_bf16 v[148:151], v[160:163], v[250:253], 0
v_mfma_f32_16x16x32_bf16 v[144:147], v[160:163], v[176:179], 0
ds_read_b64_tr_b16 v[172:173], v248 offset:1536
ds_read_b64_tr_b16 v[174:175], v248 offset:1792
ds_read_b64_tr_b16 v[188:189], v249 offset:1536
ds_read_b64_tr_b16 v[190:191], v249 offset:1792
s_waitcnt lgkmcnt(8)
v_mfma_f32_16x16x32_bf16 v[148:151], v[164:167], v[250:253], v[148:151]
v_mfma_f32_16x16x32_bf16 v[144:147], v[164:167], v[180:183], v[144:147]
s_waitcnt lgkmcnt(4)
v_mfma_f32_16x16x32_bf16 v[148:151], v[168:171], v[250:253], v[148:151]
v_mfma_f32_16x16x32_bf16 v[144:147], v[168:171], v[184:187], v[144:147]
s_waitcnt lgkmcnt(0)
v_mfma_f32_16x16x32_bf16 v[148:151], v[172:175], v[250:253], v[148:151]
v_mfma_f32_16x16x32_bf16 v[144:147], v[172:175], v[188:191], v[144:147]
ds_read_b128 v[208:211], v225 offset:0
ds_read_b128 v[212:215], v225 offset:1024
ds_read_b128 v[216:219], v225 offset:2048
ds_read_b128 v[220:223], v225 offset:3072
ds_read_b128 v[192:195], v225 offset:4096
ds_read_b128 v[196:199], v225 offset:5120
ds_read_b128 v[200:203], v225 offset:6144
v_min_u32 v148, -2, v148
v_cvt_pk_bf16_f32 v152, v144, v145
v_cvt_pk_bf16_f32 v153, v146, v147
v_min_u32 v152, -2, v152
buffer_store_dwordx2 v[152:153], v254, s[4:7], s35 offen sc1
s_mov_b32 exec_lo, 0x00010001
s_mov_b32 exec_hi, 0x00010001
buffer_store_dwordx4 v[148:151], v255, s[4:7], s31 offen sc1
s_mov_b64 exec, -1
s_waitcnt lgkmcnt(4)
v_mfma_f32_16x16x32_bf16 v[128:131], v[208:211], v[0:3], 0
ds_read_b128 v[204:207], v225 offset:7168
v_bfe_u32 v246, v240, 3, 1
v_mfma_f32_16x16x32_bf16 v[132:135], v[208:211], v[4:7], 0
v_bfe_u32 v247, v240, 4, 1
v_and_b32 v248, 16, v224
v_mfma_f32_16x16x32_bf16 v[140:143], v[212:215], v[4:7], 0
ds_read_b128 v[208:211], v225 offset:8192
s_add_u32 m0, s41, 32768
v_mfma_f32_16x16x32_bf16 v[136:139], v[212:215], v[0:3], 0
s_add_u32 s34, s36, 131072
v_mov_b32 v249, 0x3f80
v_mfma_f32_16x16x32_bf16 v[128:131], v[216:219], v[8:11], v[128:131]
ds_read_b128 v[212:215], v225 offset:9216
v_cmp_eq_u32 vcc, v246, v247
v_mfma_f32_16x16x32_bf16 v[132:135], v[216:219], v[12:15], v[132:135]
v_lshlrev_b32 v248, v248, v249
s_waitcnt lgkmcnt(4)
v_mfma_f32_16x16x32_bf16 v[140:143], v[220:223], v[12:15], v[140:143]
ds_read_b128 v[216:219], v225 offset:10240
v_bfe_u32 v249, v240, 1, 2
v_mfma_f32_16x16x32_bf16 v[136:139], v[220:223], v[8:11], v[136:139]
buffer_load_dwordx4 v224, s[4:7], s34 offen offset:0 sc1 lds
v_mfma_f32_16x16x32_bf16 v[128:131], v[192:195], v[16:19], v[128:131]
ds_read_b128 v[220:223], v225 offset:11264
v_cndmask_b32 v248, 0, v248, vcc
v_mfma_f32_16x16x32_bf16 v[132:135], v[192:195], v[20:23], v[132:135]
v_cmp_eq_u32 vcc, 0, v249
v_and_b32 v246, 15, v240
v_mfma_f32_16x16x32_bf16 v[140:143], v[196:199], v[20:23], v[140:143]
ds_read_b128 v[192:195], v225 offset:12288
v_lshl_add_u32 v255, v246, 6, v255
v_mfma_f32_16x16x32_bf16 v[136:139], v[196:199], v[16:19], v[136:139]
v_cndmask_b32 v250, 0, v248, vcc
s_waitcnt lgkmcnt(4)
v_mfma_f32_16x16x32_bf16 v[128:131], v[200:203], v[24:27], v[128:131]
ds_read_b128 v[196:199], v225 offset:13312
v_cmp_eq_u32 vcc, 1, v249
v_mfma_f32_16x16x32_bf16 v[132:135], v[200:203], v[28:31], v[132:135]
buffer_load_dwordx4 v224, s[4:7], s34 offen offset:1024 sc1 lds
v_mfma_f32_16x16x32_bf16 v[140:143], v[204:207], v[28:31], v[140:143]
ds_read_b128 v[200:203], v225 offset:14336
v_bfe_u32 v247, v240, 2, 1
v_mfma_f32_16x16x32_bf16 v[136:139], v[204:207], v[24:27], v[136:139]
v_and_b32 v246, 3, v240
v_cndmask_b32 v251, 0, v248, vcc
v_mfma_f32_16x16x32_bf16 v[128:131], v[208:211], v[32:35], v[128:131]
ds_read_b128 v[204:207], v225 offset:15360
v_cmp_eq_u32 vcc, 2, v249
v_mfma_f32_16x16x32_bf16 v[132:135], v[208:211], v[36:39], v[132:135]
v_lshl_add_u32 v246, v247, 3, v246
s_waitcnt lgkmcnt(4)
v_mfma_f32_16x16x32_bf16 v[140:143], v[212:215], v[36:39], v[140:143]
ds_read_b128 v[208:211], v225 offset:16384
v_bfe_u32 v247, v240, 3, 1
v_mfma_f32_16x16x32_bf16 v[136:139], v[212:215], v[32:35], v[136:139]
v_cndmask_b32 v252, 0, v248, vcc
v_cmp_eq_u32 vcc, 3, v249
v_mfma_f32_16x16x32_bf16 v[128:131], v[216:219], v[40:43], v[128:131]
ds_read_b128 v[212:215], v225 offset:17408
v_lshl_add_u32 v246, v247, 2, v246
v_mfma_f32_16x16x32_bf16 v[132:135], v[216:219], v[44:47], v[132:135]
buffer_load_dwordx4 v224, s[4:7], s34 offen offset:2048 sc1 lds
v_mfma_f32_16x16x32_bf16 v[140:143], v[220:223], v[44:47], v[140:143]
ds_read_b128 v[216:219], v225 offset:18432
v_lshlrev_b32 v246, 4, v246
v_mfma_f32_16x16x32_bf16 v[136:139], v[220:223], v[40:43], v[136:139]
v_cndmask_b32 v253, 0, v248, vcc
s_waitcnt lgkmcnt(4)
v_mfma_f32_16x16x32_bf16 v[128:131], v[192:195], v[48:51], v[128:131]
ds_read_b128 v[220:223], v225 offset:19456
v_bfe_u32 v247, v240, 4, 1
v_mfma_f32_16x16x32_bf16 v[132:135], v[192:195], v[52:55], v[132:135]
v_lshl_add_u32 v246, v247, 3, v246
v_lshrrev_b32 v247, 5, v240
v_mfma_f32_16x16x32_bf16 v[140:143], v[196:199], v[52:55], v[140:143]
ds_read_b128 v[192:195], v225 offset:20480
v_lshl_add_u32 v246, v247, 10, v246
v_mfma_f32_16x16x32_bf16 v[136:139], v[196:199], v[48:51], v[136:139]
s_lshr_b32 s30, s20, 1
s_lshl_b32 s30, s30, 11
v_mfma_f32_16x16x32_bf16 v[128:131], v[200:203], v[56:59], v[128:131]
ds_read_b128 v[196:199], v225 offset:21504
s_and_b32 s31, s20, 1
v_mfma_f32_16x16x32_bf16 v[132:135], v[200:203], v[60:63], v[132:135]
s_lshl_b32 s31, s31, 9
s_waitcnt lgkmcnt(4)
v_mfma_f32_16x16x32_bf16 v[140:143], v[204:207], v[60:63], v[140:143]
ds_read_b128 v[200:203], v225 offset:22528
s_add_u32 s30, s30, s31
v_mfma_f32_16x16x32_bf16 v[136:139], v[204:207], v[56:59], v[136:139]
buffer_load_dwordx4 v224, s[4:7], s34 offen offset:3072 sc1 lds
v_mfma_f32_16x16x32_bf16 v[128:131], v[208:211], v[64:67], v[128:131]
s_branch L_SK1
L_ST1:
s_setpc_b64 s[10:11]
L_SK1:
ds_read_b128 v[204:207], v225 offset:23552
s_add_u32 s30, s30, 157184
v_mfma_f32_16x16x32_bf16 v[132:135], v[208:211], v[68:71], v[132:135]
v_add_u32 v246, s30, v246
v_add_u32 v247, 65536, v225
v_mfma_f32_16x16x32_bf16 v[140:143], v[212:215], v[68:71], v[140:143]
ds_read_b128 v[208:211], v225 offset:24576
s_add_u32 s33, s32, 1024
v_mfma_f32_16x16x32_bf16 v[136:139], v[212:215], v[64:67], v[136:139]
s_and_b32 s33, s33, 0x1c00
s_waitcnt lgkmcnt(4)
v_mfma_f32_16x16x32_bf16 v[128:131], v[216:219], v[72:75], v[128:131]
ds_read_b128 v[212:215], v225 offset:25600
s_add_u32 s33, s33, s47
v_mfma_f32_16x16x32_bf16 v[132:135], v[216:219], v[76:79], v[132:135]
buffer_load_dwordx4 v[0:3], v224, s[4:7], s33 offen sc1
v_mfma_f32_16x16x32_bf16 v[140:143], v[220:223], v[76:79], v[140:143]
ds_read_b128 v[216:219], v225 offset:26624
s_add_u32 s33, s32, 2048
v_mfma_f32_16x16x32_bf16 v[136:139], v[220:223], v[72:75], v[136:139]
s_and_b32 s33, s33, 0x1c00
s_add_u32 m0, s41, 49152
v_mfma_f32_16x16x32_bf16 v[128:131], v[192:195], v[80:83], v[128:131]
ds_read_b128 v[220:223], v225 offset:27648
s_add_u32 s33, s33, s47
v_mfma_f32_16x16x32_bf16 v[132:135], v[192:195], v[84:87], v[132:135]
s_add_u32 s34, s36, 147456
buffer_load_dwordx4 v224, s[4:7], s34 offen offset:0 sc1 lds
s_waitcnt lgkmcnt(4)
v_mfma_f32_16x16x32_bf16 v[140:143], v[196:199], v[84:87], v[140:143]
ds_read_b128 v[192:195], v225 offset:28672
s_add_u32 s53, s25, 0
v_mfma_f32_16x16x32_bf16 v[136:139], v[196:199], v[80:83], v[136:139]
buffer_load_dwordx4 v[4:7], v224, s[4:7], s33 offen sc1
v_mfma_f32_16x16x32_bf16 v[128:131], v[200:203], v[88:91], v[128:131]
ds_read_b128 v[196:199], v225 offset:29696
s_add_u32 s33, s32, 3072
v_mfma_f32_16x16x32_bf16 v[132:135], v[200:203], v[92:95], v[132:135]
s_and_b32 s33, s33, 0x1c00
v_mov_b32 v228, s53
v_mfma_f32_16x16x32_bf16 v[140:143], v[204:207], v[92:95], v[140:143]
ds_read_b128 v[200:203], v225 offset:30720
s_add_u32 s33, s33, s47
v_mfma_f32_16x16x32_bf16 v[136:139], v[204:207], v[88:91], v[136:139]
v_mov_b32 v160, v229
s_waitcnt lgkmcnt(4)
v_mfma_f32_16x16x32_bf16 v[128:131], v[208:211], v[96:99], v[128:131]
ds_read_b128 v[204:207], v225 offset:31744
v_mov_b32 v161, 0
v_mfma_f32_16x16x32_bf16 v[132:135], v[208:211], v[100:103], v[132:135]
buffer_load_dwordx4 v[8:11], v224, s[4:7], s33 offen sc1
v_mov_b32 v162, 0
v_mov_b32 v163, 0
v_mfma_f32_16x16x32_bf16 v[140:143], v[212:215], v[100:103], v[140:143]
ds_read_b32 v208, v226 offset:256
s_add_u32 s33, s32, 4096
v_mfma_f32_16x16x32_bf16 v[136:139], v[212:215], v[96:99], v[136:139]
s_and_b32 s33, s33, 0x1c00
s_add_u32 s33, s33, s47
v_mfma_f32_16x16x32_bf16 v[128:131], v[216:219], v[104:107], v[128:131]
ds_read_b32 v212, v226 offset:320
v_mfma_f32_16x16x32_bf16 v[132:135], v[216:219], v[108:111], v[132:135]
buffer_load_dwordx4 v[12:15], v224, s[4:7], s33 offen sc1
s_waitcnt lgkmcnt(4)
v_mfma_f32_16x16x32_bf16 v[140:143], v[220:223], v[108:111], v[140:143]
s_add_u32 s33, s32, 5120
s_and_b32 s33, s33, 0x1c00
v_mfma_f32_16x16x32_bf16 v[136:139], v[220:223], v[104:107], v[136:139]
s_add_u32 s33, s33, s47
v_mfma_f32_16x16x32_bf16 v[128:131], v[192:195], v[112:115], v[128:131]
buffer_load_dwordx4 v[16:19], v224, s[4:7], s33 offen sc1
v_mfma_f32_16x16x32_bf16 v[132:135], v[192:195], v[116:119], v[132:135]
s_add_u32 s33, s32, 6144
s_and_b32 s33, s33, 0x1c00
v_mfma_f32_16x16x32_bf16 v[140:143], v[196:199], v[116:119], v[140:143]
s_add_u32 s33, s33, s47
v_mfma_f32_16x16x32_bf16 v[136:139], v[196:199], v[112:115], v[136:139]
s_waitcnt lgkmcnt(1)
v_mfma_f32_16x16x32_bf16 v[128:131], v[200:203], v[120:123], v[128:131]
buffer_load_dwordx4 v[20:23], v224, s[4:7], s33 offen sc1
v_mfma_f32_16x16x32_bf16 v[132:135], v[200:203], v[124:127], v[132:135]
s_add_u32 s33, s32, 7168
s_and_b32 s33, s33, 0x1c00
v_mfma_f32_16x16x32_bf16 v[140:143], v[204:207], v[124:127], v[140:143]
s_add_u32 s33, s33, s47
v_mfma_f32_16x16x32_bf16 v[136:139], v[204:207], v[120:123], v[136:139]
buffer_load_dwordx4 v[24:27], v224, s[4:7], s33 offen sc1
v_mfma_f32_16x16x32_bf16 v[128:131], v[208:211], v[232:235], v[128:131]
buffer_load_dwordx4 v[32:35], v255, s[4:7], s48 offen sc1
v_mfma_f32_16x16x32_bf16 v[132:135], v[208:211], v[160:163], v[132:135]
s_waitcnt lgkmcnt(0)
v_mfma_f32_16x16x32_bf16 v[140:143], v[212:215], v[160:163], v[140:143]
v_mfma_f32_16x16x32_bf16 v[136:139], v[212:215], v[232:235], v[136:139]
s_add_u32 s33, s32, 8192
s_and_b32 s33, s33, 0x1c00
s_add_u32 s33, s33, s47
buffer_load_dwordx4 v[28:31], v224, s[4:7], s33 offen sc1
v_cvt_pk_bf16_f32 v192, v128, v129
v_cvt_pk_bf16_f32 v193, v130, v131
v_cvt_pk_bf16_f32 v194, v132, v133
v_cvt_pk_bf16_f32 v195, v134, v135
v_cvt_pk_bf16_f32 v196, v136, v137
v_cvt_pk_bf16_f32 v197, v138, v139
v_cvt_pk_bf16_f32 v198, v140, v141
v_cvt_pk_bf16_f32 v199, v142, v143
v_permlane16_swap_b32 v192, v194
v_permlane16_swap_b32 v193, v195
v_permlane16_swap_b32 v196, v198
v_permlane16_swap_b32 v197, v199
v_mfma_f32_32x32x16_bf16 v[160:175], a[240:243], v[192:195], 0
s_nop 0
v_mfma_f32_32x32x16_bf16 v[176:191], a[244:247], v[196:199], 0
s_nop 9
v_max3_f32 v208, v160, v161, v162
s_nop 0
v_max3_f32 v216, v176, v177, v178
v_max3_f32 v209, v163, v164, v165
v_max3_f32 v217, v179, v180, v181
v_max3_f32 v210, v166, v167, v168
v_max3_f32 v218, v182, v183, v184
v_max3_f32 v211, v169, v170, v171
v_max3_f32 v219, v185, v186, v187
v_max3_f32 v212, v172, v173, v174
v_max3_f32 v220, v188, v189, v190
v_max3_f32 v208, v208, v209, v175
v_max3_f32 v216, v216, v217, v191
v_max3_f32 v210, v210, v211, v212
v_max3_f32 v218, v218, v219, v220
v_max_f32 v208, v208, v210
v_max_f32 v216, v216, v218
v_mul_f32 v208, v208, v238
v_mul_f32 v216, v216, v238
v_pk_fma_f32 v[160:161], v[160:161], v[238:239], v[208:209] op_sel_hi:[1,0,0] neg_lo:[0,0,1] neg_hi:[0,0,1]
v_pk_fma_f32 v[176:177], v[176:177], v[238:239], v[216:217] op_sel_hi:[1,0,0] neg_lo:[0,0,1] neg_hi:[0,0,1]
v_pk_fma_f32 v[162:163], v[162:163], v[238:239], v[208:209] op_sel_hi:[1,0,0] neg_lo:[0,0,1] neg_hi:[0,0,1]
v_pk_fma_f32 v[178:179], v[178:179], v[238:239], v[216:217] op_sel_hi:[1,0,0] neg_lo:[0,0,1] neg_hi:[0,0,1]
v_pk_fma_f32 v[164:165], v[164:165], v[238:239], v[208:209] op_sel_hi:[1,0,0] neg_lo:[0,0,1] neg_hi:[0,0,1]
v_pk_fma_f32 v[180:181], v[180:181], v[238:239], v[216:217] op_sel_hi:[1,0,0] neg_lo:[0,0,1] neg_hi:[0,0,1]
v_pk_fma_f32 v[166:167], v[166:167], v[238:239], v[208:209] op_sel_hi:[1,0,0] neg_lo:[0,0,1] neg_hi:[0,0,1]
v_pk_fma_f32 v[182:183], v[182:183], v[238:239], v[216:217] op_sel_hi:[1,0,0] neg_lo:[0,0,1] neg_hi:[0,0,1]
v_pk_fma_f32 v[168:169], v[168:169], v[238:239], v[208:209] op_sel_hi:[1,0,0] neg_lo:[0,0,1] neg_hi:[0,0,1]
v_pk_fma_f32 v[184:185], v[184:185], v[238:239], v[216:217] op_sel_hi:[1,0,0] neg_lo:[0,0,1] neg_hi:[0,0,1]
v_pk_fma_f32 v[170:171], v[170:171], v[238:239], v[208:209] op_sel_hi:[1,0,0] neg_lo:[0,0,1] neg_hi:[0,0,1]
v_pk_fma_f32 v[186:187], v[186:187], v[238:239], v[216:217] op_sel_hi:[1,0,0] neg_lo:[0,0,1] neg_hi:[0,0,1]
v_pk_fma_f32 v[172:173], v[172:173], v[238:239], v[208:209] op_sel_hi:[1,0,0] neg_lo:[0,0,1] neg_hi:[0,0,1]
v_pk_fma_f32 v[188:189], v[188:189], v[238:239], v[216:217] op_sel_hi:[1,0,0] neg_lo:[0,0,1] neg_hi:[0,0,1]
v_pk_fma_f32 v[174:175], v[174:175], v[238:239], v[208:209] op_sel_hi:[1,0,0] neg_lo:[0,0,1] neg_hi:[0,0,1]
v_pk_fma_f32 v[190:191], v[190:191], v[238:239], v[216:217] op_sel_hi:[1,0,0] neg_lo:[0,0,1] neg_hi:[0,0,1]
v_exp_f32 v160, v160
v_exp_f32 v176, v176
v_exp_f32 v161, v161
v_exp_f32 v177, v177
v_exp_f32 v162, v162
v_exp_f32 v178, v178
v_exp_f32 v163, v163
v_exp_f32 v179, v179
v_exp_f32 v164, v164
v_exp_f32 v180, v180
v_exp_f32 v165, v165
v_exp_f32 v181, v181
v_exp_f32 v166, v166
v_exp_f32 v182, v182
v_exp_f32 v167, v167
v_exp_f32 v183, v183
v_exp_f32 v168, v168
v_exp_f32 v184, v184
v_exp_f32 v169, v169
v_exp_f32 v185, v185
v_exp_f32 v170, v170
v_exp_f32 v186, v186
v_exp_f32 v171, v171
v_exp_f32 v187, v187
v_exp_f32 v172, v172
v_exp_f32 v188, v188
v_exp_f32 v173, v173
v_exp_f32 v189, v189
v_exp_f32 v174, v174
v_exp_f32 v190, v190
v_exp_f32 v175, v175
v_exp_f32 v191, v191
v_pk_add_f32 v[208:209], v[160:161], v[162:163]
v_pk_add_f32 v[216:217], v[176:177], v[178:179]
v_pk_add_f32 v[210:211], v[164:165], v[166:167]
v_pk_add_f32 v[218:219], v[180:181], v[182:183]
v_pk_add_f32 v[212:213], v[168:169], v[170:171]
v_pk_add_f32 v[220:221], v[184:185], v[186:187]
v_pk_add_f32 v[214:215], v[172:173], v[174:175]
v_pk_add_f32 v[222:223], v[188:189], v[190:191]
v_pk_add_f32 v[208:209], v[208:209], v[210:211]
v_pk_add_f32 v[216:217], v[216:217], v[218:219]
v_pk_add_f32 v[212:213], v[212:213], v[214:215]
v_pk_add_f32 v[220:221], v[220:221], v[222:223]
v_pk_add_f32 v[208:209], v[208:209], v[212:213]
v_pk_add_f32 v[216:217], v[216:217], v[220:221]
v_add_f32 v208, v208, v209
v_add_f32 v216, v216, v217
v_rcp_f32 v208, v208
v_rcp_f32 v216, v216
v_pk_mul_f32 v[160:161], v[160:161], v[208:209] op_sel_hi:[1,0]
v_pk_mul_f32 v[176:177], v[176:177], v[216:217] op_sel_hi:[1,0]
v_pk_mul_f32 v[162:163], v[162:163], v[208:209] op_sel_hi:[1,0]
v_pk_mul_f32 v[178:179], v[178:179], v[216:217] op_sel_hi:[1,0]
v_pk_mul_f32 v[164:165], v[164:165], v[208:209] op_sel_hi:[1,0]
v_pk_mul_f32 v[180:181], v[180:181], v[216:217] op_sel_hi:[1,0]
v_pk_mul_f32 v[166:167], v[166:167], v[208:209] op_sel_hi:[1,0]
v_pk_mul_f32 v[182:183], v[182:183], v[216:217] op_sel_hi:[1,0]
v_pk_mul_f32 v[168:169], v[168:169], v[208:209] op_sel_hi:[1,0]
v_pk_mul_f32 v[184:185], v[184:185], v[216:217] op_sel_hi:[1,0]
v_pk_mul_f32 v[170:171], v[170:171], v[208:209] op_sel_hi:[1,0]
v_pk_mul_f32 v[186:187], v[186:187], v[216:217] op_sel_hi:[1,0]
v_pk_mul_f32 v[172:173], v[172:173], v[208:209] op_sel_hi:[1,0]
v_pk_mul_f32 v[188:189], v[188:189], v[216:217] op_sel_hi:[1,0]
v_pk_mul_f32 v[174:175], v[174:175], v[208:209] op_sel_hi:[1,0]
v_pk_mul_f32 v[190:191], v[190:191], v[216:217] op_sel_hi:[1,0]
v_cvt_pk_bf16_f32 v128, v160, v161
v_cvt_pk_bf16_f32 v136, v176, v177
v_cvt_pk_bf16_f32 v129, v162, v163
v_cvt_pk_bf16_f32 v137, v178, v179
v_cvt_pk_bf16_f32 v130, v164, v165
v_cvt_pk_bf16_f32 v138, v180, v181
v_cvt_pk_bf16_f32 v131, v166, v167
v_cvt_pk_bf16_f32 v139, v182, v183
v_cvt_pk_bf16_f32 v132, v168, v169
v_cvt_pk_bf16_f32 v140, v184, v185
v_cvt_pk_bf16_f32 v133, v170, v171
v_cvt_pk_bf16_f32 v141, v186, v187
v_cvt_pk_bf16_f32 v134, v172, v173
v_cvt_pk_bf16_f32 v142, v188, v189
v_cvt_pk_bf16_f32 v135, v174, v175
v_cvt_pk_bf16_f32 v143, v190, v191
GJ_2:
s_waitcnt vmcnt(9)
v_mfma_f32_16x16x32_bf16 v[56:59], v[250:253], v[0:3], 0
v_max_u32_e64 v40, v0, v2
s_waitcnt vmcnt(7)
v_mfma_f32_16x16x32_bf16 v[56:59], v[250:253], v[4:7], v[56:59]
v_max3_u32 v40, v40, v4, v6
s_waitcnt vmcnt(6)
v_mfma_f32_16x16x32_bf16 v[56:59], v[250:253], v[8:11], v[56:59]
v_max3_u32 v40, v40, v8, v10
s_waitcnt vmcnt(5)
v_mfma_f32_16x16x32_bf16 v[56:59], v[250:253], v[12:15], v[56:59]
v_max3_u32 v40, v40, v12, v14
s_waitcnt vmcnt(4)
v_mfma_f32_16x16x32_bf16 v[56:59], v[250:253], v[16:19], v[56:59]
v_max3_u32 v40, v40, v16, v18
s_waitcnt vmcnt(3)
v_mfma_f32_16x16x32_bf16 v[56:59], v[250:253], v[20:23], v[56:59]
v_max3_u32 v40, v40, v20, v22
s_waitcnt vmcnt(2)
v_mfma_f32_16x16x32_bf16 v[56:59], v[250:253], v[24:27], v[56:59]
v_max3_u32 v40, v40, v24, v26
s_waitcnt vmcnt(1)
v_add_f32_dpp v36, v32, v32 row_ror:8 row_mask:0xf bank_mask:0xf
v_add_f32_dpp v37, v33, v33 row_ror:8 row_mask:0xf bank_mask:0xf
v_add_f32_dpp v38, v34, v34 row_ror:8 row_mask:0xf bank_mask:0xf
v_add_f32_dpp v39, v35, v35 row_ror:8 row_mask:0xf bank_mask:0xf
v_add_f32_dpp v36, v36, v36 row_ror:4 row_mask:0xf bank_mask:0xf
v_add_f32_dpp v37, v37, v37 row_ror:4 row_mask:0xf bank_mask:0xf
v_add_f32_dpp v38, v38, v38 row_ror:4 row_mask:0xf bank_mask:0xf
v_add_f32_dpp v39, v39, v39 row_ror:4 row_mask:0xf bank_mask:0xf
v_add_f32_dpp v36, v36, v36 row_ror:2 row_mask:0xf bank_mask:0xf
v_add_f32_dpp v37, v37, v37 row_ror:2 row_mask:0xf bank_mask:0xf
v_add_f32_dpp v38, v38, v38 row_ror:2 row_mask:0xf bank_mask:0xf
v_add_f32_dpp v39, v39, v39 row_ror:2 row_mask:0xf bank_mask:0xf
v_add_f32_dpp v36, v36, v36 row_ror:1 row_mask:0xf bank_mask:0xf
v_add_f32_dpp v37, v37, v37 row_ror:1 row_mask:0xf bank_mask:0xf
v_add_f32_dpp v38, v38, v38 row_ror:1 row_mask:0xf bank_mask:0xf
v_add_f32_dpp v39, v39, v39 row_ror:1 row_mask:0xf bank_mask:0xf
v_max_u32 v40, v40, v32
v_cvt_pk_bf16_f32 v44, v36, v37
v_cvt_pk_bf16_f32 v45, v38, v39
s_waitcnt vmcnt(0)
v_mfma_f32_16x16x32_bf16 v[56:59], v[250:253], v[28:31], v[56:59]
v_max3_u32 v40, v40, v28, v30
v_cmp_eq_u32 vcc, -1, v40
s_cbranch_vccnz GR_1
GK_3:
ds_write_b64 v246, v[44:45] offset:256
s_nop 3
v_cvt_pk_bf16_f32 v42, v56, v57
v_cvt_pk_bf16_f32 v43, v58, v59
ds_write_b64 v246, v[42:43]
s_add_u32 s47, s47, 32768
s_add_u32 s48, s48, 4096
s_waitcnt lgkmcnt(0)
s_barrier
ds_read_b128 v[0:3], v247 offset:26112
ds_read_b128 v[4:7], v247 offset:27136
ds_read_b128 v[8:11], v247 offset:28160
ds_read_b128 v[12:15], v247 offset:29184
s_waitcnt lgkmcnt(3)
v_mfma_f32_32x32x16_bf16 v[160:175], v[0:3], v[128:131], 0
s_waitcnt lgkmcnt(2)
v_mfma_f32_32x32x16_bf16 v[160:175], v[4:7], v[132:135], v[160:175]
s_waitcnt lgkmcnt(1)
v_mfma_f32_32x32x16_bf16 v[176:191], v[8:11], v[136:139], 0
s_waitcnt lgkmcnt(0)
v_mfma_f32_32x32x16_bf16 v[176:191], v[12:15], v[140:143], v[176:191]
v_xor_b32 v247, 2048, v242
v_xor_b32 v248, 4096, v242
v_xor_b32 v249, 6144, v242
v_accvgpr_read_b32 v217, a248
v_accvgpr_read_b32 v219, a249
v_accvgpr_read_b32 v221, a250
v_accvgpr_read_b32 v223, a251
v_lshlrev_b32 v216, 16, v217
v_and_b32 v217, 0xffff0000, v217
v_add_f32 v168, 0x358637bd, v168
v_rcp_f32 v168, v168
s_nop 0
v_pk_mul_f32 v[160:161], v[160:161], v[168:169] op_sel_hi:[1,0]
v_pk_mul_f32 v[162:163], v[162:163], v[168:169] op_sel_hi:[1,0]
v_pk_mul_f32 v[164:165], v[164:165], v[168:169] op_sel_hi:[1,0]
v_pk_mul_f32 v[166:167], v[166:167], v[168:169] op_sel_hi:[1,0]
v_cvt_pk_bf16_f32 v172, v160, v161
v_cvt_pk_bf16_f32 v173, v162, v163
v_cvt_pk_bf16_f32 v174, v164, v165
v_cvt_pk_bf16_f32 v175, v166, v167
buffer_store_dwordx4 v[172:175], v224, s[4:7], s45 offen offset:0
v_add_f32 v184, 0x358637bd, v184
v_rcp_f32 v184, v184
s_nop 0
v_pk_mul_f32 v[176:177], v[176:177], v[184:185] op_sel_hi:[1,0]
v_pk_mul_f32 v[178:179], v[178:179], v[184:185] op_sel_hi:[1,0]
v_pk_mul_f32 v[180:181], v[180:181], v[184:185] op_sel_hi:[1,0]
v_pk_mul_f32 v[182:183], v[182:183], v[184:185] op_sel_hi:[1,0]
v_cvt_pk_bf16_f32 v188, v176, v177
v_cvt_pk_bf16_f32 v189, v178, v179
v_cvt_pk_bf16_f32 v190, v180, v181
v_cvt_pk_bf16_f32 v191, v182, v183
buffer_store_dwordx4 v[188:191], v224, s[4:7], s45 offen offset:1024
v_lshlrev_b32 v218, 16, v219
v_and_b32 v219, 0xffff0000, v219
v_lshlrev_b32 v220, 16, v221
v_and_b32 v221, 0xffff0000, v221
v_lshlrev_b32 v222, 16, v223
v_and_b32 v223, 0xffff0000, v223
v_lshrrev_b32 v229, 5, v240
v_mul_u32_u24 v229, 1024, v229
v_bfe_u32 v230, v240, 4, 1
v_lshl_add_u32 v229, v230, 9, v229
v_and_b32 v230, 0xf0, v224
s_bfe_u32 s35, s41, 0x90004
v_add3_u32 v229, v229, v230, s35
v_xor_b32 v230, 0x100, v229
s_cmp_eq_u32 s20, 0
s_cbranch_scc0 L_NC8
s_call_b64 s[10:11], L_ST6
L_NC8:
s_cmp_eq_u32 s20, 1
s_cbranch_scc0 L_NC9
s_call_b64 s[10:11], L_ST7
L_NC9:
s_cmp_eq_u32 s20, 2
s_cbranch_scc0 L_NC10
s_call_b64 s[10:11], L_ST8
L_NC10:
s_cmp_eq_u32 s20, 3
s_cbranch_scc0 L_NC11
s_call_b64 s[10:11], L_ST9
L_NC11:
s_cmp_lg_u32 s26, 0
s_mov_b64 exec, 1
s_waitcnt vmcnt(0)
s_cbranch_scc0 SS_12
buffer_store_dword v228, off, s[4:7], s49 offset:0
SJ_13:
s_mov_b64 exec, -1
buffer_load_dword v227, v226, s[4:7], s51 offen sc1
s_waitcnt vmcnt(0)
CL_14:
v_cmp_ne_u32 vcc, s53, v227
s_nop 0
s_and_b32 s30, vcc_lo, 255
s_cbranch_scc0 CJ_15
buffer_load_dword v227, v226, s[4:7], s51 offen sc1
s_sub_i32 s59, s59, 1
s_cmp_lt_i32 s59, 0
s_waitcnt vmcnt(0)
s_cbranch_scc0 CL_14
CJ_15:
s_cmp_lg_u32 s26, 0
s_cbranch_scc0 AS_16
AJ_17:
s_add_u32 s33, s46, 0
buffer_load_dwordx4 v[0:3], v230, s[4:7], s33 offen sc1
s_add_u32 s33, s46, 6144
buffer_load_dwordx4 v[4:7], v230, s[4:7], s33 offen sc1
s_add_u32 s33, s46, 12288
buffer_load_dwordx4 v[8:11], v230, s[4:7], s33 offen sc1
s_add_u32 s33, s46, 18432
buffer_load_dwordx4 v[12:15], v230, s[4:7], s33 offen sc1
s_add_u32 s33, s46, 0
buffer_load_dwordx4 v[16:19], v229, s[4:7], s33 offen sc1
s_add_u32 s33, s46, 6144
buffer_load_dwordx4 v[20:23], v229, s[4:7], s33 offen sc1
s_add_u32 s33, s46, 12288
buffer_load_dwordx4 v[24:27], v229, s[4:7], s33 offen sc1
s_add_u32 s33, s46, 18432
buffer_load_dwordx4 v[28:31], v229, s[4:7], s33 offen sc1
s_add_u32 s33, s46, 98304
buffer_load_dwordx4 v[32:35], v230, s[4:7], s33 offen sc1
s_add_u32 s33, s46, 104448
buffer_load_dwordx4 v[36:39], v230, s[4:7], s33 offen sc1
s_add_u32 s33, s46, 110592
buffer_load_dwordx4 v[40:43], v230, s[4:7], s33 offen sc1
s_add_u32 s33, s46, 116736
buffer_load_dwordx4 v[44:47], v230, s[4:7], s33 offen sc1
s_waitcnt vmcnt(11)
v_mfma_f32_16x16x32_bf16 v[136:139], a[0:3], v[0:3], 0
s_add_u32 s33, s46, 98304
buffer_load_dwordx4 v[48:51], v229, s[4:7], s33 offen sc1
v_mfma_f32_16x16x32_bf16 v[140:143], a[4:7], v[0:3], 0
v_mfma_f32_16x16x32_bf16 v[152:155], a[8:11], v[0:3], 0
s_add_u32 s33, s46, 104448
buffer_load_dwordx4 v[52:55], v229, s[4:7], s33 offen sc1
v_mfma_f32_16x16x32_bf16 v[156:159], a[12:15], v[0:3], 0
s_waitcnt vmcnt(12)
v_mfma_f32_16x16x32_bf16 v[136:139], a[16:19], v[4:7], v[136:139]
s_add_u32 s33, s46, 110592
buffer_load_dwordx4 v[56:59], v229, s[4:7], s33 offen sc1
v_mfma_f32_16x16x32_bf16 v[140:143], a[20:23], v[4:7], v[140:143]
v_mfma_f32_16x16x32_bf16 v[152:155], a[24:27], v[4:7], v[152:155]
s_add_u32 s33, s46, 116736
buffer_load_dwordx4 v[60:63], v229, s[4:7], s33 offen sc1
v_mfma_f32_16x16x32_bf16 v[156:159], a[28:31], v[4:7], v[156:159]
s_waitcnt vmcnt(13)
v_mfma_f32_16x16x32_bf16 v[136:139], a[32:35], v[8:11], v[136:139]
v_lshrrev_b32 v80, 4, v240
v_mfma_f32_16x16x32_bf16 v[140:143], a[36:39], v[8:11], v[140:143]
buffer_load_dwordx4 v224, s[4:7], s34 offen offset:1024 sc1 lds
v_mfma_f32_16x16x32_bf16 v[152:155], a[40:43], v[8:11], v[152:155]
v_mul_u32_u24 v80, 1280, v80
v_mfma_f32_16x16x32_bf16 v[156:159], a[44:47], v[8:11], v[156:159]
s_waitcnt vmcnt(13)
v_mfma_f32_16x16x32_bf16 v[136:139], a[48:51], v[12:15], v[136:139]
v_and_b32 v81, 0xf0, v224
v_mfma_f32_16x16x32_bf16 v[140:143], a[52:55], v[12:15], v[140:143]
buffer_load_dwordx4 v224, s[4:7], s34 offen offset:2048 sc1 lds
v_mfma_f32_16x16x32_bf16 v[152:155], a[56:59], v[12:15], v[152:155]
v_add_u32 v80, v80, v81
v_mfma_f32_16x16x32_bf16 v[156:159], a[60:63], v[12:15], v[156:159]
s_waitcnt vmcnt(13)
v_mfma_f32_16x16x32_bf16 v[128:131], a[0:3], v[16:19], 0
s_lshl_b32 s30, s20, 8
s_add_u32 s31, s30, s28
s_add_u32 s31, s31, 369152
s_add_u32 s30, s30, 161792
s_cmp_lt_u32 s20, 3
s_cselect_b32 s31, s31, 1073741824
s_cselect_b32 s30, s30, 163136
v_add_u32 v81, s30, v81
v_mfma_f32_16x16x32_bf16 v[132:135], a[4:7], v[16:19], 0
buffer_load_dwordx4 v224, s[4:7], s34 offen offset:3072 sc1 lds
v_mfma_f32_16x16x32_bf16 v[144:147], a[8:11], v[16:19], 0
ds_write_b128 v247, v[136:139] offset:0
v_mfma_f32_16x16x32_bf16 v[148:151], a[12:15], v[16:19], 0
buffer_load_dwordx4 v[64:67], v80, s[4:7], s31 offen sc1
s_waitcnt vmcnt(14)
v_mfma_f32_16x16x32_bf16 v[128:131], a[16:19], v[20:23], v[128:131]
s_add_u32 s31, s31, 5120
buffer_load_dwordx4 v[68:71], v80, s[4:7], s31 offen sc1
v_mfma_f32_16x16x32_bf16 v[132:135], a[20:23], v[20:23], v[132:135]
s_add_u32 m0, s41, 65536
s_add_u32 s34, s36, 163840
buffer_load_dwordx4 v224, s[4:7], s34 offen offset:0 sc1 lds
v_mfma_f32_16x16x32_bf16 v[144:147], a[24:27], v[20:23], v[144:147]
ds_write_b128 v247, v[140:143] offset:1024
v_mfma_f32_16x16x32_bf16 v[148:151], a[28:31], v[20:23], v[148:151]
s_add_u32 s31, s31, 5120
buffer_load_dwordx4 v[72:75], v80, s[4:7], s31 offen sc1
s_waitcnt vmcnt(16)
v_mfma_f32_16x16x32_bf16 v[128:131], a[32:35], v[24:27], v[128:131]
ds_write_b128 v249, v[152:155] offset:16384
v_mfma_f32_16x16x32_bf16 v[132:135], a[36:39], v[24:27], v[132:135]
buffer_load_dwordx4 v224, s[4:7], s34 offen offset:1024 sc1 lds
s_add_u32 s31, s31, 5120
buffer_load_dwordx4 v[76:79], v80, s[4:7], s31 offen sc1
v_mfma_f32_16x16x32_bf16 v[144:147], a[40:43], v[24:27], v[144:147]
ds_write_b128 v249, v[156:159] offset:17408
v_mfma_f32_16x16x32_bf16 v[148:151], a[44:47], v[24:27], v[148:151]
s_waitcnt vmcnt(17)
v_mfma_f32_16x16x32_bf16 v[128:131], a[48:51], v[28:31], v[128:131]
v_mfma_f32_16x16x32_bf16 v[132:135], a[52:55], v[28:31], v[132:135]
buffer_load_dwordx4 v224, s[4:7], s34 offen offset:2048 sc1 lds
v_mfma_f32_16x16x32_bf16 v[144:147], a[56:59], v[28:31], v[144:147]
v_mfma_f32_16x16x32_bf16 v[148:151], a[60:63], v[28:31], v[148:151]
s_waitcnt vmcnt(17)
v_mfma_f32_16x16x32_bf16 v[168:171], a[0:3], v[32:35], 0
v_mfma_f32_16x16x32_bf16 v[172:175], a[4:7], v[32:35], 0
buffer_load_dwordx4 v224, s[4:7], s34 offen offset:3072 sc1 lds
s_add_u32 s53, s25, 1
v_mfma_f32_16x16x32_bf16 v[184:187], a[8:11], v[32:35], 0
v_mfma_f32_16x16x32_bf16 v[188:191], a[12:15], v[32:35], 0
ds_write_b128 v248, v[144:147] offset:8192
s_add_u32 m0, s41, 81920
s_add_u32 s34, s36, 180224
buffer_load_dwordx4 v224, s[4:7], s34 offen offset:0 sc1 lds
v_mov_b32 v228, s53
s_waitcnt vmcnt(18)
v_mfma_f32_16x16x32_bf16 v[168:171], a[16:19], v[36:39], v[168:171]
v_mfma_f32_16x16x32_bf16 v[172:175], a[20:23], v[36:39], v[172:175]
ds_write_b128 v248, v[148:151] offset:9216
buffer_load_dwordx4 v224, s[4:7], s34 offen offset:1024 sc1 lds
v_mfma_f32_16x16x32_bf16 v[184:187], a[24:27], v[36:39], v[184:187]
v_mfma_f32_16x16x32_bf16 v[188:191], a[28:31], v[36:39], v[188:191]
buffer_load_dwordx4 v224, s[4:7], s34 offen offset:2048 sc1 lds
s_waitcnt vmcnt(19)
v_mfma_f32_16x16x32_bf16 v[168:171], a[32:35], v[40:43], v[168:171]
v_mfma_f32_16x16x32_bf16 v[172:175], a[36:39], v[40:43], v[172:175]
s_waitcnt lgkmcnt(0)
s_barrier
ds_read_b128 v[192:195], v242 offset:0
ds_read_b128 v[196:199], v242 offset:1024
ds_read_b128 v[200:203], v242 offset:8192
buffer_load_dwordx4 v224, s[4:7], s34 offen offset:3072 sc1 lds
v_mfma_f32_16x16x32_bf16 v[184:187], a[40:43], v[40:43], v[184:187]
v_mfma_f32_16x16x32_bf16 v[188:191], a[44:47], v[40:43], v[188:191]
ds_read_b128 v[204:207], v242 offset:9216
ds_read_b128 v[208:211], v242 offset:16384
ds_read_b128 v[212:215], v242 offset:17408
s_waitcnt vmcnt(19)
v_mfma_f32_16x16x32_bf16 v[168:171], a[48:51], v[44:47], v[168:171]
v_mfma_f32_16x16x32_bf16 v[172:175], a[52:55], v[44:47], v[172:175]
v_mfma_f32_16x16x32_bf16 v[184:187], a[56:59], v[44:47], v[184:187]
v_mfma_f32_16x16x32_bf16 v[188:191], a[60:63], v[44:47], v[188:191]
s_waitcnt vmcnt(18)
v_mfma_f32_16x16x32_bf16 v[160:163], a[0:3], v[48:51], 0
v_mfma_f32_16x16x32_bf16 v[164:167], a[4:7], v[48:51], 0
s_waitcnt lgkmcnt(0)
s_barrier
v_mfma_f32_16x16x32_bf16 v[176:179], a[8:11], v[48:51], 0
v_mfma_f32_16x16x32_bf16 v[180:183], a[12:15], v[48:51], 0
ds_write_b128 v247, v[168:171] offset:0
s_waitcnt vmcnt(17)
v_mfma_f32_16x16x32_bf16 v[160:163], a[16:19], v[52:55], v[160:163]
v_mfma_f32_16x16x32_bf16 v[164:167], a[20:23], v[52:55], v[164:167]
v_mfma_f32_16x16x32_bf16 v[176:179], a[24:27], v[52:55], v[176:179]
v_mfma_f32_16x16x32_bf16 v[180:183], a[28:31], v[52:55], v[180:183]
ds_write_b128 v247, v[172:175] offset:1024
s_waitcnt vmcnt(16)
v_mfma_f32_16x16x32_bf16 v[160:163], a[32:35], v[56:59], v[160:163]
v_mfma_f32_16x16x32_bf16 v[164:167], a[36:39], v[56:59], v[164:167]
ds_write_b128 v249, v[184:187] offset:16384
v_mfma_f32_16x16x32_bf16 v[176:179], a[40:43], v[56:59], v[176:179]
v_mfma_f32_16x16x32_bf16 v[180:183], a[44:47], v[56:59], v[180:183]
ds_write_b128 v249, v[188:191] offset:17408
s_waitcnt vmcnt(15)
v_mfma_f32_16x16x32_bf16 v[160:163], a[48:51], v[60:63], v[160:163]
v_mfma_f32_16x16x32_bf16 v[164:167], a[52:55], v[60:63], v[164:167]
v_mfma_f32_16x16x32_bf16 v[176:179], a[56:59], v[60:63], v[176:179]
v_mfma_f32_16x16x32_bf16 v[180:183], a[60:63], v[60:63], v[180:183]
v_add_f32 v128, v128, v192
v_add_f32 v129, v129, v193
v_add_f32 v130, v130, v194
v_add_f32 v131, v131, v195
v_add_f32 v132, v132, v196
v_add_f32 v133, v133, v197
v_add_f32 v134, v134, v198
v_add_f32 v135, v135, v199
ds_write_b128 v248, v[176:179] offset:8192
v_pk_add_f32 v[128:129], v[128:129], v[200:201]
v_pk_add_f32 v[130:131], v[130:131], v[202:203]
v_pk_add_f32 v[132:133], v[132:133], v[204:205]
v_pk_add_f32 v[134:135], v[134:135], v[206:207]
v_pk_add_f32 v[128:129], v[128:129], v[208:209]
v_pk_add_f32 v[130:131], v[130:131], v[210:211]
v_pk_add_f32 v[132:133], v[132:133], v[212:213]
v_pk_add_f32 v[134:135], v[134:135], v[214:215]
v_pk_add_f32 v[128:129], v[128:129], v[216:217]
v_and_b32 v141, 0xfffe0000, v128
v_pk_add_f32 v[130:131], v[130:131], v[218:219]
v_pk_add_f32 v[132:133], v[132:133], v[220:221]
v_pk_add_f32 v[134:135], v[134:135], v[222:223]
v_cvt_pk_bf16_f32 v136, v141, v129
v_cvt_pk_bf16_f32 v137, v130, v131
ds_write_b128 v248, v[180:183] offset:9216
v_cvt_pk_bf16_f32 v138, v132, v133
v_cvt_pk_bf16_f32 v139, v134, v135
v_or_b32_e64 v136, 1, v136
s_add_u32 s31, s37, 0
buffer_store_dwordx4 v[136:139], v224, s[4:7], s31 offen
v_accvgpr_read_b32 v217, a252
v_accvgpr_read_b32 v219, a253
v_accvgpr_read_b32 v221, a254
v_accvgpr_read_b32 v223, a255
v_lshlrev_b32 v216, 16, v217
v_and_b32 v217, 0xffff0000, v217
v_lshlrev_b32 v218, 16, v219
v_and_b32 v219, 0xffff0000, v219
v_lshlrev_b32 v220, 16, v221
v_and_b32 v221, 0xffff0000, v221
v_lshlrev_b32 v222, 16, v223
v_and_b32 v223, 0xffff0000, v223
s_waitcnt lgkmcnt(0)
s_barrier
ds_read_b128 v[192:195], v242 offset:0
ds_read_b128 v[196:199], v242 offset:1024
ds_read_b128 v[200:203], v242 offset:8192
ds_read_b128 v[204:207], v242 offset:9216
ds_read_b128 v[208:211], v242 offset:16384
ds_read_b128 v[212:215], v242 offset:17408
s_waitcnt lgkmcnt(4)
v_pk_add_f32 v[160:161], v[160:161], v[192:193]
v_pk_add_f32 v[162:163], v[162:163], v[194:195]
s_branch L_SK2
L_ST2:
s_setpc_b64 s[10:11]
L_SK2:
v_pk_add_f32 v[164:165], v[164:165], v[196:197]
v_pk_add_f32 v[166:167], v[166:167], v[198:199]
s_waitcnt lgkmcnt(2)
v_pk_add_f32 v[160:161], v[160:161], v[200:201]
v_pk_add_f32 v[162:163], v[162:163], v[202:203]
v_pk_add_f32 v[164:165], v[164:165], v[204:205]
v_pk_add_f32 v[166:167], v[166:167], v[206:207]
s_waitcnt lgkmcnt(0)
v_pk_add_f32 v[160:161], v[160:161], v[208:209]
v_pk_add_f32 v[162:163], v[162:163], v[210:211]
v_pk_add_f32 v[164:165], v[164:165], v[212:213]
v_pk_add_f32 v[166:167], v[166:167], v[214:215]
v_pk_add_f32 v[160:161], v[160:161], v[216:217]
v_and_b32 v173, 0xfffe0000, v160
v_pk_add_f32 v[162:163], v[162:163], v[218:219]
v_pk_add_f32 v[164:165], v[164:165], v[220:221]
v_pk_add_f32 v[166:167], v[166:167], v[222:223]
v_cvt_pk_bf16_f32 v168, v173, v161
v_cvt_pk_bf16_f32 v169, v162, v163
v_cvt_pk_bf16_f32 v170, v164, v165
v_cvt_pk_bf16_f32 v171, v166, v167
v_or_b32 v168, 1, v168
s_add_u32 s31, s37, 32768
buffer_store_dwordx4 v[168:171], v224, s[4:7], s31 offen
v_pk_add_f32 v[144:145], v[128:129], v[130:131]
v_pk_mul_f32 v[146:147], v[128:129], v[128:129]
v_pk_add_f32 v[144:145], v[144:145], v[132:133]
v_pk_fma_f32 v[146:147], v[130:131], v[130:131], v[146:147]
v_pk_add_f32 v[144:145], v[144:145], v[134:135]
v_pk_fma_f32 v[146:147], v[132:133], v[132:133], v[146:147]
v_add_f32 v144, v144, v145
v_pk_fma_f32 v[146:147], v[134:135], v[134:135], v[146:147]
v_add_f32_e64 v145, v146, v147
ds_write_b64 v243, v[144:145] offset:0
v_cvt_pk_bf16_f32 v140, v128, v129
v_accvgpr_write_b32 a249, v137
v_accvgpr_write_b32 a250, v138
v_accvgpr_write_b32 a251, v139
v_accvgpr_write_b32 a248, v140
v_pk_add_f32 v[148:149], v[160:161], v[162:163]
v_pk_mul_f32 v[150:151], v[160:161], v[160:161]
v_pk_add_f32 v[148:149], v[148:149], v[164:165]
v_pk_fma_f32 v[150:151], v[162:163], v[162:163], v[150:151]
v_pk_add_f32 v[148:149], v[148:149], v[166:167]
v_pk_fma_f32 v[150:151], v[164:165], v[164:165], v[150:151]
v_add_f32 v148, v148, v149
v_pk_fma_f32 v[150:151], v[166:167], v[166:167], v[150:151]
v_add_f32 v149, v150, v151
ds_write_b64 v243, v[148:149] offset:2048
v_cvt_pk_bf16_f32 v172, v160, v161
v_accvgpr_write_b32 a253, v169
v_accvgpr_write_b32 a254, v170
v_accvgpr_write_b32 a255, v171
v_accvgpr_write_b32 a252, v172
s_waitcnt lgkmcnt(0)
s_barrier
ds_read_b64 v[192:193], v237 offset:0
ds_read_b64 v[194:195], v237 offset:128
ds_read_b64 v[196:197], v237 offset:256
ds_read_b64 v[198:199], v237 offset:384
ds_read_b64 v[200:201], v237 offset:1024
ds_read_b64 v[202:203], v237 offset:1152
ds_read_b64 v[204:205], v237 offset:1280
ds_read_b64 v[206:207], v237 offset:1408
s_waitcnt vmcnt(8)
v_add_f32 v64, v64, v68
v_add_f32 v65, v65, v69
v_add_f32 v66, v66, v70
v_add_f32 v67, v67, v71
v_add_f32 v72, v72, v76
v_add_f32 v73, v73, v77
v_add_f32 v74, v74, v78
v_add_f32 v75, v75, v79
v_add_f32 v64, v64, v72
s_cmp_lg_u32 s26, 0
s_mov_b64 exec, 3
s_waitcnt vmcnt(0)
s_cbranch_scc0 SS_18
buffer_store_dword v228, v239, s[4:7], s50 offen
SJ_19:
s_mov_b64 exec, -1
buffer_load_dword v227, v226, s[4:7], s52 offen sc1
s_waitcnt lgkmcnt(6)
v_pk_add_f32 v[192:193], v[192:193], v[194:195]
s_waitcnt lgkmcnt(4)
v_pk_add_f32 v[196:197], v[196:197], v[198:199]
s_waitcnt lgkmcnt(2)
v_pk_add_f32 v[200:201], v[200:201], v[202:203]
s_waitcnt lgkmcnt(0)
v_pk_add_f32 v[204:205], v[204:205], v[206:207]
v_pk_add_f32 v[192:193], v[192:193], v[196:197]
v_pk_add_f32 v[200:201], v[200:201], v[204:205]
v_pk_add_f32 v[192:193], v[192:193], v[200:201]
v_and_or_b32 v193, v193, -4, 1
s_cmp_lg_u32 s26, 0
s_mov_b64 exec, 0xffff
s_cbranch_scc0 SS_20
buffer_store_dwordx2 v[192:193], v237, s[4:7], s38 offen
SJ_21:
s_mov_b64 exec, -1
v_add_f32 v65, v65, v73
v_add_f32 v66, v66, v74
v_add_f32 v67, v67, v75
v_mov_b32 v68, v64
v_mov_b32 v69, v65
v_mov_b32 v70, v66
v_mov_b32 v71, v67
v_permlane16_swap_b32 v64, v68
v_permlane16_swap_b32 v65, v69
v_permlane16_swap_b32 v66, v70
v_permlane16_swap_b32 v67, v71
v_add_f32 v64, v64, v68
v_add_f32 v65, v65, v69
v_add_f32 v66, v66, v70
v_add_f32 v67, v67, v71
v_mov_b32 v68, v64
v_mov_b32 v69, v65
v_mov_b32 v70, v66
v_mov_b32 v71, v67
v_permlane32_swap_b32 v64, v68
v_permlane32_swap_b32 v65, v69
v_permlane32_swap_b32 v66, v70
v_permlane32_swap_b32 v67, v71
v_add_f32 v64, v64, v68
v_add_f32 v65, v65, v69
v_add_f32 v66, v66, v70
v_add_f32 v67, v67, v71
v_cvt_pk_bf16_f32 v68, v64, v65
v_cvt_pk_bf16_f32 v69, v66, v67
v_lshlrev_b32 v72, 16, v68
v_and_b32 v73, 0xffff0000, v68
v_lshlrev_b32 v74, 16, v69
v_and_b32 v75, 0xffff0000, v69
v_sub_f32 v64, v64, v72
v_sub_f32 v65, v65, v73
v_sub_f32 v66, v66, v74
v_sub_f32 v67, v67, v75
v_cvt_pk_bf16_f32 v68, v72, v64
v_cvt_pk_bf16_f32 v69, v73, v65
v_cvt_pk_bf16_f32 v70, v74, v66
v_cvt_pk_bf16_f32 v71, v75, v67
ds_write_b128 v81, v[68:71]
s_waitcnt vmcnt(1)
CL_22:
v_cmp_ne_u32 vcc, s53, v227
s_nop 0
s_and_b32 s30, vcc_lo, -1
s_cbranch_scc0 CJ_23
buffer_load_dword v227, v226, s[4:7], s52 offen sc1
s_sub_i32 s59, s59, 1
s_cmp_lt_i32 s59, 0
s_waitcnt vmcnt(0)
s_cbranch_scc0 CL_22
CJ_23:
s_cmp_lg_u32 s26, 0
s_cbranch_scc0 AS_24
AJ_25:
buffer_load_dwordx4 v[0:3], v224, s[4:7], s44 offen offset:0 sc1
buffer_load_dwordx4 v[4:7], v224, s[4:7], s44 offen offset:1024 sc1
buffer_load_dwordx4 v[8:11], v224, s[4:7], s44 offen offset:2048 sc1
buffer_load_dwordx4 v[12:15], v224, s[4:7], s44 offen offset:3072 sc1
s_add_u32 s33, s44, 4096
buffer_load_dwordx4 v[16:19], v224, s[4:7], s33 offen offset:0 sc1
buffer_load_dwordx4 v[20:23], v224, s[4:7], s33 offen offset:1024 sc1
buffer_load_dwordx4 v[24:27], v224, s[4:7], s33 offen offset:2048 sc1
buffer_load_dwordx4 v[28:31], v224, s[4:7], s33 offen offset:3072 sc1
s_add_u32 s33, s44, 8192
buffer_load_dwordx4 v[32:35], v224, s[4:7], s33 offen offset:0 sc1
buffer_load_dwordx4 v[36:39], v224, s[4:7], s33 offen offset:1024 sc1
s_waitcnt lgkmcnt(0)
s_barrier
L_P3R0:
ds_read_b128 v[216:219], v225 offset:32768
ds_read_b128 v[220:223], v224 offset:32768
ds_read_b128 v[192:195], v225 offset:0
ds_read_b128 v[196:199], v225 offset:33792
ds_read_b128 v[200:203], v224 offset:33792
ds_read_b128 v[204:207], v225 offset:1024
ds_read_b128 v[208:211], v225 offset:34816
s_waitcnt vmcnt(8) lgkmcnt(4)
v_mfma_f32_16x16x32_bf16 v[128:131], v[216:219], v[0:3], 0
ds_read_b128 v[212:215], v224 offset:34816
v_mfma_f32_16x16x32_bf16 v[132:135], v[216:219], v[4:7], 0
buffer_load_dwordx4 v[40:43], v224, s[4:7], s33 offen offset:2048 sc1
v_mfma_f32_16x16x32_bf16 v[148:151], v[220:223], v[4:7], 0
ds_read_b128 v[216:219], v225 offset:2048
v_mfma_f32_16x16x32_bf16 v[144:147], v[220:223], v[0:3], 0
v_mfma_f32_16x16x32_bf16 v[160:163], v[192:195], v[0:3], 0
ds_read_b128 v[220:223], v225 offset:35840
v_mfma_f32_16x16x32_bf16 v[164:167], v[192:195], v[4:7], 0
s_waitcnt lgkmcnt(4)
v_mfma_f32_16x16x32_bf16 v[140:143], v[196:199], v[4:7], 0
ds_read_b128 v[192:195], v224 offset:35840
v_mfma_f32_16x16x32_bf16 v[136:139], v[196:199], v[0:3], 0
buffer_load_dwordx4 v[44:47], v224, s[4:7], s33 offen offset:3072 sc1
v_mfma_f32_16x16x32_bf16 v[152:155], v[200:203], v[0:3], 0
ds_read_b128 v[196:199], v225 offset:3072
s_add_u32 s33, s44, 12288
v_mfma_f32_16x16x32_bf16 v[156:159], v[200:203], v[4:7], 0
buffer_load_dwordx4 v[48:51], v224, s[4:7], s33 offen offset:0 sc1
v_mfma_f32_16x16x32_bf16 v[172:175], v[204:207], v[4:7], 0
ds_read_b128 v[200:203], v225 offset:36864
v_mfma_f32_16x16x32_bf16 v[168:171], v[204:207], v[0:3], 0
s_waitcnt vmcnt(9) lgkmcnt(4)
v_mfma_f32_16x16x32_bf16 v[128:131], v[208:211], v[8:11], v[128:131]
ds_read_b128 v[204:207], v224 offset:36864
v_mfma_f32_16x16x32_bf16 v[132:135], v[208:211], v[12:15], v[132:135]
buffer_load_dwordx4 v[52:55], v224, s[4:7], s33 offen offset:1024 sc1
v_mfma_f32_16x16x32_bf16 v[148:151], v[212:215], v[12:15], v[148:151]
ds_read_b128 v[208:211], v225 offset:4096
v_mfma_f32_16x16x32_bf16 v[144:147], v[212:215], v[8:11], v[144:147]
v_mfma_f32_16x16x32_bf16 v[160:163], v[216:219], v[8:11], v[160:163]
ds_read_b128 v[212:215], v225 offset:37888
v_mfma_f32_16x16x32_bf16 v[164:167], v[216:219], v[12:15], v[164:167]
s_waitcnt lgkmcnt(4)
v_mfma_f32_16x16x32_bf16 v[140:143], v[220:223], v[12:15], v[140:143]
ds_read_b128 v[216:219], v224 offset:37888
v_mfma_f32_16x16x32_bf16 v[136:139], v[220:223], v[8:11], v[136:139]
buffer_load_dwordx4 v[56:59], v224, s[4:7], s33 offen offset:2048 sc1
v_mfma_f32_16x16x32_bf16 v[152:155], v[192:195], v[8:11], v[152:155]
ds_read_b128 v[220:223], v225 offset:5120
v_mfma_f32_16x16x32_bf16 v[156:159], v[192:195], v[12:15], v[156:159]
v_mfma_f32_16x16x32_bf16 v[172:175], v[196:199], v[12:15], v[172:175]
ds_read_b128 v[192:195], v225 offset:38912
v_mfma_f32_16x16x32_bf16 v[168:171], v[196:199], v[8:11], v[168:171]
s_waitcnt vmcnt(9) lgkmcnt(4)
v_mfma_f32_16x16x32_bf16 v[128:131], v[200:203], v[16:19], v[128:131]
ds_read_b128 v[196:199], v224 offset:38912
v_mfma_f32_16x16x32_bf16 v[132:135], v[200:203], v[20:23], v[132:135]
buffer_load_dwordx4 v[60:63], v224, s[4:7], s33 offen offset:3072 sc1
v_mfma_f32_16x16x32_bf16 v[148:151], v[204:207], v[20:23], v[148:151]
ds_read_b128 v[200:203], v225 offset:6144
s_add_u32 s33, s44, 16384
v_mfma_f32_16x16x32_bf16 v[144:147], v[204:207], v[16:19], v[144:147]
buffer_load_dwordx4 v[64:67], v224, s[4:7], s33 offen offset:0 sc1
v_mfma_f32_16x16x32_bf16 v[160:163], v[208:211], v[16:19], v[160:163]
ds_read_b128 v[204:207], v225 offset:39936
v_mfma_f32_16x16x32_bf16 v[164:167], v[208:211], v[20:23], v[164:167]
s_waitcnt lgkmcnt(4)
v_mfma_f32_16x16x32_bf16 v[140:143], v[212:215], v[20:23], v[140:143]
ds_read_b128 v[208:211], v224 offset:39936
v_mfma_f32_16x16x32_bf16 v[136:139], v[212:215], v[16:19], v[136:139]
buffer_load_dwordx4 v[68:71], v224, s[4:7], s33 offen offset:1024 sc1
v_mfma_f32_16x16x32_bf16 v[152:155], v[216:219], v[16:19], v[152:155]
ds_read_b128 v[212:215], v225 offset:7168
v_mfma_f32_16x16x32_bf16 v[156:159], v[216:219], v[20:23], v[156:159]
v_mfma_f32_16x16x32_bf16 v[172:175], v[220:223], v[20:23], v[172:175]
ds_read_b128 v[216:219], v225 offset:40960
v_mfma_f32_16x16x32_bf16 v[168:171], v[220:223], v[16:19], v[168:171]
s_waitcnt vmcnt(10) lgkmcnt(4)
v_mfma_f32_16x16x32_bf16 v[128:131], v[192:195], v[24:27], v[128:131]
ds_read_b128 v[220:223], v224 offset:40960
v_mfma_f32_16x16x32_bf16 v[132:135], v[192:195], v[28:31], v[132:135]
buffer_load_dwordx4 v[72:75], v224, s[4:7], s33 offen offset:2048 sc1
v_mfma_f32_16x16x32_bf16 v[148:151], v[196:199], v[28:31], v[148:151]
ds_read_b128 v[192:195], v225 offset:8192
v_mfma_f32_16x16x32_bf16 v[144:147], v[196:199], v[24:27], v[144:147]
v_mfma_f32_16x16x32_bf16 v[160:163], v[200:203], v[24:27], v[160:163]
ds_read_b128 v[196:199], v225 offset:41984
v_mfma_f32_16x16x32_bf16 v[164:167], v[200:203], v[28:31], v[164:167]
s_waitcnt lgkmcnt(4)
v_mfma_f32_16x16x32_bf16 v[140:143], v[204:207], v[28:31], v[140:143]
ds_read_b128 v[200:203], v224 offset:41984
v_mfma_f32_16x16x32_bf16 v[136:139], v[204:207], v[24:27], v[136:139]
buffer_load_dwordx4 v[76:79], v224, s[4:7], s33 offen offset:3072 sc1
v_mfma_f32_16x16x32_bf16 v[152:155], v[208:211], v[24:27], v[152:155]
ds_read_b128 v[204:207], v225 offset:9216
s_add_u32 s33, s44, 20480
v_mfma_f32_16x16x32_bf16 v[156:159], v[208:211], v[28:31], v[156:159]
buffer_load_dwordx4 v[80:83], v224, s[4:7], s33 offen offset:0 sc1
v_mfma_f32_16x16x32_bf16 v[172:175], v[212:215], v[28:31], v[172:175]
ds_read_b128 v[208:211], v225 offset:43008
v_mfma_f32_16x16x32_bf16 v[168:171], v[212:215], v[24:27], v[168:171]
s_waitcnt vmcnt(11) lgkmcnt(4)
v_mfma_f32_16x16x32_bf16 v[128:131], v[216:219], v[32:35], v[128:131]
ds_read_b128 v[212:215], v224 offset:43008
v_mfma_f32_16x16x32_bf16 v[132:135], v[216:219], v[36:39], v[132:135]
buffer_load_dwordx4 v[84:87], v224, s[4:7], s33 offen offset:1024 sc1
v_mfma_f32_16x16x32_bf16 v[148:151], v[220:223], v[36:39], v[148:151]
ds_read_b128 v[216:219], v225 offset:10240
v_mfma_f32_16x16x32_bf16 v[144:147], v[220:223], v[32:35], v[144:147]
v_mfma_f32_16x16x32_bf16 v[160:163], v[192:195], v[32:35], v[160:163]
ds_read_b128 v[220:223], v225 offset:44032
v_mfma_f32_16x16x32_bf16 v[164:167], v[192:195], v[36:39], v[164:167]
s_waitcnt lgkmcnt(4)
v_mfma_f32_16x16x32_bf16 v[140:143], v[196:199], v[36:39], v[140:143]
ds_read_b128 v[192:195], v224 offset:44032
v_mfma_f32_16x16x32_bf16 v[136:139], v[196:199], v[32:35], v[136:139]
buffer_load_dwordx4 v[88:91], v224, s[4:7], s33 offen offset:2048 sc1
v_mfma_f32_16x16x32_bf16 v[152:155], v[200:203], v[32:35], v[152:155]
ds_read_b128 v[196:199], v225 offset:11264
v_mfma_f32_16x16x32_bf16 v[156:159], v[200:203], v[36:39], v[156:159]
v_mfma_f32_16x16x32_bf16 v[172:175], v[204:207], v[36:39], v[172:175]
ds_read_b128 v[200:203], v225 offset:45056
v_mfma_f32_16x16x32_bf16 v[168:171], v[204:207], v[32:35], v[168:171]
s_waitcnt vmcnt(11) lgkmcnt(4)
v_mfma_f32_16x16x32_bf16 v[128:131], v[208:211], v[40:43], v[128:131]
ds_read_b128 v[204:207], v224 offset:45056
v_mfma_f32_16x16x32_bf16 v[132:135], v[208:211], v[44:47], v[132:135]
buffer_load_dwordx4 v[92:95], v224, s[4:7], s33 offen offset:3072 sc1
v_mfma_f32_16x16x32_bf16 v[148:151], v[212:215], v[44:47], v[148:151]
ds_read_b128 v[208:211], v225 offset:12288
s_add_u32 s33, s44, 24576
v_mfma_f32_16x16x32_bf16 v[144:147], v[212:215], v[40:43], v[144:147]
buffer_load_dwordx4 v[96:99], v224, s[4:7], s33 offen offset:0 sc1
v_mfma_f32_16x16x32_bf16 v[160:163], v[216:219], v[40:43], v[160:163]
ds_read_b128 v[212:215], v225 offset:46080
v_mfma_f32_16x16x32_bf16 v[164:167], v[216:219], v[44:47], v[164:167]
s_waitcnt lgkmcnt(4)
v_mfma_f32_16x16x32_bf16 v[140:143], v[220:223], v[44:47], v[140:143]
ds_read_b128 v[216:219], v224 offset:46080
v_mfma_f32_16x16x32_bf16 v[136:139], v[220:223], v[40:43], v[136:139]
buffer_load_dwordx4 v[100:103], v224, s[4:7], s33 offen offset:1024 sc1
v_mfma_f32_16x16x32_bf16 v[152:155], v[192:195], v[40:43], v[152:155]
ds_read_b128 v[220:223], v225 offset:13312
v_mfma_f32_16x16x32_bf16 v[156:159], v[192:195], v[44:47], v[156:159]
v_mfma_f32_16x16x32_bf16 v[172:175], v[196:199], v[44:47], v[172:175]
ds_read_b128 v[192:195], v225 offset:47104
v_mfma_f32_16x16x32_bf16 v[168:171], v[196:199], v[40:43], v[168:171]
s_waitcnt vmcnt(12) lgkmcnt(4)
v_mfma_f32_16x16x32_bf16 v[128:131], v[200:203], v[48:51], v[128:131]
ds_read_b128 v[196:199], v224 offset:47104
v_mfma_f32_16x16x32_bf16 v[132:135], v[200:203], v[52:55], v[132:135]
buffer_load_dwordx4 v[104:107], v224, s[4:7], s33 offen offset:2048 sc1
v_mfma_f32_16x16x32_bf16 v[148:151], v[204:207], v[52:55], v[148:151]
ds_read_b128 v[200:203], v225 offset:14336
v_mfma_f32_16x16x32_bf16 v[144:147], v[204:207], v[48:51], v[144:147]
v_mfma_f32_16x16x32_bf16 v[160:163], v[208:211], v[48:51], v[160:163]
ds_read_b128 v[204:207], v225 offset:48128
v_mfma_f32_16x16x32_bf16 v[164:167], v[208:211], v[52:55], v[164:167]
s_waitcnt lgkmcnt(4)
v_mfma_f32_16x16x32_bf16 v[140:143], v[212:215], v[52:55], v[140:143]
ds_read_b128 v[208:211], v224 offset:48128
v_mfma_f32_16x16x32_bf16 v[136:139], v[212:215], v[48:51], v[136:139]
buffer_load_dwordx4 v[108:111], v224, s[4:7], s33 offen offset:3072 sc1
v_mfma_f32_16x16x32_bf16 v[152:155], v[216:219], v[48:51], v[152:155]
ds_read_b128 v[212:215], v225 offset:15360
v_mfma_f32_16x16x32_bf16 v[156:159], v[216:219], v[52:55], v[156:159]
buffer_load_dwordx4 v[176:179], v245, s[4:7], s27 offen offset:0 sc1
v_mfma_f32_16x16x32_bf16 v[172:175], v[220:223], v[52:55], v[172:175]
ds_read_b128 v[216:219], v225 offset:49152
v_mfma_f32_16x16x32_bf16 v[168:171], v[220:223], v[48:51], v[168:171]
s_waitcnt vmcnt(13) lgkmcnt(4)
v_mfma_f32_16x16x32_bf16 v[128:131], v[192:195], v[56:59], v[128:131]
ds_read_b128 v[220:223], v224 offset:49152
v_mfma_f32_16x16x32_bf16 v[132:135], v[192:195], v[60:63], v[132:135]
buffer_load_dwordx4 v[180:183], v245, s[4:7], s27 offen offset:512 sc1
v_mfma_f32_16x16x32_bf16 v[148:151], v[196:199], v[60:63], v[148:151]
ds_read_b128 v[192:195], v225 offset:16384
v_mfma_f32_16x16x32_bf16 v[144:147], v[196:199], v[56:59], v[144:147]
v_mfma_f32_16x16x32_bf16 v[160:163], v[200:203], v[56:59], v[160:163]
ds_read_b128 v[196:199], v225 offset:50176
s_add_u32 s33, s44, 28672
v_mfma_f32_16x16x32_bf16 v[164:167], v[200:203], v[60:63], v[164:167]
s_waitcnt lgkmcnt(4)
v_mfma_f32_16x16x32_bf16 v[140:143], v[204:207], v[60:63], v[140:143]
ds_read_b128 v[200:203], v224 offset:50176
v_mfma_f32_16x16x32_bf16 v[136:139], v[204:207], v[56:59], v[136:139]
buffer_load_dwordx4 v[112:115], v224, s[4:7], s33 offen offset:0 sc1
v_mfma_f32_16x16x32_bf16 v[152:155], v[208:211], v[56:59], v[152:155]
ds_read_b128 v[204:207], v225 offset:17408
v_mfma_f32_16x16x32_bf16 v[156:159], v[208:211], v[60:63], v[156:159]
v_mfma_f32_16x16x32_bf16 v[172:175], v[212:215], v[60:63], v[172:175]
s_barrier
ds_read_b128 v[208:211], v225 offset:51200
v_mfma_f32_16x16x32_bf16 v[168:171], v[212:215], v[56:59], v[168:171]
s_waitcnt vmcnt(13) lgkmcnt(4)
v_mfma_f32_16x16x32_bf16 v[128:131], v[216:219], v[64:67], v[128:131]
ds_read_b128 v[212:215], v224 offset:51200
v_mfma_f32_16x16x32_bf16 v[132:135], v[216:219], v[68:71], v[132:135]
buffer_load_dwordx4 v[116:119], v224, s[4:7], s33 offen offset:1024 sc1
v_mfma_f32_16x16x32_bf16 v[148:151], v[220:223], v[68:71], v[148:151]
ds_read_b128 v[216:219], v225 offset:18432
s_add_u32 m0, s41, 98304
v_mfma_f32_16x16x32_bf16 v[144:147], v[220:223], v[64:67], v[144:147]
buffer_load_dwordx4 v[120:123], v224, s[4:7], s33 offen offset:2048 sc1
v_mfma_f32_16x16x32_bf16 v[160:163], v[192:195], v[64:67], v[160:163]
ds_read_b128 v[220:223], v225 offset:52224
s_add_u32 s34, s40, 262144
v_mfma_f32_16x16x32_bf16 v[164:167], v[192:195], v[68:71], v[164:167]
s_waitcnt lgkmcnt(4)
v_mfma_f32_16x16x32_bf16 v[140:143], v[196:199], v[68:71], v[140:143]
ds_read_b128 v[192:195], v224 offset:52224
v_mfma_f32_16x16x32_bf16 v[136:139], v[196:199], v[64:67], v[136:139]
buffer_load_dwordx4 v[124:127], v224, s[4:7], s33 offen offset:3072 sc1
v_mfma_f32_16x16x32_bf16 v[152:155], v[200:203], v[64:67], v[152:155]
ds_read_b128 v[196:199], v225 offset:19456
v_mfma_f32_16x16x32_bf16 v[156:159], v[200:203], v[68:71], v[156:159]
buffer_load_dwordx4 v224, s[4:7], s34 offen offset:0 sc1 lds
v_mfma_f32_16x16x32_bf16 v[172:175], v[204:207], v[68:71], v[172:175]
ds_read_b128 v[200:203], v225 offset:53248
v_mfma_f32_16x16x32_bf16 v[168:171], v[204:207], v[64:67], v[168:171]
s_waitcnt vmcnt(15) lgkmcnt(4)
v_mfma_f32_16x16x32_bf16 v[128:131], v[208:211], v[72:75], v[128:131]
ds_read_b128 v[204:207], v224 offset:53248
v_mfma_f32_16x16x32_bf16 v[132:135], v[208:211], v[76:79], v[132:135]
buffer_load_dwordx4 v224, s[4:7], s34 offen offset:1024 sc1 lds
v_mfma_f32_16x16x32_bf16 v[148:151], v[212:215], v[76:79], v[148:151]
ds_read_b128 v[208:211], v225 offset:20480
v_mfma_f32_16x16x32_bf16 v[144:147], v[212:215], v[72:75], v[144:147]
v_mfma_f32_16x16x32_bf16 v[160:163], v[216:219], v[72:75], v[160:163]
ds_read_b128 v[212:215], v225 offset:54272
v_and_b32 v254, 0xf0, v224
v_mfma_f32_16x16x32_bf16 v[164:167], v[216:219], v[76:79], v[164:167]
v_bfe_u32 v255, v240, 4, 1
s_waitcnt lgkmcnt(4)
v_mfma_f32_16x16x32_bf16 v[140:143], v[220:223], v[76:79], v[140:143]
ds_read_b128 v[216:219], v224 offset:54272
v_lshl_add_u32 v254, v255, 3, v254
v_mfma_f32_16x16x32_bf16 v[136:139], v[220:223], v[72:75], v[136:139]
buffer_load_dwordx4 v224, s[4:7], s34 offen offset:2048 sc1 lds
v_mfma_f32_16x16x32_bf16 v[152:155], v[192:195], v[72:75], v[152:155]
ds_read_b128 v[220:223], v225 offset:21504
v_lshrrev_b32 v255, 5, v240
v_mfma_f32_16x16x32_bf16 v[156:159], v[192:195], v[76:79], v[156:159]
v_lshl_add_u32 v254, v255, 8, v254
s_and_b32 s32, s22, 1
v_mfma_f32_16x16x32_bf16 v[172:175], v[196:199], v[76:79], v[172:175]
ds_read_b128 v[192:195], v225 offset:55296
s_mul_i32 s32, s32, 5632
v_mfma_f32_16x16x32_bf16 v[168:171], v[196:199], v[72:75], v[168:171]
s_sub_u32 s32, s45, s32
s_waitcnt vmcnt(15) lgkmcnt(4)
v_mfma_f32_16x16x32_bf16 v[128:131], v[200:203], v[80:83], v[128:131]
ds_read_b128 v[196:199], v224 offset:55296
s_add_u32 s53, s25, 0
v_mfma_f32_16x16x32_bf16 v[132:135], v[200:203], v[84:87], v[132:135]
v_mov_b32 v228, s53
s_add_u32 s32, s32, 5120
v_mfma_f32_16x16x32_bf16 v[148:151], v[204:207], v[84:87], v[148:151]
ds_read_b128 v[200:203], v225 offset:22528
v_mfma_f32_16x16x32_bf16 v[144:147], v[204:207], v[80:83], v[144:147]
buffer_load_dwordx4 v224, s[4:7], s34 offen offset:3072 sc1 lds
v_mfma_f32_16x16x32_bf16 v[160:163], v[208:211], v[80:83], v[160:163]
ds_read_b128 v[204:207], v225 offset:56320
s_add_u32 m0, s41, 32768
v_mfma_f32_16x16x32_bf16 v[164:167], v[208:211], v[84:87], v[164:167]
s_add_u32 s34, s36, 196608
s_waitcnt lgkmcnt(4)
v_mfma_f32_16x16x32_bf16 v[140:143], v[212:215], v[84:87], v[140:143]
ds_read_b128 v[208:211], v224 offset:56320
v_mfma_f32_16x16x32_bf16 v[136:139], v[212:215], v[80:83], v[136:139]
buffer_load_dwordx4 v224, s[4:7], s34 offen offset:0 sc1 lds
v_mfma_f32_16x16x32_bf16 v[152:155], v[216:219], v[80:83], v[152:155]
ds_read_b128 v[212:215], v225 offset:23552
v_mfma_f32_16x16x32_bf16 v[156:159], v[216:219], v[84:87], v[156:159]
v_mfma_f32_16x16x32_bf16 v[172:175], v[220:223], v[84:87], v[172:175]
ds_read_b128 v[216:219], v225 offset:57344
v_mfma_f32_16x16x32_bf16 v[168:171], v[220:223], v[80:83], v[168:171]
s_waitcnt vmcnt(15) lgkmcnt(4)
v_mfma_f32_16x16x32_bf16 v[128:131], v[192:195], v[88:91], v[128:131]
ds_read_b128 v[220:223], v224 offset:57344
v_mfma_f32_16x16x32_bf16 v[132:135], v[192:195], v[92:95], v[132:135]
buffer_load_dwordx4 v224, s[4:7], s34 offen offset:1024 sc1 lds
v_mfma_f32_16x16x32_bf16 v[148:151], v[196:199], v[92:95], v[148:151]
ds_read_b128 v[192:195], v225 offset:24576
v_mfma_f32_16x16x32_bf16 v[144:147], v[196:199], v[88:91], v[144:147]
v_mfma_f32_16x16x32_bf16 v[160:163], v[200:203], v[88:91], v[160:163]
ds_read_b128 v[196:199], v225 offset:58368
v_mfma_f32_16x16x32_bf16 v[164:167], v[200:203], v[92:95], v[164:167]
s_waitcnt lgkmcnt(4)
v_mfma_f32_16x16x32_bf16 v[140:143], v[204:207], v[92:95], v[140:143]
ds_read_b128 v[200:203], v224 offset:58368
v_mfma_f32_16x16x32_bf16 v[136:139], v[204:207], v[88:91], v[136:139]
v_mfma_f32_16x16x32_bf16 v[152:155], v[208:211], v[88:91], v[152:155]
ds_read_b128 v[204:207], v225 offset:25600
v_mfma_f32_16x16x32_bf16 v[156:159], v[208:211], v[92:95], v[156:159]
buffer_load_dwordx4 v224, s[4:7], s34 offen offset:2048 sc1 lds
v_mfma_f32_16x16x32_bf16 v[172:175], v[212:215], v[92:95], v[172:175]
ds_read_b128 v[208:211], v225 offset:59392
v_mfma_f32_16x16x32_bf16 v[168:171], v[212:215], v[88:91], v[168:171]
s_waitcnt vmcnt(15) lgkmcnt(4)
v_mfma_f32_16x16x32_bf16 v[128:131], v[216:219], v[96:99], v[128:131]
ds_read_b128 v[212:215], v224 offset:59392
v_mfma_f32_16x16x32_bf16 v[132:135], v[216:219], v[100:103], v[132:135]
s_waitcnt vmcnt(11)
v_xor_b32 v184, 1, v177
v_xor_b32 v185, 1, v179
v_xor_b32 v186, 1, v181
v_xor_b32 v187, 1, v183
v_or3_b32 v184, v184, v185, v186
v_or_b32 v184, v184, v187
v_and_b32 v184, 3, v184
v_cmp_ne_u32 vcc, 0, v184
s_cbranch_vccnz TR_38
TJ_40:
v_mfma_f32_16x16x32_bf16 v[148:151], v[220:223], v[100:103], v[148:151]
ds_read_b128 v[216:219], v225 offset:26624
v_add_f32 v176, v176, v180
v_mfma_f32_16x16x32_bf16 v[144:147], v[220:223], v[96:99], v[144:147]
v_add_f32 v177, v177, v181
v_add_f32 v178, v178, v182
v_mfma_f32_16x16x32_bf16 v[160:163], v[192:195], v[96:99], v[160:163]
ds_read_b128 v[220:223], v225 offset:60416
v_add_f32 v179, v179, v183
v_mfma_f32_16x16x32_bf16 v[164:167], v[192:195], v[100:103], v[164:167]
v_add_f32_dpp v176, v176, v176 quad_perm:[1,0,3,2] row_mask:0xf bank_mask:0xf
s_waitcnt lgkmcnt(4)
v_mfma_f32_16x16x32_bf16 v[140:143], v[196:199], v[100:103], v[140:143]
ds_read_b128 v[192:195], v224 offset:60416
v_add_f32_dpp v177, v177, v177 quad_perm:[1,0,3,2] row_mask:0xf bank_mask:0xf
v_mfma_f32_16x16x32_bf16 v[136:139], v[196:199], v[96:99], v[136:139]
buffer_load_dwordx4 v224, s[4:7], s34 offen offset:3072 sc1 lds
v_mfma_f32_16x16x32_bf16 v[152:155], v[200:203], v[96:99], v[152:155]
ds_read_b128 v[196:199], v225 offset:27648
v_add_f32_dpp v178, v178, v178 quad_perm:[1,0,3,2] row_mask:0xf bank_mask:0xf
v_mfma_f32_16x16x32_bf16 v[156:159], v[200:203], v[100:103], v[156:159]
v_add_f32_dpp v179, v179, v179 quad_perm:[1,0,3,2] row_mask:0xf bank_mask:0xf
v_cndmask_b32 v176, v176, v178, s[64:65]
v_mfma_f32_16x16x32_bf16 v[172:175], v[204:207], v[100:103], v[172:175]
ds_read_b128 v[200:203], v225 offset:61440
s_add_u32 m0, s41, 65536
v_mfma_f32_16x16x32_bf16 v[168:171], v[204:207], v[96:99], v[168:171]
s_add_u32 s34, s36, 212992
s_waitcnt lgkmcnt(4)
v_mfma_f32_16x16x32_bf16 v[128:131], v[208:211], v[104:107], v[128:131]
ds_read_b128 v[204:207], v224 offset:61440
v_cndmask_b32 v177, v177, v179, s[64:65]
v_mfma_f32_16x16x32_bf16 v[132:135], v[208:211], v[108:111], v[132:135]
buffer_load_dwordx4 v224, s[4:7], s34 offen offset:0 sc1 lds
v_mfma_f32_16x16x32_bf16 v[148:151], v[212:215], v[108:111], v[148:151]
ds_read_b128 v[208:211], v225 offset:28672
v_mov_b32 v178, v176
v_mfma_f32_16x16x32_bf16 v[144:147], v[212:215], v[104:107], v[144:147]
v_mov_b32 v179, v177
s_mov_b32 s35, 0x3b000000
v_mfma_f32_16x16x32_bf16 v[160:163], v[216:219], v[104:107], v[160:163]
ds_read_b128 v[212:215], v225 offset:62464
v_permlane32_swap_b32 v176, v178
v_mfma_f32_16x16x32_bf16 v[164:167], v[216:219], v[108:111], v[164:167]
v_permlane32_swap_b32 v177, v179
s_waitcnt lgkmcnt(4)
v_mfma_f32_16x16x32_bf16 v[140:143], v[220:223], v[108:111], v[140:143]
ds_read_b128 v[216:219], v224 offset:62464
v_add_f32 v176, v176, v178
v_mfma_f32_16x16x32_bf16 v[136:139], v[220:223], v[104:107], v[136:139]
v_add_f32 v177, v177, v179
v_mul_f32 v176, 0xbb000000, v176
v_mfma_f32_16x16x32_bf16 v[152:155], v[192:195], v[104:107], v[152:155]
ds_read_b128 v[220:223], v225 offset:29696
v_mul_f32 v178, v176, v176
v_mfma_f32_16x16x32_bf16 v[156:159], v[192:195], v[108:111], v[156:159]
buffer_load_dwordx4 v224, s[4:7], s34 offen offset:1024 sc1 lds
v_mfma_f32_16x16x32_bf16 v[172:175], v[196:199], v[108:111], v[172:175]
ds_read_b128 v[192:195], v225 offset:63488
v_fma_f32 v177, v177, s35, -v178
v_mfma_f32_16x16x32_bf16 v[168:171], v[196:199], v[104:107], v[168:171]
v_cvt_pk_bf16_f32 v179, v176, v176
s_waitcnt vmcnt(12) lgkmcnt(4)
v_mfma_f32_16x16x32_bf16 v[128:131], v[200:203], v[112:115], v[128:131]
ds_read_b128 v[196:199], v224 offset:63488
v_max_f32 v177, 0, v177
v_mfma_f32_16x16x32_bf16 v[132:135], v[200:203], v[116:119], v[132:135]
v_and_b32 v180, 0xffff0000, v179
v_add_f32 v177, 0x3727c5ac, v177
v_mfma_f32_16x16x32_bf16 v[148:151], v[204:207], v[116:119], v[148:151]
ds_read_b128 v[200:203], v225 offset:30720
v_sub_f32 v180, v176, v180
v_mfma_f32_16x16x32_bf16 v[144:147], v[204:207], v[112:115], v[144:147]
v_rcp_f32 v236, v177
v_mfma_f32_16x16x32_bf16 v[160:163], v[208:211], v[112:115], v[160:163]
ds_read_b128 v[204:207], v225 offset:64512
v_cvt_pk_bf16_f32 v180, v180, v180
v_mfma_f32_16x16x32_bf16 v[164:167], v[208:211], v[116:119], v[164:167]
s_lshl_b32 s35, s20, 7
s_waitcnt lgkmcnt(4)
v_mfma_f32_16x16x32_bf16 v[140:143], v[212:215], v[116:119], v[140:143]
ds_read_b128 v[208:211], v224 offset:64512
v_mov_b32 v229, 0
v_mfma_f32_16x16x32_bf16 v[136:139], v[212:215], v[112:115], v[136:139]
buffer_load_dwordx4 v224, s[4:7], s34 offen offset:2048 sc1 lds
v_mfma_f32_16x16x32_bf16 v[152:155], v[216:219], v[112:115], v[152:155]
ds_read_b128 v[212:215], v225 offset:31744
v_add_u32 v181, s35, v226
v_mfma_f32_16x16x32_bf16 v[156:159], v[216:219], v[116:119], v[156:159]
v_cndmask_b32 v232, v179, v180, s[56:57]
v_mfma_f32_16x16x32_bf16 v[172:175], v[220:223], v[116:119], v[172:175]
ds_read_b32 v216, v226 offset:512
v_mfma_f32_16x16x32_bf16 v[168:171], v[220:223], v[112:115], v[168:171]
s_waitcnt vmcnt(11) lgkmcnt(4)
v_mfma_f32_16x16x32_bf16 v[128:131], v[192:195], v[120:123], v[128:131]
ds_read_b32 v220, v226 offset:640
v_mfma_f32_16x16x32_bf16 v[132:135], v[192:195], v[124:127], v[132:135]
buffer_load_dwordx4 v224, s[4:7], s34 offen offset:3072 sc1 lds
v_mfma_f32_16x16x32_bf16 v[148:151], v[196:199], v[124:127], v[148:151]
ds_read_b32 v192, v226 offset:768
v_mfma_f32_16x16x32_bf16 v[144:147], v[196:199], v[120:123], v[144:147]
ds_write_b32 v181, v236 offset:1344
s_branch L_SK3
L_ST3:
s_setpc_b64 s[10:11]
L_SK3:
v_mfma_f32_16x16x32_bf16 v[160:163], v[200:203], v[120:123], v[160:163]
ds_read_b32 v196, v226 offset:576
v_mov_b32 v251, 0
v_mfma_f32_16x16x32_bf16 v[164:167], v[200:203], v[124:127], v[164:167]
v_mov_b32 v252, 0
s_waitcnt lgkmcnt(5)
v_mfma_f32_16x16x32_bf16 v[140:143], v[204:207], v[124:127], v[140:143]
ds_read_b32 v200, v226 offset:704
v_mov_b32 v253, 0
v_mfma_f32_16x16x32_bf16 v[136:139], v[204:207], v[120:123], v[136:139]
v_permlane16_swap_b32 v232, v229
v_mov_b32 v250, v229
v_mfma_f32_16x16x32_bf16 v[152:155], v[208:211], v[120:123], v[152:155]
ds_read_b32 v204, v226 offset:832
v_mfma_f32_16x16x32_bf16 v[156:159], v[208:211], v[124:127], v[156:159]
v_mfma_f32_16x16x32_bf16 v[172:175], v[212:215], v[124:127], v[172:175]
s_waitcnt vmcnt(8)
s_barrier
ds_read_b128 v[208:211], v225 offset:32768
v_mfma_f32_16x16x32_bf16 v[168:171], v[212:215], v[120:123], v[168:171]
s_waitcnt lgkmcnt(5)
v_mfma_f32_16x16x32_bf16 v[128:131], v[216:219], v[232:235], v[128:131]
ds_read_b128 v[212:215], v225 offset:33792
v_mfma_f32_16x16x32_bf16 v[132:135], v[216:219], v[250:253], v[132:135]
v_mfma_f32_16x16x32_bf16 v[148:151], v[220:223], v[250:253], v[148:151]
ds_read_b128 v[216:219], v225 offset:34816
v_mfma_f32_16x16x32_bf16 v[144:147], v[220:223], v[232:235], v[144:147]
v_mfma_f32_16x16x32_bf16 v[160:163], v[192:195], v[232:235], v[160:163]
ds_read_b128 v[220:223], v225 offset:35840
v_mfma_f32_16x16x32_bf16 v[164:167], v[192:195], v[250:253], v[164:167]
s_waitcnt lgkmcnt(4)
v_mfma_f32_16x16x32_bf16 v[140:143], v[196:199], v[250:253], v[140:143]
ds_read_b128 v[192:195], v225 offset:36864
v_mfma_f32_16x16x32_bf16 v[136:139], v[196:199], v[232:235], v[136:139]
v_mfma_f32_16x16x32_bf16 v[152:155], v[200:203], v[232:235], v[152:155]
ds_read_b128 v[196:199], v225 offset:37888
v_mfma_f32_16x16x32_bf16 v[156:159], v[200:203], v[250:253], v[156:159]
v_mfma_f32_16x16x32_bf16 v[172:175], v[204:207], v[250:253], v[172:175]
ds_read_b128 v[200:203], v225 offset:38912
v_mfma_f32_16x16x32_bf16 v[168:171], v[204:207], v[232:235], v[168:171]
s_waitcnt lgkmcnt(4)
v_mfma_f32_16x16x32_bf16 v[176:179], v[208:211], v[0:3], 0
s_barrier
ds_read_b128 v[204:207], v225 offset:39936
v_mfma_f32_16x16x32_bf16 v[180:183], v[208:211], v[4:7], 0
v_mfma_f32_16x16x32_bf16 v[180:183], v[212:215], v[12:15], v[180:183]
ds_read_b128 v[208:211], v225 offset:40960
s_add_u32 m0, s41, 49152
v_mfma_f32_16x16x32_bf16 v[176:179], v[212:215], v[8:11], v[176:179]
s_add_u32 s34, s36, 229376
v_max_f32 v128, 0, v128
v_mfma_f32_16x16x32_bf16 v[176:179], v[216:219], v[16:19], v[176:179]
ds_read_b128 v[212:215], v225 offset:41984
v_max_f32 v129, 0, v129
v_mfma_f32_16x16x32_bf16 v[180:183], v[216:219], v[20:23], v[180:183]
v_max_f32 v130, 0, v130
s_waitcnt lgkmcnt(4)
v_mfma_f32_16x16x32_bf16 v[180:183], v[220:223], v[28:31], v[180:183]
ds_read_b128 v[216:219], v225 offset:43008
v_max_f32 v131, 0, v131
v_mfma_f32_16x16x32_bf16 v[176:179], v[220:223], v[24:27], v[176:179]
buffer_load_dwordx4 v224, s[4:7], s34 offen offset:0 sc1 lds
v_mfma_f32_16x16x32_bf16 v[176:179], v[192:195], v[32:35], v[176:179]
ds_read_b128 v[220:223], v225 offset:44032
v_max_f32 v132, 0, v132
v_mfma_f32_16x16x32_bf16 v[180:183], v[192:195], v[36:39], v[180:183]
v_max_f32 v133, 0, v133
v_max_f32 v134, 0, v134
v_mfma_f32_16x16x32_bf16 v[180:183], v[196:199], v[44:47], v[180:183]
ds_read_b128 v[192:195], v225 offset:45056
v_max_f32 v135, 0, v135
v_mfma_f32_16x16x32_bf16 v[176:179], v[196:199], v[40:43], v[176:179]
v_mul_f32 v128, v128, v136
s_waitcnt lgkmcnt(4)
v_mfma_f32_16x16x32_bf16 v[176:179], v[200:203], v[48:51], v[176:179]
ds_read_b128 v[196:199], v225 offset:46080
v_mul_f32 v129, v129, v137
v_mfma_f32_16x16x32_bf16 v[180:183], v[200:203], v[52:55], v[180:183]
buffer_load_dwordx4 v224, s[4:7], s34 offen offset:1024 sc1 lds
v_mfma_f32_16x16x32_bf16 v[180:183], v[204:207], v[60:63], v[180:183]
ds_read_b128 v[200:203], v225 offset:47104
v_mul_f32 v130, v130, v138
v_mfma_f32_16x16x32_bf16 v[176:179], v[204:207], v[56:59], v[176:179]
v_mul_f32 v131, v131, v139
v_mul_f32 v132, v132, v140
v_mfma_f32_16x16x32_bf16 v[176:179], v[208:211], v[64:67], v[176:179]
ds_read_b128 v[204:207], v225 offset:48128
v_mul_f32 v133, v133, v141
v_mfma_f32_16x16x32_bf16 v[180:183], v[208:211], v[68:71], v[180:183]
v_mul_f32 v134, v134, v142
s_waitcnt lgkmcnt(4)
v_mfma_f32_16x16x32_bf16 v[180:183], v[212:215], v[76:79], v[180:183]
ds_read_b32 v208, v226 offset:1152
v_mul_f32 v135, v135, v143
v_mfma_f32_16x16x32_bf16 v[176:179], v[212:215], v[72:75], v[176:179]
v_add_u32 v128, 0x10000, v128
v_and_b32 v128, 0xfffe0000, v128
v_mfma_f32_16x16x32_bf16 v[176:179], v[216:219], v[80:83], v[176:179]
s_waitcnt vmcnt(2)
s_barrier
ds_read_b128 v[212:215], v224 offset:32768
v_mfma_f32_16x16x32_bf16 v[180:183], v[216:219], v[84:87], v[180:183]
buffer_load_dwordx4 v224, s[4:7], s34 offen offset:2048 sc1 lds
v_mfma_f32_16x16x32_bf16 v[180:183], v[220:223], v[92:95], v[180:183]
ds_read_b128 v[216:219], v224 offset:33792
v_add_u32 v132, 0x10000, v132
v_mfma_f32_16x16x32_bf16 v[176:179], v[220:223], v[88:91], v[176:179]
v_and_b32 v132, 0xfffe0000, v132
s_waitcnt lgkmcnt(4)
v_mfma_f32_16x16x32_bf16 v[176:179], v[192:195], v[96:99], v[176:179]
ds_read_b128 v[220:223], v224 offset:34816
v_cvt_pk_bf16_f32 v136, v128, v129
v_mfma_f32_16x16x32_bf16 v[180:183], v[192:195], v[100:103], v[180:183]
v_cvt_pk_bf16_f32 v138, v132, v133
v_cvt_pk_bf16_f32 v137, v130, v131
v_mfma_f32_16x16x32_bf16 v[180:183], v[196:199], v[108:111], v[180:183]
ds_read_b128 v[192:195], v224 offset:35840
v_cvt_pk_bf16_f32 v139, v134, v135
v_mfma_f32_16x16x32_bf16 v[176:179], v[196:199], v[104:107], v[176:179]
v_permlane16_swap_b32 v136, v138
v_permlane16_swap_b32 v137, v139
v_mfma_f32_16x16x32_bf16 v[176:179], v[200:203], v[112:115], v[176:179]
ds_read_b128 v[196:199], v224 offset:36864
v_and_b32 v136, -2, v136
v_mfma_f32_16x16x32_bf16 v[180:183], v[200:203], v[116:119], v[180:183]
s_waitcnt lgkmcnt(4)
v_mfma_f32_16x16x32_bf16 v[180:183], v[204:207], v[124:127], v[180:183]
ds_read_b128 v[200:203], v224 offset:37888
v_mfma_f32_16x16x32_bf16 v[176:179], v[204:207], v[120:123], v[176:179]
buffer_load_dwordx4 v224, s[4:7], s34 offen offset:3072 sc1 lds
buffer_store_dwordx4 v[136:139], v224, s[4:7], s45 offen offset:0
v_mfma_f32_16x16x32_bf16 v[176:179], v[208:211], v[232:235], v[176:179]
ds_read_b128 v[204:207], v224 offset:38912
v_max_f32 v144, 0, v144
v_mfma_f32_16x16x32_bf16 v[180:183], v[208:211], v[250:253], v[180:183]
v_max_f32 v145, 0, v145
s_waitcnt lgkmcnt(4)
v_mfma_f32_16x16x32_bf16 v[132:135], v[212:215], v[4:7], 0
ds_read_b128 v[208:211], v224 offset:39936
s_add_u32 m0, s41, 81920
v_mfma_f32_16x16x32_bf16 v[128:131], v[212:215], v[0:3], 0
s_add_u32 s34, s36, 245760
v_max_f32 v146, 0, v146
v_mfma_f32_16x16x32_bf16 v[136:139], v[216:219], v[0:3], 0
ds_read_b128 v[212:215], v224 offset:40960
v_max_f32 v147, 0, v147
v_mfma_f32_16x16x32_bf16 v[140:143], v[216:219], v[4:7], 0
buffer_load_dwordx4 v224, s[4:7], s34 offen offset:0 sc1 lds
v_mfma_f32_16x16x32_bf16 v[132:135], v[220:223], v[12:15], v[132:135]
ds_read_b128 v[216:219], v224 offset:41984
v_max_f32 v148, 0, v148
v_mfma_f32_16x16x32_bf16 v[128:131], v[220:223], v[8:11], v[128:131]
v_max_f32 v149, 0, v149
s_waitcnt lgkmcnt(4)
v_mfma_f32_16x16x32_bf16 v[136:139], v[192:195], v[8:11], v[136:139]
ds_read_b128 v[220:223], v224 offset:43008
v_max_f32 v150, 0, v150
v_mfma_f32_16x16x32_bf16 v[140:143], v[192:195], v[12:15], v[140:143]
v_max_f32 v151, 0, v151
v_mul_f32 v144, v144, v152
v_mfma_f32_16x16x32_bf16 v[132:135], v[196:199], v[20:23], v[132:135]
ds_read_b128 v[192:195], v224 offset:44032
v_mul_f32 v145, v145, v153
v_mfma_f32_16x16x32_bf16 v[128:131], v[196:199], v[16:19], v[128:131]
v_mul_f32 v146, v146, v154
v_mul_f32 v147, v147, v155
v_mfma_f32_16x16x32_bf16 v[136:139], v[200:203], v[16:19], v[136:139]
ds_read_b128 v[196:199], v224 offset:45056
v_mul_f32 v148, v148, v156
v_mfma_f32_16x16x32_bf16 v[140:143], v[200:203], v[20:23], v[140:143]
v_mul_f32 v149, v149, v157
v_mul_f32_e64 v150, v150, v158
v_mul_f32 v151, v151, v159
v_add_u32 v144, 0x10000, v144
v_and_b32 v144, 0xfffe0000, v144
v_add_u32 v148, 0x10000, v148
v_and_b32 v148, 0xfffe0000, v148
v_cvt_pk_bf16_f32 v152, v144, v145
v_cvt_pk_bf16_f32 v154, v148, v149
v_cvt_pk_bf16_f32 v153, v146, v147
v_cvt_pk_bf16_f32 v155, v150, v151
v_permlane16_swap_b32 v152, v154
s_nop 0
v_permlane16_swap_b32 v153, v155
v_and_b32 v152, -2, v152
buffer_store_dwordx4 v[152:155], v224, s[4:7], s45 offen offset:1024
s_waitcnt lgkmcnt(4)
v_mfma_f32_16x16x32_bf16 v[132:135], v[204:207], v[28:31], v[132:135]
ds_read_b128 v[200:203], v224 offset:46080
v_max_f32 v160, 0, v160
v_mfma_f32_16x16x32_bf16 v[128:131], v[204:207], v[24:27], v[128:131]
buffer_load_dwordx4 v224, s[4:7], s34 offen offset:1024 sc1 lds
v_mfma_f32_16x16x32_bf16 v[136:139], v[208:211], v[24:27], v[136:139]
ds_read_b128 v[204:207], v224 offset:47104
v_max_f32 v161, 0, v161
v_mfma_f32_16x16x32_bf16 v[140:143], v[208:211], v[28:31], v[140:143]
v_max_f32 v162, 0, v162
v_max_f32 v163, 0, v163
v_mfma_f32_16x16x32_bf16 v[132:135], v[212:215], v[36:39], v[132:135]
ds_read_b128 v[208:211], v224 offset:48128
v_max_f32 v164, 0, v164
v_mfma_f32_16x16x32_bf16 v[128:131], v[212:215], v[32:35], v[128:131]
v_max_f32 v165, 0, v165
s_waitcnt lgkmcnt(4)
v_mfma_f32_16x16x32_bf16 v[136:139], v[216:219], v[32:35], v[136:139]
ds_read_b128 v[212:215], v225 offset:0
v_max_f32 v166, 0, v166
v_mfma_f32_16x16x32_bf16 v[140:143], v[216:219], v[36:39], v[140:143]
buffer_load_dwordx4 v224, s[4:7], s34 offen offset:2048 sc1 lds
v_mfma_f32_16x16x32_bf16 v[132:135], v[220:223], v[44:47], v[132:135]
ds_read_b128 v[216:219], v225 offset:1024
v_max_f32 v167, 0, v167
v_mfma_f32_16x16x32_bf16 v[128:131], v[220:223], v[40:43], v[128:131]
v_mul_f32 v160, v160, v168
v_mul_f32 v161, v161, v169
v_mfma_f32_16x16x32_bf16 v[136:139], v[192:195], v[40:43], v[136:139]
ds_read_b128 v[220:223], v225 offset:2048
v_mul_f32 v162, v162, v170
v_mfma_f32_16x16x32_bf16 v[140:143], v[192:195], v[44:47], v[140:143]
v_mul_f32 v163, v163, v171
s_waitcnt lgkmcnt(4)
v_mfma_f32_16x16x32_bf16 v[132:135], v[196:199], v[52:55], v[132:135]
ds_read_b128 v[192:195], v225 offset:3072
v_mul_f32 v164, v164, v172
v_mfma_f32_16x16x32_bf16 v[128:131], v[196:199], v[48:51], v[128:131]
v_mul_f32 v165, v165, v173
v_mul_f32 v166, v166, v174
v_mfma_f32_16x16x32_bf16 v[136:139], v[200:203], v[48:51], v[136:139]
ds_read_b128 v[196:199], v225 offset:4096
v_mul_f32 v167, v167, v175
v_mfma_f32_16x16x32_bf16 v[140:143], v[200:203], v[52:55], v[140:143]
buffer_load_dwordx4 v224, s[4:7], s34 offen offset:3072 sc1 lds
v_mfma_f32_16x16x32_bf16 v[132:135], v[204:207], v[60:63], v[132:135]
ds_read_b128 v[200:203], v225 offset:5120
v_cvt_pk_bf16_f32 v168, v160, v161
v_mfma_f32_16x16x32_bf16 v[128:131], v[204:207], v[56:59], v[128:131]
v_cvt_pk_bf16_f32 v170, v164, v165
s_waitcnt lgkmcnt(4)
v_mfma_f32_16x16x32_bf16 v[136:139], v[208:211], v[56:59], v[136:139]
ds_read_b128 v[204:207], v225 offset:6144
v_cvt_pk_bf16_f32 v169, v162, v163
v_mfma_f32_16x16x32_bf16 v[140:143], v[208:211], v[60:63], v[140:143]
v_cvt_pk_bf16_f32 v171, v166, v167
v_permlane16_swap_b32 v168, v170
v_mfma_f32_16x16x32_bf16 v[132:135], v[212:215], v[68:71], v[132:135]
ds_read_b128 v[208:211], v225 offset:7168
s_add_u32 m0, s41, 114688
v_mfma_f32_16x16x32_bf16 v[128:131], v[212:215], v[64:67], v[128:131]
s_add_u32 s34, s36, 32768
v_permlane16_swap_b32 v169, v171
v_mfma_f32_16x16x32_bf16 v[136:139], v[216:219], v[64:67], v[136:139]
ds_read_b128 v[212:215], v225 offset:8192
v_mfma_f32_16x16x32_bf16 v[140:143], v[216:219], v[68:71], v[140:143]
s_waitcnt lgkmcnt(4)
v_mfma_f32_16x16x32_bf16 v[132:135], v[220:223], v[76:79], v[132:135]
ds_read_b128 v[216:219], v225 offset:9216
v_mfma_f32_16x16x32_bf16 v[128:131], v[220:223], v[72:75], v[128:131]
buffer_load_dwordx4 v224, s[4:7], s34 offen offset:0 sc1 lds
v_mfma_f32_16x16x32_bf16 v[136:139], v[192:195], v[72:75], v[136:139]
ds_read_b128 v[220:223], v225 offset:10240
v_mfma_f32_16x16x32_bf16 v[140:143], v[192:195], v[76:79], v[140:143]
buffer_store_dwordx4 v[168:171], v224, s[4:7], s45 offen offset:2048 sc1
v_mfma_f32_16x16x32_bf16 v[132:135], v[196:199], v[84:87], v[132:135]
ds_read_b128 v[192:195], v225 offset:11264
v_permlane32_swap_b32 v176, v180
v_mfma_f32_16x16x32_bf16 v[128:131], v[196:199], v[80:83], v[128:131]
v_permlane32_swap_b32 v177, v181
s_waitcnt lgkmcnt(4)
v_mfma_f32_16x16x32_bf16 v[136:139], v[200:203], v[80:83], v[136:139]
ds_read_b128 v[196:199], v225 offset:12288
v_permlane32_swap_b32 v178, v182
v_mfma_f32_16x16x32_bf16 v[140:143], v[200:203], v[84:87], v[140:143]
buffer_load_dwordx4 v224, s[4:7], s34 offen offset:1024 sc1 lds
v_mfma_f32_16x16x32_bf16 v[132:135], v[204:207], v[92:95], v[132:135]
ds_read_b128 v[200:203], v225 offset:13312
v_permlane32_swap_b32 v179, v183
v_mfma_f32_16x16x32_bf16 v[128:131], v[204:207], v[88:91], v[128:131]
s_cmp_lg_u32 s26, 0
s_waitcnt vmcnt(6)
s_cbranch_scc0 SS_41
buffer_store_dword v228, v241, s[4:7], s49 offen offset:32
SJ_42:
v_mfma_f32_16x16x32_bf16 v[136:139], v[208:211], v[88:91], v[136:139]
ds_read_b128 v[204:207], v225 offset:14336
v_max_f32 v176, 0, v176
v_mfma_f32_16x16x32_bf16 v[140:143], v[208:211], v[92:95], v[140:143]
v_max_f32 v177, 0, v177
s_waitcnt lgkmcnt(4)
v_mfma_f32_16x16x32_bf16 v[132:135], v[212:215], v[100:103], v[132:135]
ds_read_b128 v[208:211], v225 offset:15360
v_max_f32 v178, 0, v178
v_mfma_f32_16x16x32_bf16 v[128:131], v[212:215], v[96:99], v[128:131]
v_max_f32 v179, 0, v179
v_mul_f32 v176, v176, v180
v_mfma_f32_16x16x32_bf16 v[136:139], v[216:219], v[96:99], v[136:139]
ds_read_b32 v212, v226 offset:896
v_mul_f32 v177, v177, v181
v_mfma_f32_16x16x32_bf16 v[140:143], v[216:219], v[100:103], v[140:143]
buffer_load_dwordx4 v224, s[4:7], s34 offen offset:2048 sc1 lds
v_mfma_f32_16x16x32_bf16 v[132:135], v[220:223], v[108:111], v[132:135]
ds_read_b32 v216, v226 offset:960
v_mul_f32 v178, v178, v182
v_mfma_f32_16x16x32_bf16 v[128:131], v[220:223], v[104:107], v[128:131]
v_mul_f32 v179, v179, v183
s_waitcnt lgkmcnt(4)
v_mfma_f32_16x16x32_bf16 v[136:139], v[192:195], v[104:107], v[136:139]
s_barrier
ds_read_b128 v[220:223], v224 offset:49152
v_mfma_f32_16x16x32_bf16 v[140:143], v[192:195], v[108:111], v[140:143]
v_cvt_pk_bf16_f32 v180, v176, v177
v_cvt_pk_bf16_f32 v181, v178, v179
v_mfma_f32_16x16x32_bf16 v[132:135], v[196:199], v[116:119], v[132:135]
ds_read_b128 v[192:195], v224 offset:50176
v_mfma_f32_16x16x32_bf16 v[128:131], v[196:199], v[112:115], v[128:131]
buffer_store_dwordx2 v[180:181], v254, s[4:7], s32 offen sc1
v_mfma_f32_16x16x32_bf16 v[136:139], v[200:203], v[112:115], v[136:139]
ds_read_b128 v[196:199], v224 offset:51200
v_lshrrev_b32 v229, 5, v240
v_mfma_f32_16x16x32_bf16 v[140:143], v[200:203], v[116:119], v[140:143]
v_mul_u32_u24 v229, 12288, v229
s_waitcnt lgkmcnt(4)
v_mfma_f32_16x16x32_bf16 v[132:135], v[204:207], v[124:127], v[132:135]
ds_read_b128 v[200:203], v224 offset:52224
v_bfe_u32 v230, v240, 4, 1
v_mfma_f32_16x16x32_bf16 v[128:131], v[204:207], v[120:123], v[128:131]
buffer_load_dwordx4 v224, s[4:7], s34 offen offset:3072 sc1 lds
v_mfma_f32_16x16x32_bf16 v[136:139], v[208:211], v[120:123], v[136:139]
ds_read_b128 v[204:207], v224 offset:53248
v_lshl_add_u32 v229, v230, 9, v229
v_mfma_f32_16x16x32_bf16 v[140:143], v[208:211], v[124:127], v[140:143]
v_and_b32 v230, 0xf0, v224
s_bfe_u32 s35, s41, 0x90004
v_mfma_f32_16x16x32_bf16 v[132:135], v[212:215], v[250:253], v[132:135]
ds_read_b128 v[208:211], v224 offset:54272
v_add3_u32 v229, v229, v230, s35
v_mfma_f32_16x16x32_bf16 v[128:131], v[212:215], v[232:235], v[128:131]
s_waitcnt lgkmcnt(4)
v_xor_b32 v230, 0x100, v229
v_mfma_f32_16x16x32_bf16 v[136:139], v[216:219], v[232:235], v[136:139]
ds_read_b128 v[212:215], v224 offset:55296
v_mfma_f32_16x16x32_bf16 v[140:143], v[216:219], v[250:253], v[140:143]
s_waitcnt lgkmcnt(4)
v_mfma_f32_16x16x32_bf16 v[148:151], v[220:223], v[4:7], 0
ds_read_b128 v[216:219], v224 offset:56320
v_mfma_f32_16x16x32_bf16 v[144:147], v[220:223], v[0:3], 0
buffer_load_dword v227, v226, s[4:7], s51 offen sc1
v_mfma_f32_16x16x32_bf16 v[152:155], v[192:195], v[0:3], 0
ds_read_b128 v[220:223], v224 offset:57344
v_mfma_f32_16x16x32_bf16 v[156:159], v[192:195], v[4:7], 0
v_mfma_f32_16x16x32_bf16 v[148:151], v[196:199], v[12:15], v[148:151]
ds_read_b128 v[192:195], v224 offset:58368
v_max_f32 v128, 0, v128
v_mfma_f32_16x16x32_bf16 v[144:147], v[196:199], v[8:11], v[144:147]
v_max_f32 v129, 0, v129
s_waitcnt lgkmcnt(4)
v_mfma_f32_16x16x32_bf16 v[152:155], v[200:203], v[8:11], v[152:155]
ds_read_b128 v[196:199], v224 offset:59392
v_max_f32 v130, 0, v130
v_mfma_f32_16x16x32_bf16 v[156:159], v[200:203], v[12:15], v[156:159]
v_max_f32 v131, 0, v131
v_max_f32 v132, 0, v132
v_mfma_f32_16x16x32_bf16 v[148:151], v[204:207], v[20:23], v[148:151]
ds_read_b128 v[200:203], v224 offset:60416
v_max_f32 v133, 0, v133
v_mfma_f32_16x16x32_bf16 v[144:147], v[204:207], v[16:19], v[144:147]
v_max_f32 v134, 0, v134
v_max_f32 v135, 0, v135
v_mfma_f32_16x16x32_bf16 v[152:155], v[208:211], v[16:19], v[152:155]
ds_read_b128 v[204:207], v224 offset:61440
v_mul_f32 v128, v128, v136
v_mfma_f32_16x16x32_bf16 v[156:159], v[208:211], v[20:23], v[156:159]
v_mul_f32 v129, v129, v137
s_waitcnt lgkmcnt(4)
v_mfma_f32_16x16x32_bf16 v[148:151], v[212:215], v[28:31], v[148:151]
ds_read_b128 v[208:211], v224 offset:62464
v_mul_f32 v130, v130, v138
v_mfma_f32_16x16x32_bf16 v[144:147], v[212:215], v[24:27], v[144:147]
v_mul_f32 v131, v131, v139
v_mul_f32 v132, v132, v140
v_mfma_f32_16x16x32_bf16 v[152:155], v[216:219], v[24:27], v[152:155]
ds_read_b128 v[212:215], v224 offset:63488
v_mul_f32 v133, v133, v141
v_mfma_f32_16x16x32_bf16 v[156:159], v[216:219], v[28:31], v[156:159]
v_mul_f32 v134, v134, v142
v_mul_f32 v135, v135, v143
v_mfma_f32_16x16x32_bf16 v[148:151], v[220:223], v[36:39], v[148:151]
ds_read_b128 v[216:219], v224 offset:64512
v_cvt_pk_bf16_f32 v136, v128, v129
v_mfma_f32_16x16x32_bf16 v[144:147], v[220:223], v[32:35], v[144:147]
s_waitcnt vmcnt(0)
v_cmp_ne_u32 s[66:67], s53, v227
s_waitcnt lgkmcnt(4)
v_mfma_f32_16x16x32_bf16 v[152:155], v[192:195], v[32:35], v[152:155]
s_barrier
ds_read_b128 v[220:223], v225 offset:16384
v_mfma_f32_16x16x32_bf16 v[156:159], v[192:195], v[36:39], v[156:159]
s_and_b32 s66, s66, 65280
s_cmp_ge_u32 s66, s26
s_cbranch_scc1 CR_26
CJ_29:
v_mfma_f32_16x16x32_bf16 v[148:151], v[196:199], v[44:47], v[148:151]
ds_read_b128 v[192:195], v225 offset:17408
s_add_u32 s33, s46, 98304
v_mfma_f32_16x16x32_bf16 v[144:147], v[196:199], v[40:43], v[144:147]
buffer_load_dwordx4 v[0:3], v229, s[4:7], s33 offen sc1
v_mfma_f32_16x16x32_bf16 v[152:155], v[200:203], v[40:43], v[152:155]
ds_read_b128 v[196:199], v225 offset:18432
s_add_u32 s33, s46, 0
v_mfma_f32_16x16x32_bf16 v[156:159], v[200:203], v[44:47], v[156:159]
v_cvt_pk_bf16_f32 v138, v132, v133
s_waitcnt lgkmcnt(4)
v_mfma_f32_16x16x32_bf16 v[148:151], v[204:207], v[52:55], v[148:151]
ds_read_b128 v[200:203], v225 offset:19456
v_cvt_pk_bf16_f32 v137, v130, v131
v_mfma_f32_16x16x32_bf16 v[144:147], v[204:207], v[48:51], v[144:147]
buffer_load_dwordx4 v[4:7], v229, s[4:7], s33 offen sc1
v_mfma_f32_16x16x32_bf16 v[152:155], v[208:211], v[48:51], v[152:155]
ds_read_b128 v[204:207], v225 offset:20480
s_add_u32 s33, s46, 98304
v_mfma_f32_16x16x32_bf16 v[156:159], v[208:211], v[52:55], v[156:159]
s_cmp_lg_u32 s26, 0
s_cbranch_scc0 SS_43
buffer_store_dword v228, v241, s[4:7], s49 offen offset:64
SJ_44:
v_mfma_f32_16x16x32_bf16 v[148:151], v[212:215], v[60:63], v[148:151]
ds_read_b128 v[208:211], v225 offset:21504
v_cvt_pk_bf16_f32 v139, v134, v135
v_mfma_f32_16x16x32_bf16 v[144:147], v[212:215], v[56:59], v[144:147]
v_permlane16_swap_b32 v136, v138
s_waitcnt lgkmcnt(4)
v_mfma_f32_16x16x32_bf16 v[152:155], v[216:219], v[56:59], v[152:155]
ds_read_b128 v[212:215], v225 offset:22528
v_permlane16_swap_b32 v137, v139
v_mfma_f32_16x16x32_bf16 v[156:159], v[216:219], v[60:63], v[156:159]
buffer_load_dwordx4 v[8:11], v230, s[4:7], s33 offen sc1
v_mfma_f32_16x16x32_bf16 v[148:151], v[220:223], v[68:71], v[148:151]
ds_read_b128 v[216:219], v225 offset:23552
s_add_u32 s33, s46, 0
v_mfma_f32_16x16x32_bf16 v[144:147], v[220:223], v[64:67], v[144:147]
buffer_load_dwordx4 v[12:15], v230, s[4:7], s33 offen sc1
buffer_store_dwordx4 v[136:139], v224, s[4:7], s45 offen offset:3072 sc1
v_mfma_f32_16x16x32_bf16 v[152:155], v[192:195], v[64:67], v[152:155]
ds_read_b128 v[220:223], v225 offset:24576
v_mfma_f32_16x16x32_bf16 v[156:159], v[192:195], v[68:71], v[156:159]
s_waitcnt lgkmcnt(4)
v_mfma_f32_16x16x32_bf16 v[148:151], v[196:199], v[76:79], v[148:151]
ds_read_b128 v[192:195], v225 offset:25600
s_add_u32 s33, s46, 104448
v_mfma_f32_16x16x32_bf16 v[144:147], v[196:199], v[72:75], v[144:147]
v_mfma_f32_16x16x32_bf16 v[152:155], v[200:203], v[72:75], v[152:155]
ds_read_b128 v[196:199], v225 offset:26624
v_mfma_f32_16x16x32_bf16 v[156:159], v[200:203], v[76:79], v[156:159]
buffer_load_dwordx4 v[16:19], v229, s[4:7], s33 offen sc1
v_mfma_f32_16x16x32_bf16 v[148:151], v[204:207], v[84:87], v[148:151]
ds_read_b128 v[200:203], v225 offset:27648
s_add_u32 s33, s46, 6144
v_mfma_f32_16x16x32_bf16 v[144:147], v[204:207], v[80:83], v[144:147]
s_waitcnt lgkmcnt(4)
v_mfma_f32_16x16x32_bf16 v[152:155], v[208:211], v[80:83], v[152:155]
ds_read_b128 v[204:207], v225 offset:28672
v_mfma_f32_16x16x32_bf16 v[156:159], v[208:211], v[84:87], v[156:159]
buffer_load_dwordx4 v[20:23], v229, s[4:7], s33 offen sc1
v_mfma_f32_16x16x32_bf16 v[148:151], v[212:215], v[92:95], v[148:151]
ds_read_b128 v[208:211], v225 offset:29696
s_add_u32 s33, s46, 104448
v_mfma_f32_16x16x32_bf16 v[144:147], v[212:215], v[88:91], v[144:147]
v_mfma_f32_16x16x32_bf16 v[152:155], v[216:219], v[88:91], v[152:155]
ds_read_b128 v[212:215], v225 offset:30720
v_mfma_f32_16x16x32_bf16 v[156:159], v[216:219], v[92:95], v[156:159]
s_waitcnt lgkmcnt(4)
v_mfma_f32_16x16x32_bf16 v[148:151], v[220:223], v[100:103], v[148:151]
ds_read_b128 v[216:219], v225 offset:31744
v_mfma_f32_16x16x32_bf16 v[144:147], v[220:223], v[96:99], v[144:147]
buffer_load_dwordx4 v[24:27], v230, s[4:7], s33 offen sc1
v_mfma_f32_16x16x32_bf16 v[152:155], v[192:195], v[96:99], v[152:155]
ds_read_b32 v220, v226 offset:1024
s_add_u32 s33, s46, 6144
v_mfma_f32_16x16x32_bf16 v[156:159], v[192:195], v[100:103], v[156:159]
buffer_load_dwordx4 v[28:31], v230, s[4:7], s33 offen sc1
v_mfma_f32_16x16x32_bf16 v[148:151], v[196:199], v[108:111], v[148:151]
ds_read_b32 v192, v226 offset:1088
v_mfma_f32_16x16x32_bf16 v[144:147], v[196:199], v[104:107], v[144:147]
s_waitcnt lgkmcnt(4)
v_mfma_f32_16x16x32_bf16 v[152:155], v[200:203], v[104:107], v[152:155]
buffer_load_dword v227, v226, s[4:7], s51 offen sc1
v_mfma_f32_16x16x32_bf16 v[156:159], v[200:203], v[108:111], v[156:159]
s_add_u32 s33, s46, 99328
v_mfma_f32_16x16x32_bf16 v[148:151], v[204:207], v[116:119], v[148:151]
buffer_load_dwordx4 v[32:35], v229, s[4:7], s33 offen sc1
v_mfma_f32_16x16x32_bf16 v[144:147], v[204:207], v[112:115], v[144:147]
v_mfma_f32_16x16x32_bf16 v[152:155], v[208:211], v[112:115], v[152:155]
s_add_u32 s33, s46, 1024
v_mfma_f32_16x16x32_bf16 v[156:159], v[208:211], v[116:119], v[156:159]
s_waitcnt lgkmcnt(1)
v_mfma_f32_16x16x32_bf16 v[148:151], v[212:215], v[124:127], v[148:151]
buffer_load_dwordx4 v[36:39], v229, s[4:7], s33 offen sc1
v_mfma_f32_16x16x32_bf16 v[144:147], v[212:215], v[120:123], v[144:147]
v_mfma_f32_16x16x32_bf16 v[152:155], v[216:219], v[120:123], v[152:155]
s_add_u32 s33, s46, 99328
v_mfma_f32_16x16x32_bf16 v[156:159], v[216:219], v[124:127], v[156:159]
v_mfma_f32_16x16x32_bf16 v[148:151], v[220:223], v[250:253], v[148:151]
buffer_load_dwordx4 v[40:43], v230, s[4:7], s33 offen sc1
v_mfma_f32_16x16x32_bf16 v[144:147], v[220:223], v[232:235], v[144:147]
s_waitcnt lgkmcnt(0)
v_mfma_f32_16x16x32_bf16 v[152:155], v[192:195], v[232:235], v[152:155]
v_mfma_f32_16x16x32_bf16 v[156:159], v[192:195], v[250:253], v[156:159]
s_nop 4
v_max_f32 v144, 0, v144
v_max_f32 v145, 0, v145
v_max_f32 v146, 0, v146
v_max_f32 v147, 0, v147
v_max_f32 v148, 0, v148
v_max_f32 v149, 0, v149
v_max_f32 v150, 0, v150
v_max_f32 v151, 0, v151
v_pk_mul_f32 v[144:145], v[144:145], v[152:153]
v_pk_mul_f32 v[146:147], v[146:147], v[154:155]
v_pk_mul_f32 v[148:149], v[148:149], v[156:157]
v_pk_mul_f32 v[150:151], v[150:151], v[158:159]
v_cvt_pk_bf16_f32 v152, v144, v145
v_cvt_pk_bf16_f32 v154, v148, v149
v_cvt_pk_bf16_f32 v153, v146, v147
v_cvt_pk_bf16_f32 v155, v150, v151
s_add_u32 s31, s45, 4096
v_permlane16_swap_b32 v152, v154
v_permlane16_swap_b32 v153, v155
buffer_store_dwordx4 v[152:155], v224, s[4:7], s31 offen offset:0 sc1
s_waitcnt vmcnt(14)
v_mfma_f32_16x16x32_bf16 v[160:163], a[64:67], v[0:3], 0
s_add_u32 s33, s46, 1024
v_mfma_f32_16x16x32_bf16 v[164:167], a[68:71], v[0:3], 0
v_mfma_f32_16x16x32_bf16 v[176:179], a[72:75], v[0:3], 0
buffer_load_dwordx4 v[44:47], v230, s[4:7], s33 offen sc1
v_mfma_f32_16x16x32_bf16 v[180:183], a[76:79], v[0:3], 0
s_waitcnt vmcnt(14)
v_mfma_f32_16x16x32_bf16 v[148:151], a[76:79], v[4:7], 0
v_xor_b32 v247, 2048, v242
v_xor_b32 v248, 4096, v242
v_mfma_f32_16x16x32_bf16 v[144:147], a[72:75], v[4:7], 0
v_xor_b32 v249, 6144, v242
v_and_b32 v246, 15, v240
v_mfma_f32_16x16x32_bf16 v[132:135], a[68:71], v[4:7], 0
s_add_u32 s33, s46, 105472
v_mfma_f32_16x16x32_bf16 v[128:131], a[64:67], v[4:7], 0
s_waitcnt vmcnt(12)
v_mfma_f32_16x16x32_bf16 v[168:171], a[64:67], v[8:11], 0
buffer_load_dwordx4 v[48:51], v229, s[4:7], s33 offen sc1
v_mfma_f32_16x16x32_bf16 v[172:175], a[68:71], v[8:11], 0
s_lshl_b32 s30, s24, 8
s_bfe_u32 s35, s41, 0x70006
s_add_u32 s30, s30, s35
s_add_u32 s30, s30, 161280
v_lshl_add_u32 v246, v246, 2, s30
v_mfma_f32_16x16x32_bf16 v[184:187], a[72:75], v[8:11], 0
s_add_u32 s33, s46, 7168
ds_read_b32 v254, v246 offset:1344
v_mfma_f32_16x16x32_bf16 v[188:191], a[76:79], v[8:11], 0
ds_read_b32 v255, v246 offset:1472
s_waitcnt vmcnt(12)
v_mfma_f32_16x16x32_bf16 v[156:159], a[76:79], v[12:15], 0
buffer_load_dwordx4 v[52:55], v229, s[4:7], s33 offen sc1
v_mfma_f32_16x16x32_bf16 v[152:155], a[72:75], v[12:15], 0
v_accvgpr_read_b32 v217, a248
v_accvgpr_read_b32 v219, a249
v_mfma_f32_16x16x32_bf16 v[140:143], a[68:71], v[12:15], 0
s_add_u32 s33, s46, 105472
v_accvgpr_read_b32 v221, a250
v_mfma_f32_16x16x32_bf16 v[136:139], a[64:67], v[12:15], 0
s_waitcnt vmcnt(7)
v_cmp_ne_u32 s[66:67], s53, v227
v_mfma_f32_16x16x32_bf16 v[160:163], a[80:83], v[16:19], v[160:163]
s_and_b32 s66, s66, 16711680
s_cmp_ge_u32 s66, s26
s_cbranch_scc1 CR_30
CJ_33:
v_mfma_f32_16x16x32_bf16 v[164:167], a[84:87], v[16:19], v[164:167]
buffer_load_dwordx4 v[56:59], v230, s[4:7], s33 offen sc1
v_mfma_f32_16x16x32_bf16 v[176:179], a[88:91], v[16:19], v[176:179]
s_add_u32 s33, s46, 7168
v_accvgpr_read_b32 v223, a251
v_mfma_f32_16x16x32_bf16 v[180:183], a[92:95], v[16:19], v[180:183]
v_lshlrev_b32 v216, 16, v217
v_mfma_f32_16x16x32_bf16 v[148:151], a[92:95], v[20:23], v[148:151]
buffer_load_dwordx4 v[60:63], v230, s[4:7], s33 offen sc1
v_mfma_f32_16x16x32_bf16 v[144:147], a[88:91], v[20:23], v[144:147]
s_cmp_lg_u32 s26, 0
s_waitcnt vmcnt(5)
s_cbranch_scc0 SS_45
buffer_store_dword v228, v241, s[4:7], s49 offen offset:96
SJ_46:
v_mfma_f32_16x16x32_bf16 v[132:135], a[84:87], v[20:23], v[132:135]
v_and_b32 v217, 0xffff0000, v217
v_lshlrev_b32 v218, 16, v219
v_mfma_f32_16x16x32_bf16 v[128:131], a[80:83], v[20:23], v[128:131]
v_and_b32 v219, 0xffff0000, v219
v_mfma_f32_16x16x32_bf16 v[168:171], a[80:83], v[24:27], v[168:171]
s_add_u32 s33, s46, 100352
v_lshlrev_b32 v220, 16, v221
v_mfma_f32_16x16x32_bf16 v[172:175], a[84:87], v[24:27], v[172:175]
v_and_b32 v221, 0xffff0000, v221
s_branch L_SK4
L_ST4:
s_setpc_b64 s[10:11]
L_SK4:
v_lshlrev_b32 v222, 16, v223
v_mfma_f32_16x16x32_bf16 v[184:187], a[88:91], v[24:27], v[184:187]
buffer_load_dwordx4 v[64:67], v229, s[4:7], s33 offen sc1
v_mfma_f32_16x16x32_bf16 v[188:191], a[92:95], v[24:27], v[188:191]
v_and_b32 v223, 0xffff0000, v223
v_mfma_f32_16x16x32_bf16 v[156:159], a[92:95], v[28:31], v[156:159]
s_add_u32 s33, s46, 2048
v_mfma_f32_16x16x32_bf16 v[152:155], a[88:91], v[28:31], v[152:155]
v_mfma_f32_16x16x32_bf16 v[140:143], a[84:87], v[28:31], v[140:143]
buffer_load_dwordx4 v[68:71], v229, s[4:7], s33 offen sc1
v_mfma_f32_16x16x32_bf16 v[136:139], a[80:83], v[28:31], v[136:139]
v_mfma_f32_16x16x32_bf16 v[160:163], a[96:99], v[32:35], v[160:163]
s_add_u32 s33, s46, 100352
v_mfma_f32_16x16x32_bf16 v[164:167], a[100:103], v[32:35], v[164:167]
v_mfma_f32_16x16x32_bf16 v[176:179], a[104:107], v[32:35], v[176:179]
buffer_load_dwordx4 v[72:75], v230, s[4:7], s33 offen sc1
v_mfma_f32_16x16x32_bf16 v[180:183], a[108:111], v[32:35], v[180:183]
v_mfma_f32_16x16x32_bf16 v[148:151], a[108:111], v[36:39], v[148:151]
s_add_u32 s33, s46, 2048
v_mfma_f32_16x16x32_bf16 v[144:147], a[104:107], v[36:39], v[144:147]
v_mfma_f32_16x16x32_bf16 v[132:135], a[100:103], v[36:39], v[132:135]
buffer_load_dwordx4 v[76:79], v230, s[4:7], s33 offen sc1
v_mfma_f32_16x16x32_bf16 v[128:131], a[96:99], v[36:39], v[128:131]
v_mfma_f32_16x16x32_bf16 v[168:171], a[96:99], v[40:43], v[168:171]
v_mfma_f32_16x16x32_bf16 v[172:175], a[100:103], v[40:43], v[172:175]
v_mfma_f32_16x16x32_bf16 v[184:187], a[104:107], v[40:43], v[184:187]
s_add_u32 s33, s46, 106496
v_mfma_f32_16x16x32_bf16 v[188:191], a[108:111], v[40:43], v[188:191]
s_waitcnt vmcnt(9)
v_mfma_f32_16x16x32_bf16 v[156:159], a[108:111], v[44:47], v[156:159]
buffer_load_dwordx4 v[80:83], v229, s[4:7], s33 offen sc1
v_mfma_f32_16x16x32_bf16 v[152:155], a[104:107], v[44:47], v[152:155]
v_mfma_f32_16x16x32_bf16 v[140:143], a[100:103], v[44:47], v[140:143]
buffer_load_dword v227, v226, s[4:7], s51 offen sc1
v_mfma_f32_16x16x32_bf16 v[136:139], a[96:99], v[44:47], v[136:139]
s_add_u32 s33, s46, 8192
s_waitcnt vmcnt(10)
v_mfma_f32_16x16x32_bf16 v[160:163], a[112:115], v[48:51], v[160:163]
buffer_load_dwordx4 v[84:87], v229, s[4:7], s33 offen sc1
v_mfma_f32_16x16x32_bf16 v[164:167], a[116:119], v[48:51], v[164:167]
v_mfma_f32_16x16x32_bf16 v[176:179], a[120:123], v[48:51], v[176:179]
s_add_u32 s33, s46, 106496
v_mfma_f32_16x16x32_bf16 v[180:183], a[124:127], v[48:51], v[180:183]
s_waitcnt vmcnt(10)
v_mfma_f32_16x16x32_bf16 v[148:151], a[124:127], v[52:55], v[148:151]
buffer_load_dwordx4 v[88:91], v230, s[4:7], s33 offen sc1
v_mfma_f32_16x16x32_bf16 v[144:147], a[120:123], v[52:55], v[144:147]
v_mfma_f32_16x16x32_bf16 v[132:135], a[116:119], v[52:55], v[132:135]
s_add_u32 s33, s46, 8192
v_mfma_f32_16x16x32_bf16 v[128:131], a[112:115], v[52:55], v[128:131]
s_waitcnt vmcnt(10)
v_mfma_f32_16x16x32_bf16 v[168:171], a[112:115], v[56:59], v[168:171]
buffer_load_dwordx4 v[92:95], v230, s[4:7], s33 offen sc1
v_mfma_f32_16x16x32_bf16 v[172:175], a[116:119], v[56:59], v[172:175]
v_mfma_f32_16x16x32_bf16 v[184:187], a[120:123], v[56:59], v[184:187]
v_mfma_f32_16x16x32_bf16 v[188:191], a[124:127], v[56:59], v[188:191]
s_waitcnt vmcnt(10)
v_mfma_f32_16x16x32_bf16 v[156:159], a[124:127], v[60:63], v[156:159]
s_add_u32 s33, s46, 5120
v_mfma_f32_16x16x32_bf16 v[152:155], a[120:123], v[60:63], v[152:155]
v_mfma_f32_16x16x32_bf16 v[140:143], a[116:119], v[60:63], v[140:143]
buffer_load_dwordx4 v[96:99], v229, s[4:7], s33 offen sc1
v_mfma_f32_16x16x32_bf16 v[136:139], a[112:115], v[60:63], v[136:139]
s_waitcnt vmcnt(9)
v_mfma_f32_16x16x32_bf16 v[160:163], a[128:131], v[64:67], v[160:163]
s_add_u32 s33, s46, 5120
s_waitcnt vmcnt(4)
v_mfma_f32_16x16x32_bf16 v[164:167], a[132:135], v[64:67], v[164:167]
v_cmp_ne_u32 s[66:67], s53, v227
v_mfma_f32_16x16x32_bf16 v[176:179], a[136:139], v[64:67], v[176:179]
s_and_b32 s66, s66, 4278190080
s_cmp_ge_u32 s66, s26
s_cbranch_scc1 CR_34
CJ_37:
v_mfma_f32_16x16x32_bf16 v[180:183], a[140:143], v[64:67], v[180:183]
v_mfma_f32_16x16x32_bf16 v[148:151], a[140:143], v[68:71], v[148:151]
buffer_load_dwordx4 v[100:103], v230, s[4:7], s33 offen sc1
v_mfma_f32_16x16x32_bf16 v[144:147], a[136:139], v[68:71], v[144:147]
s_add_u32 s33, s46, 3072
v_mfma_f32_16x16x32_bf16 v[132:135], a[132:135], v[68:71], v[132:135]
buffer_load_dwordx4 v[104:107], v229, s[4:7], s33 offen sc1
v_mfma_f32_16x16x32_bf16 v[128:131], a[128:131], v[68:71], v[128:131]
v_mfma_f32_16x16x32_bf16 v[168:171], a[128:131], v[72:75], v[168:171]
s_add_u32 s33, s46, 3072
v_mfma_f32_16x16x32_bf16 v[172:175], a[132:135], v[72:75], v[172:175]
v_mfma_f32_16x16x32_bf16 v[184:187], a[136:139], v[72:75], v[184:187]
buffer_load_dwordx4 v[108:111], v230, s[4:7], s33 offen sc1
v_mfma_f32_16x16x32_bf16 v[188:191], a[140:143], v[72:75], v[188:191]
v_mfma_f32_16x16x32_bf16 v[156:159], a[140:143], v[76:79], v[156:159]
v_mfma_f32_16x16x32_bf16 v[152:155], a[136:139], v[76:79], v[152:155]
v_mfma_f32_16x16x32_bf16 v[140:143], a[132:135], v[76:79], v[140:143]
s_add_u32 s33, s46, 9216
v_mfma_f32_16x16x32_bf16 v[136:139], a[128:131], v[76:79], v[136:139]
v_mfma_f32_16x16x32_bf16 v[160:163], a[144:147], v[80:83], v[160:163]
buffer_load_dwordx4 v[112:115], v229, s[4:7], s33 offen sc1
v_mfma_f32_16x16x32_bf16 v[164:167], a[148:151], v[80:83], v[164:167]
v_mfma_f32_16x16x32_bf16 v[176:179], a[152:155], v[80:83], v[176:179]
s_add_u32 s33, s46, 9216
v_mfma_f32_16x16x32_bf16 v[180:183], a[156:159], v[80:83], v[180:183]
s_waitcnt vmcnt(7)
v_mfma_f32_16x16x32_bf16 v[148:151], a[156:159], v[84:87], v[148:151]
buffer_load_dwordx4 v[116:119], v230, s[4:7], s33 offen sc1
v_mfma_f32_16x16x32_bf16 v[144:147], a[152:155], v[84:87], v[144:147]
v_mfma_f32_16x16x32_bf16 v[132:135], a[148:151], v[84:87], v[132:135]
s_add_u32 s33, s46, 4096
v_mfma_f32_16x16x32_bf16 v[128:131], a[144:147], v[84:87], v[128:131]
s_waitcnt vmcnt(7)
v_mfma_f32_16x16x32_bf16 v[168:171], a[144:147], v[88:91], v[168:171]
buffer_load_dwordx4 v[120:123], v229, s[4:7], s33 offen sc1
v_mfma_f32_16x16x32_bf16 v[172:175], a[148:151], v[88:91], v[172:175]
v_mfma_f32_16x16x32_bf16 v[184:187], a[152:155], v[88:91], v[184:187]
s_add_u32 s33, s46, 4096
v_mfma_f32_16x16x32_bf16 v[188:191], a[156:159], v[88:91], v[188:191]
s_waitcnt vmcnt(7)
v_mfma_f32_16x16x32_bf16 v[156:159], a[156:159], v[92:95], v[156:159]
buffer_load_dwordx4 v[124:127], v230, s[4:7], s33 offen sc1
v_mfma_f32_16x16x32_bf16 v[152:155], a[152:155], v[92:95], v[152:155]
v_mfma_f32_16x16x32_bf16 v[140:143], a[148:151], v[92:95], v[140:143]
s_add_u32 s33, s46, 10240
v_mfma_f32_16x16x32_bf16 v[136:139], a[144:147], v[92:95], v[136:139]
s_waitcnt vmcnt(7)
v_mfma_f32_16x16x32_bf16 v[128:131], a[224:227], v[96:99], v[128:131]
buffer_load_dwordx4 v[0:3], v229, s[4:7], s33 offen sc1
v_mfma_f32_16x16x32_bf16 v[132:135], a[228:231], v[96:99], v[132:135]
s_add_u32 s33, s46, 10240
v_mfma_f32_16x16x32_bf16 v[144:147], a[232:235], v[96:99], v[144:147]
buffer_load_dwordx4 v[4:7], v230, s[4:7], s33 offen sc1
v_mfma_f32_16x16x32_bf16 v[148:151], a[236:239], v[96:99], v[148:151]
s_waitcnt vmcnt(8)
v_mfma_f32_16x16x32_bf16 v[156:159], a[236:239], v[100:103], v[156:159]
s_add_u32 s33, s46, 103424
v_mfma_f32_16x16x32_bf16 v[152:155], a[232:235], v[100:103], v[152:155]
v_mfma_f32_16x16x32_bf16 v[140:143], a[228:231], v[100:103], v[140:143]
buffer_load_dwordx4 v[8:11], v229, s[4:7], s33 offen sc1
v_mfma_f32_16x16x32_bf16 v[136:139], a[224:227], v[100:103], v[136:139]
s_waitcnt vmcnt(8)
v_mfma_f32_16x16x32_bf16 v[128:131], a[160:163], v[104:107], v[128:131]
s_add_u32 s33, s46, 103424
v_mfma_f32_16x16x32_bf16 v[132:135], a[164:167], v[104:107], v[132:135]
v_mfma_f32_16x16x32_bf16 v[144:147], a[168:171], v[104:107], v[144:147]
buffer_load_dwordx4 v[12:15], v230, s[4:7], s33 offen sc1
v_mfma_f32_16x16x32_bf16 v[148:151], a[172:175], v[104:107], v[148:151]
s_waitcnt vmcnt(8)
v_mfma_f32_16x16x32_bf16 v[156:159], a[172:175], v[108:111], v[156:159]
s_add_u32 s33, s46, 101376
v_mfma_f32_16x16x32_bf16 v[152:155], a[168:171], v[108:111], v[152:155]
v_mfma_f32_16x16x32_bf16 v[140:143], a[164:167], v[108:111], v[140:143]
buffer_load_dwordx4 v[16:19], v229, s[4:7], s33 offen sc1
v_mfma_f32_16x16x32_bf16 v[136:139], a[160:163], v[108:111], v[136:139]
s_add_u32 s33, s46, 101376
s_waitcnt vmcnt(8)
v_mfma_f32_16x16x32_bf16 v[128:131], a[176:179], v[112:115], v[128:131]
buffer_load_dwordx4 v[20:23], v230, s[4:7], s33 offen sc1
v_mfma_f32_16x16x32_bf16 v[132:135], a[180:183], v[112:115], v[132:135]
v_mfma_f32_16x16x32_bf16 v[144:147], a[184:187], v[112:115], v[144:147]
s_add_u32 s33, s46, 107520
v_mfma_f32_16x16x32_bf16 v[148:151], a[188:191], v[112:115], v[148:151]
s_waitcnt vmcnt(8)
v_mfma_f32_16x16x32_bf16 v[156:159], a[188:191], v[116:119], v[156:159]
buffer_load_dwordx4 v[24:27], v229, s[4:7], s33 offen sc1
v_mfma_f32_16x16x32_bf16 v[152:155], a[184:187], v[116:119], v[152:155]
v_mfma_f32_16x16x32_bf16 v[140:143], a[180:183], v[116:119], v[140:143]
s_add_u32 s33, s46, 107520
v_mfma_f32_16x16x32_bf16 v[136:139], a[176:179], v[116:119], v[136:139]
s_waitcnt vmcnt(8)
v_mfma_f32_16x16x32_bf16 v[128:131], a[192:195], v[120:123], v[128:131]
buffer_load_dwordx4 v[28:31], v230, s[4:7], s33 offen sc1
v_mfma_f32_16x16x32_bf16 v[132:135], a[196:199], v[120:123], v[132:135]
v_mfma_f32_16x16x32_bf16 v[144:147], a[200:203], v[120:123], v[144:147]
s_add_u32 s33, s46, 102400
v_mfma_f32_16x16x32_bf16 v[148:151], a[204:207], v[120:123], v[148:151]
s_waitcnt vmcnt(8)
v_mfma_f32_16x16x32_bf16 v[156:159], a[204:207], v[124:127], v[156:159]
buffer_load_dwordx4 v[32:35], v229, s[4:7], s33 offen sc1
v_mfma_f32_16x16x32_bf16 v[152:155], a[200:203], v[124:127], v[152:155]
s_add_u32 s33, s46, 102400
v_mfma_f32_16x16x32_bf16 v[140:143], a[196:199], v[124:127], v[140:143]
buffer_load_dwordx4 v[36:39], v230, s[4:7], s33 offen sc1
v_mfma_f32_16x16x32_bf16 v[136:139], a[192:195], v[124:127], v[136:139]
s_waitcnt vmcnt(9)
v_mfma_f32_16x16x32_bf16 v[128:131], a[208:211], v[0:3], v[128:131]
s_add_u32 s33, s46, 108544
v_mfma_f32_16x16x32_bf16 v[132:135], a[212:215], v[0:3], v[132:135]
v_mfma_f32_16x16x32_bf16 v[144:147], a[216:219], v[0:3], v[144:147]
buffer_load_dwordx4 v[40:43], v229, s[4:7], s33 offen sc1
v_mfma_f32_16x16x32_bf16 v[148:151], a[220:223], v[0:3], v[148:151]
s_waitcnt vmcnt(9)
v_mfma_f32_16x16x32_bf16 v[156:159], a[220:223], v[4:7], v[156:159]
s_add_u32 s33, s46, 108544
v_mfma_f32_16x16x32_bf16 v[152:155], a[216:219], v[4:7], v[152:155]
v_mfma_f32_16x16x32_bf16 v[140:143], a[212:215], v[4:7], v[140:143]
buffer_load_dwordx4 v[44:47], v230, s[4:7], s33 offen sc1
v_mfma_f32_16x16x32_bf16 v[136:139], a[208:211], v[4:7], v[136:139]
s_waitcnt vmcnt(9)
v_mfma_f32_16x16x32_bf16 v[160:163], a[224:227], v[8:11], v[160:163]
v_mfma_f32_16x16x32_bf16 v[164:167], a[228:231], v[8:11], v[164:167]
s_add_u32 m0, s41, 98304
s_add_u32 s34, s36, 49152
buffer_load_dwordx4 v224, s[4:7], s34 offen offset:0 sc1 lds
s_add_u32 s53, s25, 2
v_mfma_f32_16x16x32_bf16 v[176:179], a[232:235], v[8:11], v[176:179]
v_mfma_f32_16x16x32_bf16 v[180:183], a[236:239], v[8:11], v[180:183]
ds_write_b128 v247, v[136:139] offset:0
buffer_load_dwordx4 v224, s[4:7], s34 offen offset:1024 sc1 lds
v_mov_b32 v228, s53
s_waitcnt vmcnt(10)
v_mfma_f32_16x16x32_bf16 v[188:191], a[236:239], v[12:15], v[188:191]
v_mfma_f32_16x16x32_bf16 v[184:187], a[232:235], v[12:15], v[184:187]
ds_write_b128 v247, v[140:143] offset:1024
buffer_load_dwordx4 v224, s[4:7], s34 offen offset:2048 sc1 lds
v_mfma_f32_16x16x32_bf16 v[172:175], a[228:231], v[12:15], v[172:175]
v_mfma_f32_16x16x32_bf16 v[168:171], a[224:227], v[12:15], v[168:171]
ds_write_b128 v248, v[144:147] offset:8192
buffer_load_dwordx4 v224, s[4:7], s34 offen offset:3072 sc1 lds
s_waitcnt vmcnt(11)
v_mfma_f32_16x16x32_bf16 v[160:163], a[160:163], v[16:19], v[160:163]
v_mfma_f32_16x16x32_bf16 v[164:167], a[164:167], v[16:19], v[164:167]
ds_write_b128 v248, v[148:151] offset:9216
v_mfma_f32_16x16x32_bf16 v[176:179], a[168:171], v[16:19], v[176:179]
v_mfma_f32_16x16x32_bf16 v[180:183], a[172:175], v[16:19], v[180:183]
ds_write_b128 v249, v[152:155] offset:16384
s_waitcnt vmcnt(10)
v_mfma_f32_16x16x32_bf16 v[184:187], a[168:171], v[20:23], v[184:187]
v_mfma_f32_16x16x32_bf16 v[188:191], a[172:175], v[20:23], v[188:191]
ds_write_b128 v249, v[156:159] offset:17408
s_waitcnt vmcnt(9)
v_mfma_f32_16x16x32_bf16 v[176:179], a[184:187], v[24:27], v[176:179]
v_mfma_f32_16x16x32_bf16 v[180:183], a[188:191], v[24:27], v[180:183]
s_waitcnt vmcnt(8)
v_mfma_f32_16x16x32_bf16 v[184:187], a[184:187], v[28:31], v[184:187]
v_mfma_f32_16x16x32_bf16 v[188:191], a[188:191], v[28:31], v[188:191]
s_waitcnt lgkmcnt(0)
s_barrier
ds_read_b128 v[192:195], v242 offset:0
ds_read_b128 v[196:199], v242 offset:1024
s_waitcnt vmcnt(7)
v_mfma_f32_16x16x32_bf16 v[176:179], a[200:203], v[32:35], v[176:179]
v_mfma_f32_16x16x32_bf16 v[180:183], a[204:207], v[32:35], v[180:183]
ds_read_b128 v[200:203], v242 offset:8192
ds_read_b128 v[204:207], v242 offset:9216
s_waitcnt vmcnt(6)
v_mfma_f32_16x16x32_bf16 v[184:187], a[200:203], v[36:39], v[184:187]
v_mfma_f32_16x16x32_bf16 v[188:191], a[204:207], v[36:39], v[188:191]
ds_read_b128 v[208:211], v242 offset:16384
ds_read_b128 v[212:215], v242 offset:17408
s_waitcnt vmcnt(5)
v_mfma_f32_16x16x32_bf16 v[176:179], a[216:219], v[40:43], v[176:179]
v_mfma_f32_16x16x32_bf16 v[180:183], a[220:223], v[40:43], v[180:183]
s_waitcnt vmcnt(4)
v_mfma_f32_16x16x32_bf16 v[184:187], a[216:219], v[44:47], v[184:187]
v_mfma_f32_16x16x32_bf16 v[188:191], a[220:223], v[44:47], v[188:191]
v_mfma_f32_16x16x32_bf16 v[168:171], a[160:163], v[20:23], v[168:171]
v_mfma_f32_16x16x32_bf16 v[172:175], a[164:167], v[20:23], v[172:175]
v_mfma_f32_16x16x32_bf16 v[160:163], a[176:179], v[24:27], v[160:163]
v_mfma_f32_16x16x32_bf16 v[164:167], a[180:183], v[24:27], v[164:167]
s_waitcnt lgkmcnt(0)
s_barrier
v_mfma_f32_16x16x32_bf16 v[168:171], a[176:179], v[28:31], v[168:171]
v_mfma_f32_16x16x32_bf16 v[172:175], a[180:183], v[28:31], v[172:175]
ds_write_b128 v248, v[176:179] offset:8192
v_mfma_f32_16x16x32_bf16 v[160:163], a[192:195], v[32:35], v[160:163]
v_mfma_f32_16x16x32_bf16 v[164:167], a[196:199], v[32:35], v[164:167]
ds_write_b128 v248, v[180:183] offset:9216
v_mfma_f32_16x16x32_bf16 v[168:171], a[192:195], v[36:39], v[168:171]
v_mfma_f32_16x16x32_bf16 v[172:175], a[196:199], v[36:39], v[172:175]
v_mfma_f32_16x16x32_bf16 v[160:163], a[208:211], v[40:43], v[160:163]
v_mfma_f32_16x16x32_bf16 v[164:167], a[212:215], v[40:43], v[164:167]
ds_write_b128 v249, v[184:187] offset:16384
v_mfma_f32_16x16x32_bf16 v[168:171], a[208:211], v[44:47], v[168:171]
v_mfma_f32_16x16x32_bf16 v[172:175], a[212:215], v[44:47], v[172:175]
ds_write_b128 v249, v[188:191] offset:17408
v_add_f32 v128, v128, v192
v_add_f32 v129, v129, v193
v_add_f32 v130, v130, v194
v_add_f32 v131, v131, v195
v_add_f32 v132, v132, v196
v_add_f32 v133, v133, v197
v_add_f32 v134, v134, v198
v_add_f32_e64 v135, v135, v199
ds_write_b128 v247, v[168:171] offset:0
v_pk_add_f32 v[128:129], v[128:129], v[200:201]
v_pk_add_f32 v[130:131], v[130:131], v[202:203]
v_pk_add_f32 v[132:133], v[132:133], v[204:205]
v_pk_add_f32 v[134:135], v[134:135], v[206:207]
v_pk_add_f32 v[128:129], v[128:129], v[208:209]
v_pk_add_f32 v[130:131], v[130:131], v[210:211]
v_pk_add_f32 v[132:133], v[132:133], v[212:213]
v_pk_add_f32 v[134:135], v[134:135], v[214:215]
v_pk_fma_f32 v[128:129], v[128:129], v[254:255], v[216:217] op_sel_hi:[1,0,1]
v_add_u32 v141, 0x10000, v128
v_and_b32 v141, 0xfffe0000, v141
v_pk_fma_f32 v[130:131], v[130:131], v[254:255], v[218:219] op_sel_hi:[1,0,1]
v_pk_fma_f32 v[132:133], v[132:133], v[254:255], v[220:221] op_sel_hi:[1,0,1]
v_pk_fma_f32 v[134:135], v[134:135], v[254:255], v[222:223] op_sel_hi:[1,0,1]
v_cvt_pk_bf16_f32 v136, v141, v129
v_cvt_pk_bf16_f32 v137, v130, v131
ds_write_b128 v247, v[172:175] offset:1024
v_cvt_pk_bf16_f32 v138, v132, v133
v_cvt_pk_bf16_f32 v139, v134, v135
v_and_b32_e64 v136, -2, v136
s_add_u32 s31, s37, 0
buffer_store_dwordx4 v[136:139], v224, s[4:7], s31 offen
v_accvgpr_read_b32 v217, a252
v_accvgpr_read_b32 v219, a253
v_accvgpr_read_b32 v221, a254
v_accvgpr_read_b32 v223, a255
v_lshlrev_b32 v216, 16, v217
v_and_b32 v217, 0xffff0000, v217
v_lshlrev_b32 v218, 16, v219
v_and_b32 v219, 0xffff0000, v219
v_lshlrev_b32 v220, 16, v221
v_and_b32 v221, 0xffff0000, v221
v_lshlrev_b32 v222, 16, v223
v_and_b32 v223, 0xffff0000, v223
s_waitcnt lgkmcnt(0)
s_barrier
ds_read_b128 v[192:195], v242 offset:0
ds_read_b128 v[196:199], v242 offset:1024
ds_read_b128 v[200:203], v242 offset:8192
ds_read_b128 v[204:207], v242 offset:9216
ds_read_b128 v[208:211], v242 offset:16384
ds_read_b128 v[212:215], v242 offset:17408
s_waitcnt lgkmcnt(4)
v_pk_add_f32 v[160:161], v[160:161], v[192:193]
v_pk_add_f32 v[162:163], v[162:163], v[194:195]
v_pk_add_f32 v[164:165], v[164:165], v[196:197]
v_pk_add_f32 v[166:167], v[166:167], v[198:199]
s_waitcnt lgkmcnt(2)
v_pk_add_f32 v[160:161], v[160:161], v[200:201]
v_pk_add_f32 v[162:163], v[162:163], v[202:203]
v_pk_add_f32 v[164:165], v[164:165], v[204:205]
v_pk_add_f32 v[166:167], v[166:167], v[206:207]
s_waitcnt lgkmcnt(0)
v_pk_add_f32 v[160:161], v[160:161], v[208:209]
v_pk_add_f32 v[162:163], v[162:163], v[210:211]
v_pk_add_f32 v[164:165], v[164:165], v[212:213]
v_pk_add_f32 v[166:167], v[166:167], v[214:215]
v_pk_fma_f32 v[160:161], v[160:161], v[254:255], v[216:217] op_sel:[0,1,0] op_sel_hi:[1,1,1]
v_add_u32 v173, 0x10000, v160
v_and_b32 v173, 0xfffe0000, v173
v_pk_fma_f32 v[162:163], v[162:163], v[254:255], v[218:219] op_sel:[0,1,0] op_sel_hi:[1,1,1]
v_pk_fma_f32 v[164:165], v[164:165], v[254:255], v[220:221] op_sel:[0,1,0] op_sel_hi:[1,1,1]
v_pk_fma_f32 v[166:167], v[166:167], v[254:255], v[222:223] op_sel:[0,1,0] op_sel_hi:[1,1,1]
v_cvt_pk_bf16_f32 v168, v173, v161
v_cvt_pk_bf16_f32 v169, v162, v163
v_cvt_pk_bf16_f32 v170, v164, v165
v_cvt_pk_bf16_f32 v171, v166, v167
v_and_b32_e64 v168, -2, v168
s_add_u32 s31, s37, 32768
buffer_store_dwordx4 v[168:171], v224, s[4:7], s31 offen
s_cmp_lg_u32 s26, 0
s_mov_b64 exec, 3
s_cbranch_scc0 SS_47
buffer_store_dword v228, v239, s[4:7], s50 offen
SJ_48:
s_mov_b64 exec, -1
v_pk_add_f32 v[144:145], v[128:129], v[130:131]
v_pk_mul_f32 v[146:147], v[128:129], v[128:129]
v_pk_add_f32 v[144:145], v[144:145], v[132:133]
v_pk_fma_f32 v[146:147], v[130:131], v[130:131], v[146:147]
v_pk_add_f32 v[144:145], v[144:145], v[134:135]
v_pk_fma_f32 v[146:147], v[132:133], v[132:133], v[146:147]
v_add_f32 v144, v144, v145
v_pk_fma_f32 v[146:147], v[134:135], v[134:135], v[146:147]
v_add_f32 v145, v146, v147
ds_write_b64 v243, v[144:145] offset:0
v_cvt_pk_bf16_f32 v140, v128, v129
v_accvgpr_write_b32 a249, v137
v_accvgpr_write_b32 a250, v138
v_accvgpr_write_b32 a251, v139
v_accvgpr_write_b32 a248, v140
v_pk_add_f32 v[148:149], v[160:161], v[162:163]
v_pk_mul_f32 v[150:151], v[160:161], v[160:161]
v_pk_add_f32 v[148:149], v[148:149], v[164:165]
v_pk_fma_f32 v[150:151], v[162:163], v[162:163], v[150:151]
v_pk_add_f32 v[148:149], v[148:149], v[166:167]
v_pk_fma_f32 v[150:151], v[164:165], v[164:165], v[150:151]
v_add_f32 v148, v148, v149
v_pk_fma_f32 v[150:151], v[166:167], v[166:167], v[150:151]
v_add_f32 v149, v150, v151
ds_write_b64 v243, v[148:149] offset:2048
v_cvt_pk_bf16_f32 v172, v160, v161
v_accvgpr_write_b32 a253, v169
v_accvgpr_write_b32 a254, v170
v_accvgpr_write_b32 a255, v171
v_accvgpr_write_b32 a252, v172
s_waitcnt lgkmcnt(0)
s_barrier
buffer_load_dword v227, v226, s[4:7], s52 offen sc1
ds_read_b64 v[192:193], v237 offset:0
ds_read_b64 v[194:195], v237 offset:128
ds_read_b64 v[196:197], v237 offset:256
ds_read_b64 v[198:199], v237 offset:384
ds_read_b64 v[200:201], v237 offset:1024
ds_read_b64 v[202:203], v237 offset:1152
ds_read_b64 v[204:205], v237 offset:1280
ds_read_b64 v[206:207], v237 offset:1408
s_waitcnt lgkmcnt(6)
v_pk_add_f32 v[192:193], v[192:193], v[194:195]
s_waitcnt lgkmcnt(4)
v_pk_add_f32 v[196:197], v[196:197], v[198:199]
s_waitcnt lgkmcnt(2)
v_pk_add_f32 v[200:201], v[200:201], v[202:203]
s_waitcnt lgkmcnt(0)
v_pk_add_f32 v[204:205], v[204:205], v[206:207]
v_pk_add_f32 v[192:193], v[192:193], v[196:197]
v_pk_add_f32 v[200:201], v[200:201], v[204:205]
v_pk_add_f32 v[192:193], v[192:193], v[200:201]
v_and_or_b32 v193, v193, -4, 2
s_cmp_lg_u32 s26, 0
s_mov_b64 exec, 0xffff
s_cbranch_scc0 SS_49
buffer_store_dwordx2 v[192:193], v237, s[4:7], s38 offen
SJ_50:
s_mov_b64 exec, -1
s_waitcnt vmcnt(1)
CL_51:
v_cmp_ne_u32 vcc, s53, v227
s_nop 0
s_and_b32 s30, vcc_lo, -1
s_cbranch_scc0 CJ_52
buffer_load_dword v227, v226, s[4:7], s52 offen sc1
s_sub_i32 s59, s59, 1
s_cmp_lt_i32 s59, 0
s_waitcnt vmcnt(0)
s_cbranch_scc0 CL_51
CJ_52:
s_cmp_lg_u32 s26, 0
s_cbranch_scc0 AS_53
AJ_54:
s_barrier
L_P1R:
buffer_load_dwordx4 v[0:3], v224, s[4:7], s44 offen offset:0 sc1
buffer_load_dwordx4 v[4:7], v224, s[4:7], s44 offen offset:1024 sc1
buffer_load_dwordx4 v[8:11], v224, s[4:7], s44 offen offset:2048 sc1
buffer_load_dwordx4 v[12:15], v224, s[4:7], s44 offen offset:3072 sc1
s_add_u32 s33, s44, 4096
buffer_load_dwordx4 v[16:19], v224, s[4:7], s33 offen offset:0 sc1
buffer_load_dwordx4 v[20:23], v224, s[4:7], s33 offen offset:1024 sc1
buffer_load_dwordx4 v[24:27], v224, s[4:7], s33 offen offset:2048 sc1
buffer_load_dwordx4 v[28:31], v224, s[4:7], s33 offen offset:3072 sc1
s_add_u32 s33, s44, 8192
buffer_load_dwordx4 v[32:35], v224, s[4:7], s33 offen offset:0 sc1
buffer_load_dwordx4 v[36:39], v224, s[4:7], s33 offen offset:1024 sc1
buffer_load_dwordx4 v[40:43], v224, s[4:7], s33 offen offset:2048 sc1
buffer_load_dwordx4 v[44:47], v224, s[4:7], s33 offen offset:3072 sc1
s_add_u32 s33, s44, 12288
buffer_load_dwordx4 v[48:51], v224, s[4:7], s33 offen offset:0 sc1
buffer_load_dwordx4 v[52:55], v224, s[4:7], s33 offen offset:1024 sc1
ds_read_b128 v[196:199], v224 offset:0
ds_read_b128 v[200:203], v225 offset:49152
ds_read_b128 v[204:207], v224 offset:1024
ds_read_b128 v[208:211], v225 offset:50176
ds_read_b128 v[212:215], v224 offset:2048
ds_read_b128 v[216:219], v225 offset:51200
ds_read_b128 v[220:223], v224 offset:3072
s_waitcnt vmcnt(12) lgkmcnt(5)
v_mfma_f32_16x16x32_bf16 v[128:131], v[196:199], v[0:3], 0
ds_read_b128 v[192:195], v225 offset:52224
v_and_b32 v246, 0x1f0, v224
v_mfma_f32_16x16x32_bf16 v[132:135], v[196:199], v[4:7], 0
buffer_load_dwordx4 v[56:59], v224, s[4:7], s33 offen offset:2048 sc1
v_mfma_f32_16x16x32_bf16 v[148:151], v[200:203], v[4:7], 0
ds_read_b128 v[196:199], v224 offset:4096
s_lshl_b32 s32, s20, 9
v_mfma_f32_16x16x32_bf16 v[144:147], v[200:203], v[0:3], 0
s_add_u32 s32, s32, 131072
s_waitcnt lgkmcnt(5)
v_mfma_f32_16x16x32_bf16 v[136:139], v[204:207], v[0:3], 0
ds_read_b128 v[200:203], v225 offset:53248
v_or_b32 v231, v0, v4
v_mfma_f32_16x16x32_bf16 v[140:143], v[204:207], v[4:7], 0
buffer_load_dwordx4 v[60:63], v224, s[4:7], s33 offen offset:3072 sc1
v_mfma_f32_16x16x32_bf16 v[156:159], v[208:211], v[4:7], 0
ds_read_b128 v[204:207], v224 offset:5120
s_add_u32 s33, s44, 16384
v_mfma_f32_16x16x32_bf16 v[152:155], v[208:211], v[0:3], 0
v_lshrrev_b32 v247, 5, v240
s_waitcnt vmcnt(12) lgkmcnt(5)
v_mfma_f32_16x16x32_bf16 v[128:131], v[212:215], v[8:11], v[128:131]
ds_read_b128 v[208:211], v225 offset:54272
v_mul_u32_u24 v247, 2176, v247
v_mfma_f32_16x16x32_bf16 v[132:135], v[212:215], v[12:15], v[132:135]
buffer_load_dwordx4 v[64:67], v224, s[4:7], s33 offen offset:0 sc1
v_mfma_f32_16x16x32_bf16 v[148:151], v[216:219], v[12:15], v[148:151]
ds_read_b128 v[212:215], v224 offset:6144
v_add3_u32 v246, v246, v247, s32
v_mfma_f32_16x16x32_bf16 v[144:147], v[216:219], v[8:11], v[144:147]
v_add_u32 v247, v246, v247
s_waitcnt lgkmcnt(5)
v_mfma_f32_16x16x32_bf16 v[136:139], v[220:223], v[8:11], v[136:139]
ds_read_b128 v[216:219], v225 offset:55296
v_bitop3_b32 v231, v231, v8, v12 bitop3:0xfe
v_mfma_f32_16x16x32_bf16 v[140:143], v[220:223], v[12:15], v[140:143]
buffer_load_dwordx4 v[68:71], v224, s[4:7], s33 offen offset:1024 sc1
v_mfma_f32_16x16x32_bf16 v[156:159], v[192:195], v[12:15], v[156:159]
ds_read_b128 v[220:223], v224 offset:7168
v_lshrrev_b32 v248, 2, v240
v_mfma_f32_16x16x32_bf16 v[152:155], v[192:195], v[8:11], v[152:155]
v_lshlrev_b32 v248, 4, v248
s_waitcnt vmcnt(12) lgkmcnt(5)
v_mfma_f32_16x16x32_bf16 v[128:131], v[196:199], v[16:19], v[128:131]
ds_read_b128 v[192:195], v225 offset:56320
v_and_b32 v249, 1, v240
v_mfma_f32_16x16x32_bf16 v[132:135], v[196:199], v[20:23], v[132:135]
buffer_load_dwordx4 v[72:75], v224, s[4:7], s33 offen offset:2048 sc1
v_mfma_f32_16x16x32_bf16 v[148:151], v[200:203], v[20:23], v[148:151]
ds_read_b128 v[196:199], v224 offset:8192
v_lshl_add_u32 v248, v249, 3, v248
v_mfma_f32_16x16x32_bf16 v[144:147], v[200:203], v[16:19], v[144:147]
v_bfe_u32 v249, v240, 1, 1
s_waitcnt lgkmcnt(5)
v_mfma_f32_16x16x32_bf16 v[136:139], v[204:207], v[16:19], v[136:139]
ds_read_b128 v[200:203], v225 offset:57344
v_bitop3_b32 v231, v231, v16, v20 bitop3:0xfe
v_mfma_f32_16x16x32_bf16 v[140:143], v[204:207], v[20:23], v[140:143]
buffer_load_dwordx4 v[76:79], v224, s[4:7], s33 offen offset:3072 sc1
v_mfma_f32_16x16x32_bf16 v[156:159], v[208:211], v[20:23], v[156:159]
ds_read_b128 v[204:207], v224 offset:9216
s_add_u32 s33, s44, 20480
v_mfma_f32_16x16x32_bf16 v[152:155], v[208:211], v[16:19], v[152:155]
v_mul_u32_u24 v249, 2176, v249
s_waitcnt vmcnt(12) lgkmcnt(5)
v_mfma_f32_16x16x32_bf16 v[128:131], v[212:215], v[24:27], v[128:131]
ds_read_b128 v[208:211], v225 offset:58368
v_add_u32 v248, v248, v249
v_mfma_f32_16x16x32_bf16 v[132:135], v[212:215], v[28:31], v[132:135]
buffer_load_dwordx4 v[80:83], v224, s[4:7], s33 offen offset:0 sc1
v_mfma_f32_16x16x32_bf16 v[148:151], v[216:219], v[28:31], v[148:151]
ds_read_b128 v[212:215], v224 offset:10240
s_lshr_b32 s32, s20, 1
v_mfma_f32_16x16x32_bf16 v[144:147], v[216:219], v[24:27], v[144:147]
s_mul_i32 s32, s32, 4352
s_waitcnt lgkmcnt(5)
v_mfma_f32_16x16x32_bf16 v[136:139], v[220:223], v[24:27], v[136:139]
ds_read_b128 v[216:219], v225 offset:59392
v_bitop3_b32 v231, v231, v24, v28 bitop3:0xfe
v_mfma_f32_16x16x32_bf16 v[140:143], v[220:223], v[28:31], v[140:143]
buffer_load_dwordx4 v[84:87], v224, s[4:7], s33 offen offset:1024 sc1
v_mfma_f32_16x16x32_bf16 v[156:159], v[192:195], v[28:31], v[156:159]
ds_read_b128 v[220:223], v224 offset:11264
s_add_u32 s32, s32, 148480
v_mfma_f32_16x16x32_bf16 v[152:155], v[192:195], v[24:27], v[152:155]
v_add_u32 v249, s32, v248
s_waitcnt vmcnt(12) lgkmcnt(5)
v_mfma_f32_16x16x32_bf16 v[128:131], v[196:199], v[32:35], v[128:131]
ds_read_b128 v[192:195], v225 offset:60416
s_mul_i32 s32, s20, 4352
v_mfma_f32_16x16x32_bf16 v[132:135], v[196:199], v[36:39], v[132:135]
buffer_load_dwordx4 v[176:179], v245, s[4:7], s27 offen offset:0 sc1
v_mfma_f32_16x16x32_bf16 v[148:151], v[200:203], v[36:39], v[148:151]
ds_read_b128 v[196:199], v224 offset:12288
s_add_u32 s32, s32, 131072
v_mfma_f32_16x16x32_bf16 v[144:147], v[200:203], v[32:35], v[144:147]
v_add_u32 v248, s32, v248
s_waitcnt lgkmcnt(5)
v_mfma_f32_16x16x32_bf16 v[136:139], v[204:207], v[32:35], v[136:139]
ds_read_b128 v[200:203], v225 offset:61440
v_bitop3_b32 v231, v231, v32, v36 bitop3:0xfe
v_mfma_f32_16x16x32_bf16 v[140:143], v[204:207], v[36:39], v[140:143]
buffer_load_dwordx4 v[180:183], v245, s[4:7], s27 offen offset:512 sc1
v_mfma_f32_16x16x32_bf16 v[156:159], v[208:211], v[36:39], v[156:159]
ds_read_b128 v[204:207], v224 offset:13312
v_and_b32 v254, 0xf0, v224
v_mfma_f32_16x16x32_bf16 v[152:155], v[208:211], v[32:35], v[152:155]
v_bfe_u32 v255, v240, 4, 1
s_waitcnt vmcnt(12) lgkmcnt(5)
v_mfma_f32_16x16x32_bf16 v[128:131], v[212:215], v[40:43], v[128:131]
ds_read_b128 v[208:211], v225 offset:62464
v_lshl_add_u32 v254, v255, 3, v254
v_mfma_f32_16x16x32_bf16 v[132:135], v[212:215], v[44:47], v[132:135]
buffer_load_dwordx4 v[88:91], v224, s[4:7], s33 offen offset:2048 sc1
s_branch L_SK5
L_ST5:
s_setpc_b64 s[10:11]
L_SK5:
v_mfma_f32_16x16x32_bf16 v[148:151], v[216:219], v[44:47], v[148:151]
ds_read_b128 v[212:215], v224 offset:14336
v_lshrrev_b32 v255, 5, v240
v_mfma_f32_16x16x32_bf16 v[144:147], v[216:219], v[40:43], v[144:147]
v_lshl_add_u32 v254, v255, 8, v254
s_waitcnt lgkmcnt(5)
v_mfma_f32_16x16x32_bf16 v[136:139], v[220:223], v[40:43], v[136:139]
ds_read_b128 v[216:219], v225 offset:63488
v_bitop3_b32 v231, v231, v40, v44 bitop3:0xfe
v_mfma_f32_16x16x32_bf16 v[140:143], v[220:223], v[44:47], v[140:143]
buffer_load_dwordx4 v[92:95], v224, s[4:7], s33 offen offset:3072 sc1
v_mfma_f32_16x16x32_bf16 v[156:159], v[192:195], v[44:47], v[156:159]
ds_read_b128 v[220:223], v224 offset:15360
s_add_u32 s33, s44, 24576
v_mfma_f32_16x16x32_bf16 v[152:155], v[192:195], v[40:43], v[152:155]
v_and_b32 v255, 48, v240
s_waitcnt vmcnt(12) lgkmcnt(5)
v_mfma_f32_16x16x32_bf16 v[128:131], v[196:199], v[48:51], v[128:131]
ds_read_b128 v[192:195], v225 offset:64512
v_mov_b32 v250, 0x3f803f80
v_mfma_f32_16x16x32_bf16 v[132:135], v[196:199], v[52:55], v[132:135]
buffer_load_dwordx4 v[96:99], v224, s[4:7], s33 offen offset:0 sc1
v_mfma_f32_16x16x32_bf16 v[148:151], v[200:203], v[52:55], v[148:151]
ds_read_b128 v[196:199], v224 offset:16384
v_mov_b32 v251, 0x3f803f80
v_mfma_f32_16x16x32_bf16 v[144:147], v[200:203], v[48:51], v[144:147]
v_mov_b32 v252, 0x3f803f80
s_waitcnt lgkmcnt(5)
v_mfma_f32_16x16x32_bf16 v[136:139], v[204:207], v[48:51], v[136:139]
ds_read_b128 v[200:203], v225 offset:32768
v_bitop3_b32 v231, v231, v48, v52 bitop3:0xfe
v_mfma_f32_16x16x32_bf16 v[140:143], v[204:207], v[52:55], v[140:143]
buffer_load_dwordx4 v[100:103], v224, s[4:7], s33 offen offset:1024 sc1
v_mfma_f32_16x16x32_bf16 v[156:159], v[208:211], v[52:55], v[156:159]
ds_read_b128 v[204:207], v224 offset:17408
v_mov_b32 v253, 0x3f803f80
v_mfma_f32_16x16x32_bf16 v[152:155], v[208:211], v[48:51], v[152:155]
s_waitcnt vmcnt(12) lgkmcnt(5)
v_mfma_f32_16x16x32_bf16 v[128:131], v[212:215], v[56:59], v[128:131]
ds_read_b128 v[208:211], v225 offset:33792
v_mfma_f32_16x16x32_bf16 v[132:135], v[212:215], v[60:63], v[132:135]
buffer_load_dwordx4 v[104:107], v224, s[4:7], s33 offen offset:2048 sc1
v_mfma_f32_16x16x32_bf16 v[148:151], v[216:219], v[60:63], v[148:151]
ds_read_b128 v[212:215], v224 offset:18432
v_mfma_f32_16x16x32_bf16 v[144:147], v[216:219], v[56:59], v[144:147]
s_waitcnt lgkmcnt(5)
v_mfma_f32_16x16x32_bf16 v[136:139], v[220:223], v[56:59], v[136:139]
ds_read_b128 v[216:219], v225 offset:34816
v_bitop3_b32 v231, v231, v56, v60 bitop3:0xfe
v_mfma_f32_16x16x32_bf16 v[140:143], v[220:223], v[60:63], v[140:143]
buffer_load_dwordx4 v[108:111], v224, s[4:7], s33 offen offset:3072 sc1
v_mfma_f32_16x16x32_bf16 v[156:159], v[192:195], v[60:63], v[156:159]
ds_read_b128 v[220:223], v224 offset:19456
s_add_u32 s33, s44, 28672
v_mfma_f32_16x16x32_bf16 v[152:155], v[192:195], v[56:59], v[152:155]
s_waitcnt vmcnt(12) lgkmcnt(5)
v_mfma_f32_16x16x32_bf16 v[128:131], v[196:199], v[64:67], v[128:131]
ds_read_b128 v[192:195], v225 offset:35840
v_mfma_f32_16x16x32_bf16 v[132:135], v[196:199], v[68:71], v[132:135]
buffer_load_dwordx4 v[112:115], v224, s[4:7], s33 offen offset:0 sc1
v_mfma_f32_16x16x32_bf16 v[148:151], v[200:203], v[68:71], v[148:151]
ds_read_b128 v[196:199], v224 offset:20480
v_mfma_f32_16x16x32_bf16 v[144:147], v[200:203], v[64:67], v[144:147]
s_waitcnt lgkmcnt(5)
v_mfma_f32_16x16x32_bf16 v[136:139], v[204:207], v[64:67], v[136:139]
ds_read_b128 v[200:203], v225 offset:36864
v_bitop3_b32 v231, v231, v64, v68 bitop3:0xfe
v_mfma_f32_16x16x32_bf16 v[140:143], v[204:207], v[68:71], v[140:143]
buffer_load_dwordx4 v[116:119], v224, s[4:7], s33 offen offset:1024 sc1
v_mfma_f32_16x16x32_bf16 v[156:159], v[208:211], v[68:71], v[156:159]
ds_read_b128 v[204:207], v224 offset:21504
v_mfma_f32_16x16x32_bf16 v[152:155], v[208:211], v[64:67], v[152:155]
s_waitcnt vmcnt(12) lgkmcnt(5)
v_mfma_f32_16x16x32_bf16 v[128:131], v[212:215], v[72:75], v[128:131]
ds_read_b128 v[208:211], v225 offset:37888
v_mfma_f32_16x16x32_bf16 v[132:135], v[212:215], v[76:79], v[132:135]
buffer_load_dwordx4 v[120:123], v224, s[4:7], s33 offen offset:2048 sc1
v_mfma_f32_16x16x32_bf16 v[148:151], v[216:219], v[76:79], v[148:151]
ds_read_b128 v[212:215], v224 offset:22528
v_mfma_f32_16x16x32_bf16 v[144:147], v[216:219], v[72:75], v[144:147]
s_waitcnt lgkmcnt(5)
v_mfma_f32_16x16x32_bf16 v[136:139], v[220:223], v[72:75], v[136:139]
ds_read_b128 v[216:219], v225 offset:38912
v_bitop3_b32 v231, v231, v72, v76 bitop3:0xfe
v_mfma_f32_16x16x32_bf16 v[140:143], v[220:223], v[76:79], v[140:143]
buffer_load_dwordx4 v[124:127], v224, s[4:7], s33 offen offset:3072 sc1
v_mfma_f32_16x16x32_bf16 v[156:159], v[192:195], v[76:79], v[156:159]
ds_read_b128 v[220:223], v224 offset:23552
s_add_u32 m0, s41, 32768
v_mfma_f32_16x16x32_bf16 v[152:155], v[192:195], v[72:75], v[152:155]
s_add_u32 s34, s36, 65536
s_waitcnt vmcnt(12) lgkmcnt(5)
v_mfma_f32_16x16x32_bf16 v[128:131], v[196:199], v[80:83], v[128:131]
ds_read_b128 v[192:195], v225 offset:39936
v_mfma_f32_16x16x32_bf16 v[132:135], v[196:199], v[84:87], v[132:135]
buffer_load_dwordx4 v224, s[4:7], s34 offen offset:0 sc1 lds
v_mfma_f32_16x16x32_bf16 v[148:151], v[200:203], v[84:87], v[148:151]
ds_read_b128 v[196:199], v224 offset:24576
v_mfma_f32_16x16x32_bf16 v[144:147], v[200:203], v[80:83], v[144:147]
s_waitcnt lgkmcnt(5)
v_mfma_f32_16x16x32_bf16 v[136:139], v[204:207], v[80:83], v[136:139]
ds_read_b128 v[200:203], v225 offset:40960
v_bitop3_b32 v231, v231, v80, v84 bitop3:0xfe
v_mfma_f32_16x16x32_bf16 v[140:143], v[204:207], v[84:87], v[140:143]
buffer_load_dwordx4 v224, s[4:7], s34 offen offset:1024 sc1 lds
v_mfma_f32_16x16x32_bf16 v[156:159], v[208:211], v[84:87], v[156:159]
ds_read_b128 v[204:207], v224 offset:25600
v_mfma_f32_16x16x32_bf16 v[152:155], v[208:211], v[80:83], v[152:155]
s_waitcnt vmcnt(10) lgkmcnt(5)
v_mfma_f32_16x16x32_bf16 v[128:131], v[212:215], v[88:91], v[128:131]
ds_read_b128 v[208:211], v225 offset:41984
v_mfma_f32_16x16x32_bf16 v[132:135], v[212:215], v[92:95], v[132:135]
buffer_load_dwordx4 v224, s[4:7], s34 offen offset:2048 sc1 lds
v_mfma_f32_16x16x32_bf16 v[148:151], v[216:219], v[92:95], v[148:151]
ds_read_b128 v[212:215], v224 offset:26624
v_mfma_f32_16x16x32_bf16 v[144:147], v[216:219], v[88:91], v[144:147]
s_waitcnt lgkmcnt(5)
v_mfma_f32_16x16x32_bf16 v[136:139], v[220:223], v[88:91], v[136:139]
ds_read_b128 v[216:219], v225 offset:43008
v_bitop3_b32 v231, v231, v88, v92 bitop3:0xfe
v_mfma_f32_16x16x32_bf16 v[140:143], v[220:223], v[92:95], v[140:143]
buffer_load_dwordx4 v224, s[4:7], s34 offen offset:3072 sc1 lds
v_mfma_f32_16x16x32_bf16 v[156:159], v[192:195], v[92:95], v[156:159]
ds_read_b128 v[220:223], v224 offset:27648
s_add_u32 m0, s41, 65536
v_mfma_f32_16x16x32_bf16 v[152:155], v[192:195], v[88:91], v[152:155]
s_add_u32 s34, s36, 81920
s_waitcnt vmcnt(10) lgkmcnt(5)
v_mfma_f32_16x16x32_bf16 v[128:131], v[196:199], v[96:99], v[128:131]
ds_read_b128 v[192:195], v225 offset:44032
v_mfma_f32_16x16x32_bf16 v[132:135], v[196:199], v[100:103], v[132:135]
buffer_load_dwordx4 v224, s[4:7], s34 offen offset:0 sc1 lds
v_mfma_f32_16x16x32_bf16 v[148:151], v[200:203], v[100:103], v[148:151]
ds_read_b128 v[196:199], v224 offset:28672
v_mfma_f32_16x16x32_bf16 v[144:147], v[200:203], v[96:99], v[144:147]
s_waitcnt lgkmcnt(5)
v_mfma_f32_16x16x32_bf16 v[136:139], v[204:207], v[96:99], v[136:139]
ds_read_b128 v[200:203], v225 offset:45056
v_bitop3_b32 v231, v231, v96, v100 bitop3:0xfe
v_mfma_f32_16x16x32_bf16 v[140:143], v[204:207], v[100:103], v[140:143]
buffer_load_dwordx4 v224, s[4:7], s34 offen offset:1024 sc1 lds
v_mfma_f32_16x16x32_bf16 v[156:159], v[208:211], v[100:103], v[156:159]
ds_read_b128 v[204:207], v224 offset:29696
v_mfma_f32_16x16x32_bf16 v[152:155], v[208:211], v[96:99], v[152:155]
s_waitcnt vmcnt(10) lgkmcnt(5)
v_mfma_f32_16x16x32_bf16 v[128:131], v[212:215], v[104:107], v[128:131]
ds_read_b128 v[208:211], v225 offset:46080
v_mfma_f32_16x16x32_bf16 v[132:135], v[212:215], v[108:111], v[132:135]
buffer_load_dwordx4 v224, s[4:7], s34 offen offset:2048 sc1 lds
v_mfma_f32_16x16x32_bf16 v[148:151], v[216:219], v[108:111], v[148:151]
ds_read_b128 v[212:215], v224 offset:30720
v_mfma_f32_16x16x32_bf16 v[144:147], v[216:219], v[104:107], v[144:147]
s_waitcnt lgkmcnt(5)
v_mfma_f32_16x16x32_bf16 v[136:139], v[220:223], v[104:107], v[136:139]
ds_read_b128 v[216:219], v225 offset:47104
v_bitop3_b32 v231, v231, v104, v108 bitop3:0xfe
v_mfma_f32_16x16x32_bf16 v[140:143], v[220:223], v[108:111], v[140:143]
buffer_load_dwordx4 v224, s[4:7], s34 offen offset:3072 sc1 lds
v_mfma_f32_16x16x32_bf16 v[156:159], v[192:195], v[108:111], v[156:159]
ds_read_b128 v[220:223], v224 offset:31744
v_mfma_f32_16x16x32_bf16 v[152:155], v[192:195], v[104:107], v[152:155]
s_waitcnt vmcnt(10) lgkmcnt(5)
v_mfma_f32_16x16x32_bf16 v[128:131], v[196:199], v[112:115], v[128:131]
ds_read_b128 v[192:195], v225 offset:48128
v_mfma_f32_16x16x32_bf16 v[132:135], v[196:199], v[116:119], v[132:135]
v_xor_b32 v184, 2, v177
v_xor_b32 v185, 2, v179
v_xor_b32 v186, 2, v181
v_xor_b32 v187, 2, v183
v_or3_b32 v184, v184, v185, v186
v_or_b32 v184, v184, v187
v_and_b32 v184, 3, v184
v_cmp_ne_u32 vcc, 0, v184
s_cbranch_vccnz TR_57
TJ_59:
v_mfma_f32_16x16x32_bf16 v[148:151], v[200:203], v[116:119], v[148:151]
ds_read_b32 v196, v226 offset:0
v_add_f32 v176, v176, v180
v_mfma_f32_16x16x32_bf16 v[144:147], v[200:203], v[112:115], v[144:147]
v_add_f32 v177, v177, v181
s_waitcnt lgkmcnt(5)
v_mfma_f32_16x16x32_bf16 v[136:139], v[204:207], v[112:115], v[136:139]
ds_read_b32 v200, v226 offset:128
v_bitop3_b32 v231, v231, v112, v116 bitop3:0xfe
v_mfma_f32_16x16x32_bf16 v[140:143], v[204:207], v[116:119], v[140:143]
v_add_f32 v178, v178, v182
v_add_f32 v179, v179, v183
v_mfma_f32_16x16x32_bf16 v[156:159], v[208:211], v[116:119], v[156:159]
ds_read_b32 v204, v226 offset:64
v_add_f32_dpp v176, v176, v176 quad_perm:[1,0,3,2] row_mask:0xf bank_mask:0xf
v_mfma_f32_16x16x32_bf16 v[152:155], v[208:211], v[112:115], v[152:155]
v_add_f32_dpp v177, v177, v177 quad_perm:[1,0,3,2] row_mask:0xf bank_mask:0xf
s_waitcnt vmcnt(8) lgkmcnt(5)
v_mfma_f32_16x16x32_bf16 v[128:131], v[212:215], v[120:123], v[128:131]
ds_read_b32 v208, v226 offset:192
v_add_f32_dpp v178, v178, v178 quad_perm:[1,0,3,2] row_mask:0xf bank_mask:0xf
v_mfma_f32_16x16x32_bf16 v[132:135], v[212:215], v[124:127], v[132:135]
v_add_f32_dpp v179, v179, v179 quad_perm:[1,0,3,2] row_mask:0xf bank_mask:0xf
v_cndmask_b32 v176, v176, v178, s[64:65]
v_mfma_f32_16x16x32_bf16 v[148:151], v[216:219], v[124:127], v[148:151]
v_cndmask_b32 v177, v177, v179, s[64:65]
v_mov_b32 v178, v176
v_mfma_f32_16x16x32_bf16 v[144:147], v[216:219], v[120:123], v[144:147]
v_mov_b32 v179, v177
s_waitcnt lgkmcnt(4)
v_mfma_f32_16x16x32_bf16 v[136:139], v[220:223], v[120:123], v[136:139]
v_bitop3_b32 v231, v231, v120, v124 bitop3:0xfe
s_mov_b32 s35, 0x3b000000
v_mfma_f32_16x16x32_bf16 v[140:143], v[220:223], v[124:127], v[140:143]
v_and_b32 v231, 1, v231
v_permlane32_swap_b32 v176, v178
v_permlane32_swap_b32 v177, v179
v_add_f32 v176, v176, v178
v_add_f32 v177, v177, v179
v_mul_f32 v176, 0xbb000000, v176
v_mul_f32 v178, v176, v176
v_fma_f32 v177, v177, s35, -v178
v_cvt_pk_bf16_f32 v179, v176, v176
v_max_f32 v177, 0, v177
v_and_b32 v180, 0xffff0000, v179
v_add_f32 v177, 0x3727c5ac, v177
v_sub_f32 v180, v176, v180
v_rsq_f32 v236, v177
v_mov_b32 v229, 0
v_cvt_pk_bf16_f32 v180, v180, v180
v_mul_f32 v238, 0x3fb8aa3b, v236
v_cndmask_b32 v232, v179, v180, s[56:57]
v_mov_b32 v230, v236
v_mov_b32 v161, 0
v_mov_b32 v162, 0
v_mov_b32 v163, 0
v_permlane16_swap_b32 v232, v229
v_permlane16_swap_b32 v236, v230
v_mov_b32 v160, v229
v_mfma_f32_16x16x32_bf16 v[156:159], v[192:195], v[124:127], v[156:159]
v_cmp_ne_u32 s[66:67], 0, v231
v_mfma_f32_16x16x32_bf16 v[152:155], v[192:195], v[120:123], v[152:155]
s_waitcnt lgkmcnt(2)
v_mfma_f32_16x16x32_bf16 v[128:131], v[196:199], v[232:235], v[128:131]
s_cmp_lg_u64 s[66:67], 0
s_cbranch_scc1 VR_55
VJ_56:
v_mfma_f32_16x16x32_bf16 v[132:135], v[196:199], v[160:163], v[132:135]
s_barrier
v_mfma_f32_16x16x32_bf16 v[148:151], v[200:203], v[160:163], v[148:151]
v_mfma_f32_16x16x32_bf16 v[144:147], v[200:203], v[232:235], v[144:147]
s_waitcnt lgkmcnt(0)
v_mfma_f32_16x16x32_bf16 v[136:139], v[204:207], v[232:235], v[136:139]
v_mfma_f32_16x16x32_bf16 v[140:143], v[204:207], v[160:163], v[140:143]
v_mfma_f32_16x16x32_bf16 v[156:159], v[208:211], v[160:163], v[156:159]
v_mfma_f32_16x16x32_bf16 v[152:155], v[208:211], v[232:235], v[152:155]
s_lshl_b32 s30, s21, 9
s_add_u32 s35, s30, s47
s_lshl_b32 s31, s21, 6
s_add_u32 s31, s31, s48
s_and_b32 s32, s30, 0x1c00
v_cvt_pk_bf16_f32 v192, v128, v129
v_cvt_pk_bf16_f32 v193, v130, v131
v_cvt_pk_bf16_f32 v194, v132, v133
v_cvt_pk_bf16_f32 v195, v134, v135
v_cvt_pk_bf16_f32 v196, v136, v137
v_cvt_pk_bf16_f32 v197, v138, v139
v_cvt_pk_bf16_f32 v198, v140, v141
v_cvt_pk_bf16_f32 v199, v142, v143
v_permlane16_swap_b32 v192, v194
v_permlane16_swap_b32 v193, v195
v_permlane16_swap_b32 v196, v198
s_add_u32 m0, s41, 0
s_add_u32 s34, s36, 196608
buffer_load_dwordx4 v224, s[4:7], s34 offen offset:0 sc1 lds
v_permlane16_swap_b32 v197, v199
v_mfma_f32_32x32x16_bf16 v[160:175], a[240:243], v[192:195], 0
s_nop 0
v_mfma_f32_32x32x16_bf16 v[176:191], a[244:247], v[196:199], 0
v_mul_f32 v144, v236, v144
v_mul_f32 v145, v236, v145
v_mul_f32 v146, v236, v146
v_mul_f32 v147, v236, v147
v_mul_f32 v148, v230, v148
v_mul_f32 v149, v230, v149
v_mul_f32 v150, v230, v150
v_mul_f32 v151, v230, v151
v_mul_f32 v152, v236, v152
v_mul_f32 v153, v236, v153
v_mul_f32 v154, v236, v154
v_mul_f32 v155, v236, v155
v_mul_f32 v156, v230, v156
buffer_load_dwordx4 v224, s[4:7], s34 offen offset:1024 sc1 lds
v_mul_f32 v157, v230, v157
v_mul_f32 v158, v230, v158
v_mul_f32 v159, v230, v159
v_cvt_pk_bf16_f32 v200, v144, v145
v_cvt_pk_bf16_f32 v201, v146, v147
v_cvt_pk_bf16_f32 v202, v148, v149
v_cvt_pk_bf16_f32 v203, v150, v151
v_cvt_pk_bf16_f32 v204, v152, v153
v_cvt_pk_bf16_f32 v205, v154, v155
v_cvt_pk_bf16_f32 v206, v156, v157
v_cvt_pk_bf16_f32 v207, v158, v159
v_permlane16_swap_b32 v200, v202
v_permlane16_swap_b32 v201, v203
v_permlane16_swap_b32 v204, v206
v_permlane16_swap_b32 v205, v207
ds_write_b128 v246, v[200:203] offset:17408
buffer_load_dwordx4 v224, s[4:7], s34 offen offset:2048 sc1 lds
ds_write_b128 v246, v[204:207] offset:21760
v_max3_f32 v208, v160, v161, v162
v_max3_f32 v216, v176, v177, v178
v_max3_f32 v209, v163, v164, v165
v_max3_f32 v217, v179, v180, v181
v_max3_f32 v210, v166, v167, v168
v_max3_f32 v218, v182, v183, v184
v_max3_f32 v211, v169, v170, v171
v_max3_f32 v219, v185, v186, v187
v_max3_f32 v212, v172, v173, v174
v_max3_f32 v220, v188, v189, v190
v_max3_f32 v208, v208, v209, v175
v_max3_f32 v216, v216, v217, v191
v_max3_f32 v210, v210, v211, v212
v_max3_f32 v218, v218, v219, v220
v_max_f32 v208, v208, v210
buffer_load_dwordx4 v224, s[4:7], s34 offen offset:3072 sc1 lds
v_max_f32 v216, v216, v218
v_mul_f32 v208, v208, v238
v_mul_f32 v216, v216, v238
v_pk_fma_f32 v[160:161], v[160:161], v[238:239], v[208:209] op_sel_hi:[1,0,0] neg_lo:[0,0,1] neg_hi:[0,0,1]
v_pk_fma_f32 v[176:177], v[176:177], v[238:239], v[216:217] op_sel_hi:[1,0,0] neg_lo:[0,0,1] neg_hi:[0,0,1]
v_pk_fma_f32 v[162:163], v[162:163], v[238:239], v[208:209] op_sel_hi:[1,0,0] neg_lo:[0,0,1] neg_hi:[0,0,1]
v_pk_fma_f32 v[178:179], v[178:179], v[238:239], v[216:217] op_sel_hi:[1,0,0] neg_lo:[0,0,1] neg_hi:[0,0,1]
v_pk_fma_f32 v[164:165], v[164:165], v[238:239], v[208:209] op_sel_hi:[1,0,0] neg_lo:[0,0,1] neg_hi:[0,0,1]
v_pk_fma_f32 v[180:181], v[180:181], v[238:239], v[216:217] op_sel_hi:[1,0,0] neg_lo:[0,0,1] neg_hi:[0,0,1]
v_pk_fma_f32 v[166:167], v[166:167], v[238:239], v[208:209] op_sel_hi:[1,0,0] neg_lo:[0,0,1] neg_hi:[0,0,1]
v_pk_fma_f32 v[182:183], v[182:183], v[238:239], v[216:217] op_sel_hi:[1,0,0] neg_lo:[0,0,1] neg_hi:[0,0,1]
v_pk_fma_f32 v[168:169], v[168:169], v[238:239], v[208:209] op_sel_hi:[1,0,0] neg_lo:[0,0,1] neg_hi:[0,0,1]
v_pk_fma_f32 v[184:185], v[184:185], v[238:239], v[216:217] op_sel_hi:[1,0,0] neg_lo:[0,0,1] neg_hi:[0,0,1]
v_pk_fma_f32 v[170:171], v[170:171], v[238:239], v[208:209] op_sel_hi:[1,0,0] neg_lo:[0,0,1] neg_hi:[0,0,1]
v_pk_fma_f32 v[186:187], v[186:187], v[238:239], v[216:217] op_sel_hi:[1,0,0] neg_lo:[0,0,1] neg_hi:[0,0,1]
v_pk_fma_f32 v[172:173], v[172:173], v[238:239], v[208:209] op_sel_hi:[1,0,0] neg_lo:[0,0,1] neg_hi:[0,0,1]
s_add_u32 m0, s41, 16384
s_add_u32 s34, s36, 212992
buffer_load_dwordx4 v224, s[4:7], s34 offen offset:0 sc1 lds
v_pk_fma_f32 v[188:189], v[188:189], v[238:239], v[216:217] op_sel_hi:[1,0,0] neg_lo:[0,0,1] neg_hi:[0,0,1]
v_pk_fma_f32 v[174:175], v[174:175], v[238:239], v[208:209] op_sel_hi:[1,0,0] neg_lo:[0,0,1] neg_hi:[0,0,1]
v_pk_fma_f32 v[190:191], v[190:191], v[238:239], v[216:217] op_sel_hi:[1,0,0] neg_lo:[0,0,1] neg_hi:[0,0,1]
v_exp_f32 v160, v160
v_exp_f32 v176, v176
v_exp_f32 v161, v161
v_exp_f32 v177, v177
v_exp_f32 v162, v162
v_exp_f32 v178, v178
v_exp_f32 v163, v163
v_exp_f32 v179, v179
v_exp_f32 v164, v164
v_exp_f32 v180, v180
v_exp_f32 v165, v165
v_exp_f32 v181, v181
v_exp_f32 v166, v166
buffer_load_dwordx4 v224, s[4:7], s34 offen offset:1024 sc1 lds
v_exp_f32 v182, v182
v_exp_f32 v167, v167
v_exp_f32 v183, v183
v_exp_f32 v168, v168
v_exp_f32 v184, v184
v_exp_f32 v169, v169
v_exp_f32 v185, v185
v_exp_f32 v170, v170
v_exp_f32 v186, v186
v_exp_f32 v171, v171
v_exp_f32 v187, v187
v_exp_f32 v172, v172
v_exp_f32 v188, v188
v_exp_f32 v173, v173
v_exp_f32 v189, v189
v_exp_f32 v174, v174
buffer_load_dwordx4 v224, s[4:7], s34 offen offset:2048 sc1 lds
v_exp_f32 v190, v190
v_exp_f32 v175, v175
v_exp_f32 v191, v191
v_pk_add_f32 v[208:209], v[160:161], v[162:163]
v_pk_add_f32 v[216:217], v[176:177], v[178:179]
v_pk_add_f32 v[210:211], v[164:165], v[166:167]
v_pk_add_f32 v[218:219], v[180:181], v[182:183]
v_pk_add_f32 v[212:213], v[168:169], v[170:171]
v_pk_add_f32 v[220:221], v[184:185], v[186:187]
v_pk_add_f32 v[214:215], v[172:173], v[174:175]
v_pk_add_f32 v[222:223], v[188:189], v[190:191]
v_pk_add_f32 v[208:209], v[208:209], v[210:211]
v_pk_add_f32 v[216:217], v[216:217], v[218:219]
v_pk_add_f32 v[212:213], v[212:213], v[214:215]
v_pk_add_f32 v[220:221], v[220:221], v[222:223]
v_pk_add_f32 v[208:209], v[208:209], v[212:213]
buffer_load_dwordx4 v224, s[4:7], s34 offen offset:3072 sc1 lds
v_pk_add_f32 v[216:217], v[216:217], v[220:221]
v_add_f32 v208, v208, v209
v_add_f32 v216, v216, v217
v_rcp_f32 v208, v208
v_rcp_f32 v216, v216
v_pk_mul_f32 v[160:161], v[160:161], v[208:209] op_sel_hi:[1,0]
v_pk_mul_f32 v[176:177], v[176:177], v[216:217] op_sel_hi:[1,0]
v_pk_mul_f32 v[162:163], v[162:163], v[208:209] op_sel_hi:[1,0]
v_pk_mul_f32 v[178:179], v[178:179], v[216:217] op_sel_hi:[1,0]
v_pk_mul_f32 v[164:165], v[164:165], v[208:209] op_sel_hi:[1,0]
v_pk_mul_f32 v[180:181], v[180:181], v[216:217] op_sel_hi:[1,0]
v_pk_mul_f32 v[166:167], v[166:167], v[208:209] op_sel_hi:[1,0]
v_pk_mul_f32 v[182:183], v[182:183], v[216:217] op_sel_hi:[1,0]
v_pk_mul_f32 v[168:169], v[168:169], v[208:209] op_sel_hi:[1,0]
v_pk_mul_f32 v[184:185], v[184:185], v[216:217] op_sel_hi:[1,0]
v_pk_mul_f32 v[170:171], v[170:171], v[208:209] op_sel_hi:[1,0]
s_add_u32 m0, s41, 114688
s_add_u32 s34, s36, 163840
buffer_load_dwordx4 v224, s[4:7], s34 offen offset:0 sc1 lds
v_pk_mul_f32 v[186:187], v[186:187], v[216:217] op_sel_hi:[1,0]
v_pk_mul_f32 v[172:173], v[172:173], v[208:209] op_sel_hi:[1,0]
v_pk_mul_f32 v[188:189], v[188:189], v[216:217] op_sel_hi:[1,0]
v_pk_mul_f32 v[174:175], v[174:175], v[208:209] op_sel_hi:[1,0]
v_pk_mul_f32 v[190:191], v[190:191], v[216:217] op_sel_hi:[1,0]
v_cvt_pk_bf16_f32 v128, v160, v161
v_cvt_pk_bf16_f32 v136, v176, v177
v_cvt_pk_bf16_f32 v129, v162, v163
v_cvt_pk_bf16_f32 v137, v178, v179
v_cvt_pk_bf16_f32 v130, v164, v165
v_cvt_pk_bf16_f32 v138, v180, v181
v_cvt_pk_bf16_f32 v131, v166, v167
v_cvt_pk_bf16_f32 v139, v182, v183
ds_write_b128 v247, v[128:131] offset:0
ds_write_b128 v247, v[136:139] offset:8704
v_cvt_pk_bf16_f32 v132, v168, v169
v_cvt_pk_bf16_f32 v140, v184, v185
v_cvt_pk_bf16_f32 v133, v170, v171
v_cvt_pk_bf16_f32 v141, v186, v187
v_cvt_pk_bf16_f32 v134, v172, v173
v_cvt_pk_bf16_f32 v142, v188, v189
v_cvt_pk_bf16_f32 v135, v174, v175
v_cvt_pk_bf16_f32 v143, v190, v191
ds_write_b128 v247, v[132:135] offset:2176
ds_write_b128 v247, v[140:143] offset:10880
s_waitcnt vmcnt(9) lgkmcnt(0)
s_barrier
ds_read_b64_tr_b16 v[160:161], v248 offset:0
ds_read_b64_tr_b16 v[162:163], v248 offset:256
ds_read_b64_tr_b16 v[176:177], v249 offset:0
ds_read_b64_tr_b16 v[178:179], v249 offset:256
ds_read_b64_tr_b16 v[164:165], v248 offset:512
ds_read_b64_tr_b16 v[166:167], v248 offset:768
ds_read_b64_tr_b16 v[180:181], v249 offset:512
ds_read_b64_tr_b16 v[182:183], v249 offset:768
ds_read_b64_tr_b16 v[168:169], v248 offset:1024
ds_read_b64_tr_b16 v[170:171], v248 offset:1280
ds_read_b64_tr_b16 v[184:185], v249 offset:1024
ds_read_b64_tr_b16 v[186:187], v249 offset:1280
s_waitcnt lgkmcnt(8)
v_mfma_f32_16x16x32_bf16 v[148:151], v[160:163], v[250:253], 0
v_mfma_f32_16x16x32_bf16 v[144:147], v[160:163], v[176:179], 0
ds_read_b64_tr_b16 v[172:173], v248 offset:1536
ds_read_b64_tr_b16 v[174:175], v248 offset:1792
ds_read_b64_tr_b16 v[188:189], v249 offset:1536
ds_read_b64_tr_b16 v[190:191], v249 offset:1792
s_waitcnt lgkmcnt(8)
v_mfma_f32_16x16x32_bf16 v[148:151], v[164:167], v[250:253], v[148:151]
v_mfma_f32_16x16x32_bf16 v[144:147], v[164:167], v[180:183], v[144:147]
s_waitcnt lgkmcnt(4)
v_mfma_f32_16x16x32_bf16 v[148:151], v[168:171], v[250:253], v[148:151]
v_mfma_f32_16x16x32_bf16 v[144:147], v[168:171], v[184:187], v[144:147]
s_waitcnt lgkmcnt(0)
v_mfma_f32_16x16x32_bf16 v[148:151], v[172:175], v[250:253], v[148:151]
v_mfma_f32_16x16x32_bf16 v[144:147], v[172:175], v[188:191], v[144:147]
ds_read_b128 v[212:215], v224 offset:32768
ds_read_b128 v[216:219], v224 offset:33792
ds_read_b128 v[220:223], v224 offset:34816
ds_read_b128 v[192:195], v224 offset:35840
ds_read_b128 v[196:199], v224 offset:36864
ds_read_b128 v[200:203], v224 offset:37888
ds_read_b128 v[204:207], v224 offset:38912
v_min_u32 v148, -2, v148
v_cvt_pk_bf16_f32 v152, v144, v145
v_cvt_pk_bf16_f32 v153, v146, v147
v_min_u32 v152, -2, v152
buffer_store_dwordx2 v[152:153], v254, s[4:7], s35 offen sc1
s_mov_b32 exec_lo, 0x00010001
s_mov_b32 exec_hi, 0x00010001
buffer_store_dwordx4 v[148:151], v255, s[4:7], s31 offen sc1
s_mov_b64 exec, -1
s_waitcnt lgkmcnt(4)
v_mfma_f32_16x16x32_bf16 v[128:131], v[212:215], v[0:3], 0
ds_read_b128 v[208:211], v224 offset:39936
v_bfe_u32 v246, v240, 3, 1
v_mfma_f32_16x16x32_bf16 v[132:135], v[212:215], v[4:7], 0
v_bfe_u32 v247, v240, 4, 1
v_and_b32 v248, 16, v224
v_mfma_f32_16x16x32_bf16 v[140:143], v[216:219], v[4:7], 0
ds_read_b128 v[212:215], v224 offset:40960
v_mov_b32 v249, 0x3f80
v_mfma_f32_16x16x32_bf16 v[136:139], v[216:219], v[0:3], 0
v_cmp_eq_u32 vcc, v246, v247
v_lshlrev_b32 v248, v248, v249
v_mfma_f32_16x16x32_bf16 v[128:131], v[220:223], v[8:11], v[128:131]
ds_read_b128 v[216:219], v224 offset:41984
v_bfe_u32 v249, v240, 1, 2
v_mfma_f32_16x16x32_bf16 v[132:135], v[220:223], v[12:15], v[132:135]
v_cndmask_b32 v248, 0, v248, vcc
s_waitcnt lgkmcnt(4)
v_mfma_f32_16x16x32_bf16 v[140:143], v[192:195], v[12:15], v[140:143]
ds_read_b128 v[220:223], v224 offset:43008
v_cmp_eq_u32 vcc, 0, v249
v_mfma_f32_16x16x32_bf16 v[136:139], v[192:195], v[8:11], v[136:139]
buffer_load_dwordx4 v224, s[4:7], s34 offen offset:1024 sc1 lds
v_mfma_f32_16x16x32_bf16 v[128:131], v[196:199], v[16:19], v[128:131]
ds_read_b128 v[192:195], v224 offset:44032
v_and_b32 v246, 15, v240
v_mfma_f32_16x16x32_bf16 v[132:135], v[196:199], v[20:23], v[132:135]
v_lshl_add_u32 v255, v246, 6, v255
v_cndmask_b32 v250, 0, v248, vcc
v_mfma_f32_16x16x32_bf16 v[140:143], v[200:203], v[20:23], v[140:143]
ds_read_b128 v[196:199], v224 offset:45056
v_cmp_eq_u32 vcc, 1, v249
v_mfma_f32_16x16x32_bf16 v[136:139], v[200:203], v[16:19], v[136:139]
v_bfe_u32 v247, v240, 2, 1
s_waitcnt lgkmcnt(4)
v_mfma_f32_16x16x32_bf16 v[128:131], v[204:207], v[24:27], v[128:131]
ds_read_b128 v[200:203], v224 offset:46080
v_and_b32 v246, 3, v240
v_mfma_f32_16x16x32_bf16 v[132:135], v[204:207], v[28:31], v[132:135]
buffer_load_dwordx4 v224, s[4:7], s34 offen offset:2048 sc1 lds
v_mfma_f32_16x16x32_bf16 v[140:143], v[208:211], v[28:31], v[140:143]
ds_read_b128 v[204:207], v224 offset:47104
v_cndmask_b32 v251, 0, v248, vcc
v_mfma_f32_16x16x32_bf16 v[136:139], v[208:211], v[24:27], v[136:139]
v_cmp_eq_u32 vcc, 2, v249
v_lshl_add_u32 v246, v247, 3, v246
v_mfma_f32_16x16x32_bf16 v[128:131], v[212:215], v[32:35], v[128:131]
ds_read_b128 v[208:211], v224 offset:48128
v_bfe_u32 v247, v240, 3, 1
v_mfma_f32_16x16x32_bf16 v[132:135], v[212:215], v[36:39], v[132:135]
v_cndmask_b32 v252, 0, v248, vcc
s_waitcnt lgkmcnt(4)
v_mfma_f32_16x16x32_bf16 v[140:143], v[216:219], v[36:39], v[140:143]
ds_read_b128 v[212:215], v225 offset:0
v_cmp_eq_u32 vcc, 3, v249
v_mfma_f32_16x16x32_bf16 v[136:139], v[216:219], v[32:35], v[136:139]
v_lshl_add_u32 v246, v247, 2, v246
v_lshlrev_b32 v246, 4, v246
v_mfma_f32_16x16x32_bf16 v[128:131], v[220:223], v[40:43], v[128:131]
ds_read_b128 v[216:219], v225 offset:1024
v_cndmask_b32 v253, 0, v248, vcc
v_mfma_f32_16x16x32_bf16 v[132:135], v[220:223], v[44:47], v[132:135]
buffer_load_dwordx4 v224, s[4:7], s34 offen offset:3072 sc1 lds
v_mfma_f32_16x16x32_bf16 v[140:143], v[192:195], v[44:47], v[140:143]
ds_read_b128 v[220:223], v225 offset:2048
v_bfe_u32 v247, v240, 4, 1
v_mfma_f32_16x16x32_bf16 v[136:139], v[192:195], v[40:43], v[136:139]
v_lshl_add_u32 v246, v247, 3, v246
s_waitcnt lgkmcnt(4)
v_mfma_f32_16x16x32_bf16 v[128:131], v[196:199], v[48:51], v[128:131]
ds_read_b128 v[192:195], v225 offset:3072
v_lshrrev_b32 v247, 5, v240
v_mfma_f32_16x16x32_bf16 v[132:135], v[196:199], v[52:55], v[132:135]
v_lshl_add_u32 v246, v247, 10, v246
s_lshr_b32 s30, s20, 1
v_mfma_f32_16x16x32_bf16 v[140:143], v[200:203], v[52:55], v[140:143]
ds_read_b128 v[196:199], v225 offset:4096
s_add_u32 m0, s41, 98304
v_mfma_f32_16x16x32_bf16 v[136:139], v[200:203], v[48:51], v[136:139]
s_add_u32 s34, s36, 180224
s_lshl_b32 s30, s30, 11
v_mfma_f32_16x16x32_bf16 v[128:131], v[204:207], v[56:59], v[128:131]
ds_read_b128 v[200:203], v225 offset:5120
s_and_b32 s31, s20, 1
v_mfma_f32_16x16x32_bf16 v[132:135], v[204:207], v[60:63], v[132:135]
s_lshl_b32 s31, s31, 9
s_waitcnt lgkmcnt(4)
v_mfma_f32_16x16x32_bf16 v[140:143], v[208:211], v[60:63], v[140:143]
ds_read_b128 v[204:207], v225 offset:6144
s_add_u32 s30, s30, s31
v_mfma_f32_16x16x32_bf16 v[136:139], v[208:211], v[56:59], v[136:139]
buffer_load_dwordx4 v224, s[4:7], s34 offen offset:0 sc1 lds
v_mfma_f32_16x16x32_bf16 v[128:131], v[212:215], v[64:67], v[128:131]
ds_read_b128 v[208:211], v225 offset:7168
s_add_u32 s30, s30, 157184
v_mfma_f32_16x16x32_bf16 v[132:135], v[212:215], v[68:71], v[132:135]
v_add_u32 v246, s30, v246
v_add_u32 v247, 65536, v225
v_mfma_f32_16x16x32_bf16 v[140:143], v[216:219], v[68:71], v[140:143]
ds_read_b128 v[212:215], v225 offset:8192
s_add_u32 s33, s32, 1024
v_mfma_f32_16x16x32_bf16 v[136:139], v[216:219], v[64:67], v[136:139]
s_and_b32 s33, s33, 0x1c00
s_waitcnt lgkmcnt(4)
v_mfma_f32_16x16x32_bf16 v[128:131], v[220:223], v[72:75], v[128:131]
ds_read_b128 v[216:219], v225 offset:9216
s_add_u32 s33, s33, s47
v_mfma_f32_16x16x32_bf16 v[132:135], v[220:223], v[76:79], v[132:135]
buffer_load_dwordx4 v[0:3], v224, s[4:7], s33 offen sc1
v_mfma_f32_16x16x32_bf16 v[140:143], v[192:195], v[76:79], v[140:143]
ds_read_b128 v[220:223], v225 offset:10240
s_add_u32 s33, s32, 2048
v_mfma_f32_16x16x32_bf16 v[136:139], v[192:195], v[72:75], v[136:139]
s_and_b32 s33, s33, 0x1c00
s_branch L_SK6
L_ST6:
s_setpc_b64 s[10:11]
L_SK6:
s_add_u32 s53, s25, 1
v_mfma_f32_16x16x32_bf16 v[128:131], v[196:199], v[80:83], v[128:131]
ds_read_b128 v[192:195], v225 offset:11264
s_add_u32 s33, s33, s47
v_mfma_f32_16x16x32_bf16 v[132:135], v[196:199], v[84:87], v[132:135]
buffer_load_dwordx4 v224, s[4:7], s34 offen offset:1024 sc1 lds
s_waitcnt lgkmcnt(4)
v_mfma_f32_16x16x32_bf16 v[140:143], v[200:203], v[84:87], v[140:143]
ds_read_b128 v[196:199], v225 offset:12288
v_mov_b32 v228, s53
v_mfma_f32_16x16x32_bf16 v[136:139], v[200:203], v[80:83], v[136:139]
buffer_load_dwordx4 v[4:7], v224, s[4:7], s33 offen sc1
v_mfma_f32_16x16x32_bf16 v[128:131], v[204:207], v[88:91], v[128:131]
ds_read_b128 v[200:203], v225 offset:13312
s_add_u32 s33, s32, 3072
v_mfma_f32_16x16x32_bf16 v[132:135], v[204:207], v[92:95], v[132:135]
s_and_b32 s33, s33, 0x1c00
v_mov_b32 v160, v229
v_mfma_f32_16x16x32_bf16 v[140:143], v[208:211], v[92:95], v[140:143]
ds_read_b128 v[204:207], v225 offset:14336
s_add_u32 s33, s33, s47
v_mfma_f32_16x16x32_bf16 v[136:139], v[208:211], v[88:91], v[136:139]
v_mov_b32 v161, 0
s_waitcnt lgkmcnt(4)
v_mfma_f32_16x16x32_bf16 v[128:131], v[212:215], v[96:99], v[128:131]
ds_read_b128 v[208:211], v225 offset:15360
v_mov_b32 v162, 0
v_mfma_f32_16x16x32_bf16 v[132:135], v[212:215], v[100:103], v[132:135]
buffer_load_dwordx4 v[8:11], v224, s[4:7], s33 offen sc1
v_mov_b32 v163, 0
v_mfma_f32_16x16x32_bf16 v[140:143], v[216:219], v[100:103], v[140:143]
ds_read_b32 v212, v226 offset:256
s_add_u32 s33, s32, 4096
v_mfma_f32_16x16x32_bf16 v[136:139], v[216:219], v[96:99], v[136:139]
s_and_b32 s33, s33, 0x1c00
s_add_u32 s33, s33, s47
v_mfma_f32_16x16x32_bf16 v[128:131], v[220:223], v[104:107], v[128:131]
ds_read_b32 v216, v226 offset:320
v_mfma_f32_16x16x32_bf16 v[132:135], v[220:223], v[108:111], v[132:135]
buffer_load_dwordx4 v[12:15], v224, s[4:7], s33 offen sc1
s_waitcnt lgkmcnt(4)
v_mfma_f32_16x16x32_bf16 v[140:143], v[192:195], v[108:111], v[140:143]
s_add_u32 s33, s32, 5120
s_and_b32 s33, s33, 0x1c00
v_mfma_f32_16x16x32_bf16 v[136:139], v[192:195], v[104:107], v[136:139]
s_add_u32 s33, s33, s47
v_mfma_f32_16x16x32_bf16 v[128:131], v[196:199], v[112:115], v[128:131]
buffer_load_dwordx4 v[16:19], v224, s[4:7], s33 offen sc1
v_mfma_f32_16x16x32_bf16 v[132:135], v[196:199], v[116:119], v[132:135]
s_add_u32 s33, s32, 6144
s_and_b32 s33, s33, 0x1c00
v_mfma_f32_16x16x32_bf16 v[140:143], v[200:203], v[116:119], v[140:143]
s_add_u32 s33, s33, s47
v_mfma_f32_16x16x32_bf16 v[136:139], v[200:203], v[112:115], v[136:139]
s_waitcnt lgkmcnt(1)
v_mfma_f32_16x16x32_bf16 v[128:131], v[204:207], v[120:123], v[128:131]
buffer_load_dwordx4 v[20:23], v224, s[4:7], s33 offen sc1
v_mfma_f32_16x16x32_bf16 v[132:135], v[204:207], v[124:127], v[132:135]
s_add_u32 s33, s32, 7168
s_and_b32 s33, s33, 0x1c00
v_mfma_f32_16x16x32_bf16 v[140:143], v[208:211], v[124:127], v[140:143]
s_add_u32 s33, s33, s47
v_mfma_f32_16x16x32_bf16 v[136:139], v[208:211], v[120:123], v[136:139]
buffer_load_dwordx4 v[24:27], v224, s[4:7], s33 offen sc1
v_mfma_f32_16x16x32_bf16 v[128:131], v[212:215], v[232:235], v[128:131]
buffer_load_dwordx4 v[32:35], v255, s[4:7], s48 offen sc1
v_mfma_f32_16x16x32_bf16 v[132:135], v[212:215], v[160:163], v[132:135]
s_waitcnt lgkmcnt(0)
v_mfma_f32_16x16x32_bf16 v[140:143], v[216:219], v[160:163], v[140:143]
v_mfma_f32_16x16x32_bf16 v[136:139], v[216:219], v[232:235], v[136:139]
s_add_u32 s33, s32, 8192
s_and_b32 s33, s33, 0x1c00
s_add_u32 s33, s33, s47
buffer_load_dwordx4 v[28:31], v224, s[4:7], s33 offen sc1
v_cvt_pk_bf16_f32 v192, v128, v129
v_cvt_pk_bf16_f32 v193, v130, v131
v_cvt_pk_bf16_f32 v194, v132, v133
v_cvt_pk_bf16_f32 v195, v134, v135
v_cvt_pk_bf16_f32 v196, v136, v137
v_cvt_pk_bf16_f32 v197, v138, v139
v_cvt_pk_bf16_f32 v198, v140, v141
v_cvt_pk_bf16_f32 v199, v142, v143
v_permlane16_swap_b32 v192, v194
v_permlane16_swap_b32 v193, v195
v_permlane16_swap_b32 v196, v198
v_permlane16_swap_b32 v197, v199
v_mfma_f32_32x32x16_bf16 v[160:175], a[240:243], v[192:195], 0
s_nop 0
v_mfma_f32_32x32x16_bf16 v[176:191], a[244:247], v[196:199], 0
s_nop 9
v_max3_f32 v208, v160, v161, v162
s_nop 0
v_max3_f32 v216, v176, v177, v178
v_max3_f32 v209, v163, v164, v165
v_max3_f32 v217, v179, v180, v181
v_max3_f32 v210, v166, v167, v168
v_max3_f32 v218, v182, v183, v184
v_max3_f32 v211, v169, v170, v171
v_max3_f32 v219, v185, v186, v187
v_max3_f32 v212, v172, v173, v174
v_max3_f32 v220, v188, v189, v190
v_max3_f32 v208, v208, v209, v175
v_max3_f32 v216, v216, v217, v191
v_max3_f32 v210, v210, v211, v212
v_max3_f32 v218, v218, v219, v220
v_max_f32 v208, v208, v210
v_max_f32 v216, v216, v218
v_mul_f32 v208, v208, v238
v_mul_f32 v216, v216, v238
v_pk_fma_f32 v[160:161], v[160:161], v[238:239], v[208:209] op_sel_hi:[1,0,0] neg_lo:[0,0,1] neg_hi:[0,0,1]
v_pk_fma_f32 v[176:177], v[176:177], v[238:239], v[216:217] op_sel_hi:[1,0,0] neg_lo:[0,0,1] neg_hi:[0,0,1]
v_pk_fma_f32 v[162:163], v[162:163], v[238:239], v[208:209] op_sel_hi:[1,0,0] neg_lo:[0,0,1] neg_hi:[0,0,1]
v_pk_fma_f32 v[178:179], v[178:179], v[238:239], v[216:217] op_sel_hi:[1,0,0] neg_lo:[0,0,1] neg_hi:[0,0,1]
v_pk_fma_f32 v[164:165], v[164:165], v[238:239], v[208:209] op_sel_hi:[1,0,0] neg_lo:[0,0,1] neg_hi:[0,0,1]
v_pk_fma_f32 v[180:181], v[180:181], v[238:239], v[216:217] op_sel_hi:[1,0,0] neg_lo:[0,0,1] neg_hi:[0,0,1]
v_pk_fma_f32 v[166:167], v[166:167], v[238:239], v[208:209] op_sel_hi:[1,0,0] neg_lo:[0,0,1] neg_hi:[0,0,1]
v_pk_fma_f32 v[182:183], v[182:183], v[238:239], v[216:217] op_sel_hi:[1,0,0] neg_lo:[0,0,1] neg_hi:[0,0,1]
v_pk_fma_f32 v[168:169], v[168:169], v[238:239], v[208:209] op_sel_hi:[1,0,0] neg_lo:[0,0,1] neg_hi:[0,0,1]
v_pk_fma_f32 v[184:185], v[184:185], v[238:239], v[216:217] op_sel_hi:[1,0,0] neg_lo:[0,0,1] neg_hi:[0,0,1]
v_pk_fma_f32 v[170:171], v[170:171], v[238:239], v[208:209] op_sel_hi:[1,0,0] neg_lo:[0,0,1] neg_hi:[0,0,1]
v_pk_fma_f32 v[186:187], v[186:187], v[238:239], v[216:217] op_sel_hi:[1,0,0] neg_lo:[0,0,1] neg_hi:[0,0,1]
v_pk_fma_f32 v[172:173], v[172:173], v[238:239], v[208:209] op_sel_hi:[1,0,0] neg_lo:[0,0,1] neg_hi:[0,0,1]
v_pk_fma_f32 v[188:189], v[188:189], v[238:239], v[216:217] op_sel_hi:[1,0,0] neg_lo:[0,0,1] neg_hi:[0,0,1]
v_pk_fma_f32 v[174:175], v[174:175], v[238:239], v[208:209] op_sel_hi:[1,0,0] neg_lo:[0,0,1] neg_hi:[0,0,1]
v_pk_fma_f32 v[190:191], v[190:191], v[238:239], v[216:217] op_sel_hi:[1,0,0] neg_lo:[0,0,1] neg_hi:[0,0,1]
v_exp_f32 v160, v160
v_exp_f32 v176, v176
v_exp_f32 v161, v161
v_exp_f32 v177, v177
v_exp_f32 v162, v162
v_exp_f32 v178, v178
v_exp_f32 v163, v163
v_exp_f32 v179, v179
v_exp_f32 v164, v164
v_exp_f32 v180, v180
v_exp_f32 v165, v165
v_exp_f32 v181, v181
v_exp_f32 v166, v166
v_exp_f32 v182, v182
v_exp_f32 v167, v167
v_exp_f32 v183, v183
v_exp_f32 v168, v168
v_exp_f32 v184, v184
v_exp_f32 v169, v169
v_exp_f32 v185, v185
v_exp_f32 v170, v170
v_exp_f32 v186, v186
v_exp_f32 v171, v171
v_exp_f32 v187, v187
v_exp_f32 v172, v172
v_exp_f32 v188, v188
v_exp_f32 v173, v173
v_exp_f32 v189, v189
v_exp_f32 v174, v174
v_exp_f32 v190, v190
v_exp_f32 v175, v175
v_exp_f32 v191, v191
v_pk_add_f32 v[208:209], v[160:161], v[162:163]
v_pk_add_f32 v[216:217], v[176:177], v[178:179]
v_pk_add_f32 v[210:211], v[164:165], v[166:167]
v_pk_add_f32 v[218:219], v[180:181], v[182:183]
v_pk_add_f32 v[212:213], v[168:169], v[170:171]
v_pk_add_f32 v[220:221], v[184:185], v[186:187]
v_pk_add_f32 v[214:215], v[172:173], v[174:175]
v_pk_add_f32 v[222:223], v[188:189], v[190:191]
v_pk_add_f32 v[208:209], v[208:209], v[210:211]
v_pk_add_f32 v[216:217], v[216:217], v[218:219]
v_pk_add_f32 v[212:213], v[212:213], v[214:215]
v_pk_add_f32 v[220:221], v[220:221], v[222:223]
v_pk_add_f32 v[208:209], v[208:209], v[212:213]
v_pk_add_f32 v[216:217], v[216:217], v[220:221]
v_add_f32 v208, v208, v209
v_add_f32 v216, v216, v217
v_rcp_f32 v208, v208
v_rcp_f32 v216, v216
v_pk_mul_f32 v[160:161], v[160:161], v[208:209] op_sel_hi:[1,0]
v_pk_mul_f32 v[176:177], v[176:177], v[216:217] op_sel_hi:[1,0]
v_pk_mul_f32 v[162:163], v[162:163], v[208:209] op_sel_hi:[1,0]
v_pk_mul_f32 v[178:179], v[178:179], v[216:217] op_sel_hi:[1,0]
v_pk_mul_f32 v[164:165], v[164:165], v[208:209] op_sel_hi:[1,0]
v_pk_mul_f32 v[180:181], v[180:181], v[216:217] op_sel_hi:[1,0]
v_pk_mul_f32 v[166:167], v[166:167], v[208:209] op_sel_hi:[1,0]
v_pk_mul_f32 v[182:183], v[182:183], v[216:217] op_sel_hi:[1,0]
v_pk_mul_f32 v[168:169], v[168:169], v[208:209] op_sel_hi:[1,0]
v_pk_mul_f32 v[184:185], v[184:185], v[216:217] op_sel_hi:[1,0]
v_pk_mul_f32 v[170:171], v[170:171], v[208:209] op_sel_hi:[1,0]
v_pk_mul_f32 v[186:187], v[186:187], v[216:217] op_sel_hi:[1,0]
v_pk_mul_f32 v[172:173], v[172:173], v[208:209] op_sel_hi:[1,0]
v_pk_mul_f32 v[188:189], v[188:189], v[216:217] op_sel_hi:[1,0]
v_pk_mul_f32 v[174:175], v[174:175], v[208:209] op_sel_hi:[1,0]
v_pk_mul_f32 v[190:191], v[190:191], v[216:217] op_sel_hi:[1,0]
v_cvt_pk_bf16_f32 v128, v160, v161
v_cvt_pk_bf16_f32 v136, v176, v177
v_cvt_pk_bf16_f32 v129, v162, v163
v_cvt_pk_bf16_f32 v137, v178, v179
v_cvt_pk_bf16_f32 v130, v164, v165
v_cvt_pk_bf16_f32 v138, v180, v181
v_cvt_pk_bf16_f32 v131, v166, v167
v_cvt_pk_bf16_f32 v139, v182, v183
v_cvt_pk_bf16_f32 v132, v168, v169
v_cvt_pk_bf16_f32 v140, v184, v185
v_cvt_pk_bf16_f32 v133, v170, v171
v_cvt_pk_bf16_f32 v141, v186, v187
v_cvt_pk_bf16_f32 v134, v172, v173
v_cvt_pk_bf16_f32 v142, v188, v189
v_cvt_pk_bf16_f32 v135, v174, v175
v_cvt_pk_bf16_f32 v143, v190, v191
GJ_61:
s_waitcnt vmcnt(9)
v_mfma_f32_16x16x32_bf16 v[56:59], v[250:253], v[0:3], 0
v_max_u32_e64 v40, v0, v2
s_waitcnt vmcnt(7)
v_mfma_f32_16x16x32_bf16 v[56:59], v[250:253], v[4:7], v[56:59]
v_max3_u32 v40, v40, v4, v6
s_waitcnt vmcnt(6)
v_mfma_f32_16x16x32_bf16 v[56:59], v[250:253], v[8:11], v[56:59]
v_max3_u32 v40, v40, v8, v10
s_waitcnt vmcnt(5)
v_mfma_f32_16x16x32_bf16 v[56:59], v[250:253], v[12:15], v[56:59]
v_max3_u32 v40, v40, v12, v14
s_waitcnt vmcnt(4)
v_mfma_f32_16x16x32_bf16 v[56:59], v[250:253], v[16:19], v[56:59]
v_max3_u32 v40, v40, v16, v18
s_waitcnt vmcnt(3)
v_mfma_f32_16x16x32_bf16 v[56:59], v[250:253], v[20:23], v[56:59]
v_max3_u32 v40, v40, v20, v22
s_waitcnt vmcnt(2)
v_mfma_f32_16x16x32_bf16 v[56:59], v[250:253], v[24:27], v[56:59]
v_max3_u32 v40, v40, v24, v26
s_waitcnt vmcnt(1)
v_add_f32_dpp v36, v32, v32 row_ror:8 row_mask:0xf bank_mask:0xf
v_add_f32_dpp v37, v33, v33 row_ror:8 row_mask:0xf bank_mask:0xf
v_add_f32_dpp v38, v34, v34 row_ror:8 row_mask:0xf bank_mask:0xf
v_add_f32_dpp v39, v35, v35 row_ror:8 row_mask:0xf bank_mask:0xf
v_add_f32_dpp v36, v36, v36 row_ror:4 row_mask:0xf bank_mask:0xf
v_add_f32_dpp v37, v37, v37 row_ror:4 row_mask:0xf bank_mask:0xf
v_add_f32_dpp v38, v38, v38 row_ror:4 row_mask:0xf bank_mask:0xf
v_add_f32_dpp v39, v39, v39 row_ror:4 row_mask:0xf bank_mask:0xf
v_add_f32_dpp v36, v36, v36 row_ror:2 row_mask:0xf bank_mask:0xf
v_add_f32_dpp v37, v37, v37 row_ror:2 row_mask:0xf bank_mask:0xf
v_add_f32_dpp v38, v38, v38 row_ror:2 row_mask:0xf bank_mask:0xf
v_add_f32_dpp v39, v39, v39 row_ror:2 row_mask:0xf bank_mask:0xf
v_add_f32_dpp v36, v36, v36 row_ror:1 row_mask:0xf bank_mask:0xf
v_add_f32_dpp v37, v37, v37 row_ror:1 row_mask:0xf bank_mask:0xf
v_add_f32_dpp v38, v38, v38 row_ror:1 row_mask:0xf bank_mask:0xf
v_add_f32_dpp v39, v39, v39 row_ror:1 row_mask:0xf bank_mask:0xf
v_max_u32 v40, v40, v32
v_cvt_pk_bf16_f32 v44, v36, v37
v_cvt_pk_bf16_f32 v45, v38, v39
s_waitcnt vmcnt(0)
v_mfma_f32_16x16x32_bf16 v[56:59], v[250:253], v[28:31], v[56:59]
v_max3_u32 v40, v40, v28, v30
v_cmp_eq_u32 vcc, -1, v40
s_cbranch_vccnz GR_60
GK_62:
ds_write_b64 v246, v[44:45] offset:256
s_nop 3
v_cvt_pk_bf16_f32 v42, v56, v57
v_cvt_pk_bf16_f32 v43, v58, v59
ds_write_b64 v246, v[42:43]
s_waitcnt lgkmcnt(0)
s_barrier
ds_read_b128 v[0:3], v247 offset:26112
ds_read_b128 v[4:7], v247 offset:27136
ds_read_b128 v[8:11], v247 offset:28160
ds_read_b128 v[12:15], v247 offset:29184
s_waitcnt lgkmcnt(3)
v_mfma_f32_32x32x16_bf16 v[160:175], v[0:3], v[128:131], 0
s_waitcnt lgkmcnt(2)
v_mfma_f32_32x32x16_bf16 v[160:175], v[4:7], v[132:135], v[160:175]
s_waitcnt lgkmcnt(1)
v_mfma_f32_32x32x16_bf16 v[176:191], v[8:11], v[136:139], 0
s_waitcnt lgkmcnt(0)
v_mfma_f32_32x32x16_bf16 v[176:191], v[12:15], v[140:143], v[176:191]
v_xor_b32 v247, 2048, v242
v_xor_b32 v248, 4096, v242
v_xor_b32 v249, 6144, v242
v_accvgpr_read_b32 v217, a248
v_accvgpr_read_b32 v219, a249
v_accvgpr_read_b32 v221, a250
v_accvgpr_read_b32 v223, a251
v_lshlrev_b32 v216, 16, v217
v_and_b32 v217, 0xffff0000, v217
v_add_f32 v168, 0x358637bd, v168
v_rcp_f32 v168, v168
s_nop 0
v_pk_mul_f32 v[160:161], v[160:161], v[168:169] op_sel_hi:[1,0]
v_pk_mul_f32 v[162:163], v[162:163], v[168:169] op_sel_hi:[1,0]
v_pk_mul_f32 v[164:165], v[164:165], v[168:169] op_sel_hi:[1,0]
v_pk_mul_f32 v[166:167], v[166:167], v[168:169] op_sel_hi:[1,0]
v_and_b32 v160, 0xfffe0000, v160
v_cvt_pk_bf16_f32 v172, v160, v161
v_cvt_pk_bf16_f32 v173, v162, v163
v_cvt_pk_bf16_f32 v174, v164, v165
v_cvt_pk_bf16_f32 v175, v166, v167
v_or_b32 v172, 1, v172
buffer_store_dwordx4 v[172:175], v224, s[4:7], s45 offen offset:0
v_add_f32 v184, 0x358637bd, v184
v_rcp_f32_e64 v184, v184
s_nop 0
v_pk_mul_f32 v[176:177], v[176:177], v[184:185] op_sel_hi:[1,0]
v_pk_mul_f32 v[178:179], v[178:179], v[184:185] op_sel_hi:[1,0]
v_pk_mul_f32 v[180:181], v[180:181], v[184:185] op_sel_hi:[1,0]
v_pk_mul_f32 v[182:183], v[182:183], v[184:185] op_sel_hi:[1,0]
v_and_b32 v176, 0xfffe0000, v176
v_cvt_pk_bf16_f32 v188, v176, v177
v_cvt_pk_bf16_f32 v189, v178, v179
v_cvt_pk_bf16_f32 v190, v180, v181
v_cvt_pk_bf16_f32 v191, v182, v183
v_or_b32_e64 v188, 1, v188
buffer_store_dwordx4 v[188:191], v224, s[4:7], s45 offen offset:1024
s_cmp_lg_u32 s26, 0
s_mov_b64 exec, 1
s_cbranch_scc0 SS_71
buffer_store_dword v228, off, s[4:7], s49 offset:0
SJ_72:
s_mov_b64 exec, -1
v_lshlrev_b32 v218, 16, v219
v_and_b32 v219, 0xffff0000, v219
v_lshlrev_b32 v220, 16, v221
v_and_b32 v221, 0xffff0000, v221
v_lshlrev_b32 v222, 16, v223
v_and_b32 v223, 0xffff0000, v223
v_lshrrev_b32 v229, 5, v240
v_mul_u32_u24 v229, 1024, v229
v_bfe_u32 v230, v240, 4, 1
v_lshl_add_u32 v229, v230, 9, v229
v_and_b32 v230, 0xf0, v224
s_bfe_u32 s35, s41, 0x90004
v_add3_u32 v229, v229, v230, s35
v_xor_b32 v230, 0x100, v229
buffer_load_dword v227, v226, s[4:7], s51 offen sc1
s_waitcnt vmcnt(0)
CL_73:
v_cmp_ne_u32 vcc, s53, v227
s_nop 0
s_and_b32 s30, vcc_lo, 255
s_cbranch_scc0 CJ_74
buffer_load_dword v227, v226, s[4:7], s51 offen sc1
s_sub_i32 s59, s59, 1
s_cmp_lt_i32 s59, 0
s_waitcnt vmcnt(0)
s_cbranch_scc0 CL_73
CJ_74:
s_cmp_lg_u32 s26, 0
s_cbranch_scc0 AS_75
AJ_76:
s_add_u32 s33, s46, 0
buffer_load_dwordx4 v[0:3], v230, s[4:7], s33 offen sc1
s_add_u32 s33, s46, 6144
buffer_load_dwordx4 v[4:7], v230, s[4:7], s33 offen sc1
s_add_u32 s33, s46, 12288
buffer_load_dwordx4 v[8:11], v230, s[4:7], s33 offen sc1
s_add_u32 s33, s46, 18432
buffer_load_dwordx4 v[12:15], v230, s[4:7], s33 offen sc1
s_add_u32 s33, s46, 0
buffer_load_dwordx4 v[16:19], v229, s[4:7], s33 offen sc1
s_add_u32 s33, s46, 6144
buffer_load_dwordx4 v[20:23], v229, s[4:7], s33 offen sc1
s_add_u32 s33, s46, 12288
buffer_load_dwordx4 v[24:27], v229, s[4:7], s33 offen sc1
s_add_u32 s33, s46, 18432
buffer_load_dwordx4 v[28:31], v229, s[4:7], s33 offen sc1
s_add_u32 s33, s46, 98304
buffer_load_dwordx4 v[32:35], v230, s[4:7], s33 offen sc1
s_add_u32 s33, s46, 104448
buffer_load_dwordx4 v[36:39], v230, s[4:7], s33 offen sc1
s_add_u32 s33, s46, 110592
buffer_load_dwordx4 v[40:43], v230, s[4:7], s33 offen sc1
s_add_u32 s33, s46, 116736
buffer_load_dwordx4 v[44:47], v230, s[4:7], s33 offen sc1
s_waitcnt vmcnt(11)
v_mfma_f32_16x16x32_bf16 v[136:139], a[0:3], v[0:3], 0
s_add_u32 s33, s46, 98304
buffer_load_dwordx4 v[48:51], v229, s[4:7], s33 offen sc1
v_mfma_f32_16x16x32_bf16 v[140:143], a[4:7], v[0:3], 0
v_mfma_f32_16x16x32_bf16 v[152:155], a[8:11], v[0:3], 0
s_add_u32 s33, s46, 104448
buffer_load_dwordx4 v[52:55], v229, s[4:7], s33 offen sc1
v_mfma_f32_16x16x32_bf16 v[156:159], a[12:15], v[0:3], 0
s_waitcnt vmcnt(12)
v_mfma_f32_16x16x32_bf16 v[136:139], a[16:19], v[4:7], v[136:139]
s_add_u32 s33, s46, 110592
buffer_load_dwordx4 v[56:59], v229, s[4:7], s33 offen sc1
v_mfma_f32_16x16x32_bf16 v[140:143], a[20:23], v[4:7], v[140:143]
v_and_b32 v231, v0, v4
v_mfma_f32_16x16x32_bf16 v[152:155], a[24:27], v[4:7], v[152:155]
s_add_u32 s33, s46, 116736
buffer_load_dwordx4 v[60:63], v229, s[4:7], s33 offen sc1
v_mfma_f32_16x16x32_bf16 v[156:159], a[28:31], v[4:7], v[156:159]
s_waitcnt vmcnt(13)
v_mfma_f32_16x16x32_bf16 v[136:139], a[32:35], v[8:11], v[136:139]
v_mfma_f32_16x16x32_bf16 v[140:143], a[36:39], v[8:11], v[140:143]
buffer_load_dwordx4 v224, s[4:7], s34 offen offset:2048 sc1 lds
v_mfma_f32_16x16x32_bf16 v[152:155], a[40:43], v[8:11], v[152:155]
v_mfma_f32_16x16x32_bf16 v[156:159], a[44:47], v[8:11], v[156:159]
s_waitcnt vmcnt(13)
v_mfma_f32_16x16x32_bf16 v[136:139], a[48:51], v[12:15], v[136:139]
v_mfma_f32_16x16x32_bf16 v[140:143], a[52:55], v[12:15], v[140:143]
v_bitop3_b32 v231, v231, v8, v12 bitop3:0x80
buffer_load_dwordx4 v224, s[4:7], s34 offen offset:3072 sc1 lds
v_mfma_f32_16x16x32_bf16 v[152:155], a[56:59], v[12:15], v[152:155]
v_mfma_f32_16x16x32_bf16 v[156:159], a[60:63], v[12:15], v[156:159]
s_waitcnt vmcnt(13)
v_mfma_f32_16x16x32_bf16 v[128:131], a[0:3], v[16:19], 0
v_mfma_f32_16x16x32_bf16 v[132:135], a[4:7], v[16:19], 0
v_mfma_f32_16x16x32_bf16 v[144:147], a[8:11], v[16:19], 0
ds_write_b128 v247, v[136:139] offset:0
v_mfma_f32_16x16x32_bf16 v[148:151], a[12:15], v[16:19], 0
s_waitcnt vmcnt(12)
v_mfma_f32_16x16x32_bf16 v[128:131], a[16:19], v[20:23], v[128:131]
v_mfma_f32_16x16x32_bf16 v[132:135], a[20:23], v[20:23], v[132:135]
v_bitop3_b32 v231, v231, v16, v20 bitop3:0x80
v_mfma_f32_16x16x32_bf16 v[144:147], a[24:27], v[20:23], v[144:147]
ds_write_b128 v247, v[140:143] offset:1024
v_mfma_f32_16x16x32_bf16 v[148:151], a[28:31], v[20:23], v[148:151]
s_waitcnt vmcnt(11)
v_mfma_f32_16x16x32_bf16 v[128:131], a[32:35], v[24:27], v[128:131]
ds_write_b128 v249, v[152:155] offset:16384
v_mfma_f32_16x16x32_bf16 v[132:135], a[36:39], v[24:27], v[132:135]
v_mfma_f32_16x16x32_bf16 v[144:147], a[40:43], v[24:27], v[144:147]
ds_write_b128 v249, v[156:159] offset:17408
v_mfma_f32_16x16x32_bf16 v[148:151], a[44:47], v[24:27], v[148:151]
s_waitcnt vmcnt(10)
v_mfma_f32_16x16x32_bf16 v[128:131], a[48:51], v[28:31], v[128:131]
v_mfma_f32_16x16x32_bf16 v[132:135], a[52:55], v[28:31], v[132:135]
v_bitop3_b32 v231, v231, v24, v28 bitop3:0x80
v_and_b32 v231, 1, v231
v_cmp_ne_u32 s[66:67], 1, v231
v_mfma_f32_16x16x32_bf16 v[144:147], a[56:59], v[28:31], v[144:147]
v_mfma_f32_16x16x32_bf16 v[148:151], a[60:63], v[28:31], v[148:151]
s_cmp_lg_u64 s[66:67], 0
s_cbranch_scc1 VR_77
VJ_78:
s_waitcnt vmcnt(9)
v_mfma_f32_16x16x32_bf16 v[168:171], a[0:3], v[32:35], 0
v_mfma_f32_16x16x32_bf16 v[172:175], a[4:7], v[32:35], 0
s_add_u32 s53, s25, 3
v_mfma_f32_16x16x32_bf16 v[184:187], a[8:11], v[32:35], 0
v_mfma_f32_16x16x32_bf16 v[188:191], a[12:15], v[32:35], 0
ds_write_b128 v248, v[144:147] offset:8192
v_mov_b32 v228, s53
s_waitcnt vmcnt(8)
v_mfma_f32_16x16x32_bf16 v[168:171], a[16:19], v[36:39], v[168:171]
v_mfma_f32_16x16x32_bf16 v[172:175], a[20:23], v[36:39], v[172:175]
v_and_b32 v231, v32, v36
ds_write_b128 v248, v[148:151] offset:9216
v_mfma_f32_16x16x32_bf16 v[184:187], a[24:27], v[36:39], v[184:187]
v_mfma_f32_16x16x32_bf16 v[188:191], a[28:31], v[36:39], v[188:191]
s_waitcnt vmcnt(7)
v_mfma_f32_16x16x32_bf16 v[168:171], a[32:35], v[40:43], v[168:171]
v_mfma_f32_16x16x32_bf16 v[172:175], a[36:39], v[40:43], v[172:175]
s_waitcnt lgkmcnt(0)
s_barrier
ds_read_b128 v[192:195], v242 offset:0
ds_read_b128 v[196:199], v242 offset:1024
ds_read_b128 v[200:203], v242 offset:8192
v_mfma_f32_16x16x32_bf16 v[184:187], a[40:43], v[40:43], v[184:187]
v_mfma_f32_16x16x32_bf16 v[188:191], a[44:47], v[40:43], v[188:191]
ds_read_b128 v[204:207], v242 offset:9216
ds_read_b128 v[208:211], v242 offset:16384
ds_read_b128 v[212:215], v242 offset:17408
s_waitcnt vmcnt(6)
v_mfma_f32_16x16x32_bf16 v[168:171], a[48:51], v[44:47], v[168:171]
v_mfma_f32_16x16x32_bf16 v[172:175], a[52:55], v[44:47], v[172:175]
v_bitop3_b32 v231, v231, v40, v44 bitop3:0x80
v_mfma_f32_16x16x32_bf16 v[184:187], a[56:59], v[44:47], v[184:187]
v_mfma_f32_16x16x32_bf16 v[188:191], a[60:63], v[44:47], v[188:191]
s_waitcnt vmcnt(5)
v_mfma_f32_16x16x32_bf16 v[160:163], a[0:3], v[48:51], 0
v_mfma_f32_16x16x32_bf16 v[164:167], a[4:7], v[48:51], 0
s_waitcnt lgkmcnt(0)
s_barrier
v_mfma_f32_16x16x32_bf16 v[176:179], a[8:11], v[48:51], 0
v_mfma_f32_16x16x32_bf16 v[180:183], a[12:15], v[48:51], 0
ds_write_b128 v247, v[168:171] offset:0
s_waitcnt vmcnt(4)
v_mfma_f32_16x16x32_bf16 v[160:163], a[16:19], v[52:55], v[160:163]
v_mfma_f32_16x16x32_bf16 v[164:167], a[20:23], v[52:55], v[164:167]
v_bitop3_b32 v231, v231, v48, v52 bitop3:0x80
v_mfma_f32_16x16x32_bf16 v[176:179], a[24:27], v[52:55], v[176:179]
v_mfma_f32_16x16x32_bf16 v[180:183], a[28:31], v[52:55], v[180:183]
ds_write_b128 v247, v[172:175] offset:1024
s_waitcnt vmcnt(3)
v_mfma_f32_16x16x32_bf16 v[160:163], a[32:35], v[56:59], v[160:163]
v_mfma_f32_16x16x32_bf16 v[164:167], a[36:39], v[56:59], v[164:167]
ds_write_b128 v249, v[184:187] offset:16384
v_mfma_f32_16x16x32_bf16 v[176:179], a[40:43], v[56:59], v[176:179]
v_mfma_f32_16x16x32_bf16 v[180:183], a[44:47], v[56:59], v[180:183]
ds_write_b128 v249, v[188:191] offset:17408
s_waitcnt vmcnt(2)
v_mfma_f32_16x16x32_bf16 v[160:163], a[48:51], v[60:63], v[160:163]
v_mfma_f32_16x16x32_bf16 v[164:167], a[52:55], v[60:63], v[164:167]
v_bitop3_b32 v231, v231, v56, v60 bitop3:0x80
v_and_b32 v231, 1, v231
v_cmp_ne_u32 s[66:67], 1, v231
v_mfma_f32_16x16x32_bf16 v[176:179], a[56:59], v[60:63], v[176:179]
v_mfma_f32_16x16x32_bf16 v[180:183], a[60:63], v[60:63], v[180:183]
s_cmp_lg_u64 s[66:67], 0
s_cbranch_scc1 VR_79
VJ_80:
v_add_f32 v128, v128, v192
v_add_f32 v129, v129, v193
v_add_f32 v130, v130, v194
v_add_f32 v131, v131, v195
v_add_f32 v132, v132, v196
v_add_f32 v133, v133, v197
v_add_f32 v134, v134, v198
v_add_f32 v135, v135, v199
ds_write_b128 v248, v[176:179] offset:8192
v_pk_add_f32 v[128:129], v[128:129], v[200:201]
v_pk_add_f32 v[130:131], v[130:131], v[202:203]
v_pk_add_f32 v[132:133], v[132:133], v[204:205]
v_pk_add_f32 v[134:135], v[134:135], v[206:207]
v_pk_add_f32 v[128:129], v[128:129], v[208:209]
v_pk_add_f32 v[130:131], v[130:131], v[210:211]
v_pk_add_f32 v[132:133], v[132:133], v[212:213]
v_pk_add_f32 v[134:135], v[134:135], v[214:215]
v_pk_add_f32 v[128:129], v[128:129], v[216:217]
v_and_b32 v141, 0xfffe0000, v128
v_pk_add_f32 v[130:131], v[130:131], v[218:219]
v_pk_add_f32 v[132:133], v[132:133], v[220:221]
v_pk_add_f32 v[134:135], v[134:135], v[222:223]
v_cvt_pk_bf16_f32 v136, v141, v129
v_cvt_pk_bf16_f32 v137, v130, v131
ds_write_b128 v248, v[180:183] offset:9216
v_cvt_pk_bf16_f32 v138, v132, v133
v_cvt_pk_bf16_f32 v139, v134, v135
v_or_b32_e64 v136, 1, v136
s_add_u32 s31, s37, 0
buffer_store_dwordx4 v[136:139], v224, s[4:7], s31 offen nt
v_accvgpr_read_b32 v217, a252
v_accvgpr_read_b32 v219, a253
v_accvgpr_read_b32 v221, a254
v_accvgpr_read_b32 v223, a255
v_lshlrev_b32 v216, 16, v217
v_and_b32 v217, 0xffff0000, v217
v_lshlrev_b32 v218, 16, v219
v_and_b32 v219, 0xffff0000, v219
v_lshlrev_b32 v220, 16, v221
v_and_b32 v221, 0xffff0000, v221
v_lshlrev_b32 v222, 16, v223
v_and_b32 v223, 0xffff0000, v223
s_waitcnt lgkmcnt(0)
s_barrier
ds_read_b128 v[192:195], v242 offset:0
ds_read_b128 v[196:199], v242 offset:1024
ds_read_b128 v[200:203], v242 offset:8192
ds_read_b128 v[204:207], v242 offset:9216
ds_read_b128 v[208:211], v242 offset:16384
ds_read_b128 v[212:215], v242 offset:17408
s_waitcnt lgkmcnt(4)
v_pk_add_f32 v[160:161], v[160:161], v[192:193]
v_pk_add_f32 v[162:163], v[162:163], v[194:195]
v_pk_add_f32 v[164:165], v[164:165], v[196:197]
v_pk_add_f32 v[166:167], v[166:167], v[198:199]
s_waitcnt lgkmcnt(2)
v_pk_add_f32 v[160:161], v[160:161], v[200:201]
v_pk_add_f32 v[162:163], v[162:163], v[202:203]
v_pk_add_f32 v[164:165], v[164:165], v[204:205]
v_pk_add_f32 v[166:167], v[166:167], v[206:207]
s_waitcnt lgkmcnt(0)
v_pk_add_f32 v[160:161], v[160:161], v[208:209]
v_pk_add_f32 v[162:163], v[162:163], v[210:211]
v_pk_add_f32 v[164:165], v[164:165], v[212:213]
v_pk_add_f32 v[166:167], v[166:167], v[214:215]
v_pk_add_f32 v[160:161], v[160:161], v[216:217]
v_and_b32 v173, 0xfffe0000, v160
v_pk_add_f32 v[162:163], v[162:163], v[218:219]
v_pk_add_f32 v[164:165], v[164:165], v[220:221]
v_pk_add_f32 v[166:167], v[166:167], v[222:223]
v_cvt_pk_bf16_f32 v168, v173, v161
v_cvt_pk_bf16_f32 v169, v162, v163
v_cvt_pk_bf16_f32 v170, v164, v165
v_cvt_pk_bf16_f32 v171, v166, v167
v_or_b32 v168, 1, v168
s_add_u32 s31, s37, 32768
buffer_store_dwordx4 v[168:171], v224, s[4:7], s31 offen nt
s_cmp_lg_u32 s26, 0
s_mov_b64 exec, 3
s_cbranch_scc0 SS_81
buffer_store_dword v228, v239, s[4:7], s50 offen
SJ_82:
s_mov_b64 exec, -1
v_pk_add_f32 v[144:145], v[128:129], v[130:131]
v_pk_mul_f32 v[146:147], v[128:129], v[128:129]
v_pk_add_f32 v[144:145], v[144:145], v[132:133]
v_pk_fma_f32 v[146:147], v[130:131], v[130:131], v[146:147]
v_pk_add_f32 v[144:145], v[144:145], v[134:135]
v_pk_fma_f32 v[146:147], v[132:133], v[132:133], v[146:147]
v_add_f32 v144, v144, v145
v_pk_fma_f32 v[146:147], v[134:135], v[134:135], v[146:147]
v_add_f32_e64 v145, v146, v147
ds_write_b64 v243, v[144:145] offset:0
v_cvt_pk_bf16_f32 v140, v128, v129
v_accvgpr_write_b32 a249, v137
v_accvgpr_write_b32 a250, v138
v_accvgpr_write_b32 a251, v139
v_accvgpr_write_b32 a248, v140
v_pk_add_f32 v[148:149], v[160:161], v[162:163]
v_pk_mul_f32 v[150:151], v[160:161], v[160:161]
s_branch L_SK7
L_ST7:
s_setpc_b64 s[10:11]
L_SK7:
v_pk_add_f32 v[148:149], v[148:149], v[164:165]
v_pk_fma_f32 v[150:151], v[162:163], v[162:163], v[150:151]
v_pk_add_f32 v[148:149], v[148:149], v[166:167]
v_pk_fma_f32 v[150:151], v[164:165], v[164:165], v[150:151]
v_add_f32 v148, v148, v149
v_pk_fma_f32 v[150:151], v[166:167], v[166:167], v[150:151]
v_add_f32 v149, v150, v151
ds_write_b64 v243, v[148:149] offset:2048
v_cvt_pk_bf16_f32 v172, v160, v161
v_accvgpr_write_b32 a253, v169
v_accvgpr_write_b32 a254, v170
v_accvgpr_write_b32 a255, v171
v_accvgpr_write_b32 a252, v172
s_waitcnt lgkmcnt(0)
s_barrier
buffer_load_dword v227, v226, s[4:7], s52 offen sc1
ds_read_b64 v[192:193], v237 offset:0
ds_read_b64 v[194:195], v237 offset:128
ds_read_b64 v[196:197], v237 offset:256
ds_read_b64 v[198:199], v237 offset:384
ds_read_b64 v[200:201], v237 offset:1024
ds_read_b64 v[202:203], v237 offset:1152
ds_read_b64 v[204:205], v237 offset:1280
ds_read_b64 v[206:207], v237 offset:1408
s_waitcnt lgkmcnt(6)
v_pk_add_f32 v[192:193], v[192:193], v[194:195]
s_waitcnt lgkmcnt(4)
v_pk_add_f32 v[196:197], v[196:197], v[198:199]
s_waitcnt lgkmcnt(2)
v_pk_add_f32 v[200:201], v[200:201], v[202:203]
s_waitcnt lgkmcnt(0)
v_pk_add_f32 v[204:205], v[204:205], v[206:207]
v_pk_add_f32 v[192:193], v[192:193], v[196:197]
v_pk_add_f32 v[200:201], v[200:201], v[204:205]
v_pk_add_f32 v[192:193], v[192:193], v[200:201]
v_and_or_b32 v193, v193, -4, 3
s_cmp_lg_u32 s26, 0
s_mov_b64 exec, 0xffff
s_cbranch_scc0 SS_83
buffer_store_dwordx2 v[192:193], v237, s[4:7], s38 offen
SJ_84:
s_mov_b64 exec, -1
s_waitcnt vmcnt(1)
CL_85:
v_cmp_ne_u32 vcc, s53, v227
s_nop 0
s_and_b32 s30, vcc_lo, -1
s_cbranch_scc0 CJ_86
buffer_load_dword v227, v226, s[4:7], s52 offen sc1
s_sub_i32 s59, s59, 1
s_cmp_lt_i32 s59, 0
s_waitcnt vmcnt(0)
s_cbranch_scc0 CL_85
CJ_86:
s_cmp_lg_u32 s26, 0
s_cbranch_scc0 AS_87
AJ_88:
buffer_load_dwordx4 v[0:3], v224, s[4:7], s44 offen offset:0 sc1
buffer_load_dwordx4 v[4:7], v224, s[4:7], s44 offen offset:1024 sc1
buffer_load_dwordx4 v[8:11], v224, s[4:7], s44 offen offset:2048 sc1
buffer_load_dwordx4 v[12:15], v224, s[4:7], s44 offen offset:3072 sc1
s_add_u32 s33, s44, 4096
buffer_load_dwordx4 v[16:19], v224, s[4:7], s33 offen offset:0 sc1
buffer_load_dwordx4 v[20:23], v224, s[4:7], s33 offen offset:1024 sc1
buffer_load_dwordx4 v[24:27], v224, s[4:7], s33 offen offset:2048 sc1
buffer_load_dwordx4 v[28:31], v224, s[4:7], s33 offen offset:3072 sc1
s_add_u32 s33, s44, 8192
buffer_load_dwordx4 v[32:35], v224, s[4:7], s33 offen offset:0 sc1
buffer_load_dwordx4 v[36:39], v224, s[4:7], s33 offen offset:1024 sc1
s_barrier
L_P3R1:
ds_read_b128 v[220:223], v224 offset:49152
ds_read_b128 v[192:195], v224 offset:0
ds_read_b128 v[196:199], v225 offset:49152
ds_read_b128 v[200:203], v224 offset:50176
ds_read_b128 v[204:207], v224 offset:1024
ds_read_b128 v[208:211], v225 offset:50176
ds_read_b128 v[212:215], v224 offset:51200
s_waitcnt vmcnt(8) lgkmcnt(4)
v_mfma_f32_16x16x32_bf16 v[128:131], v[220:223], v[0:3], 0
ds_read_b128 v[216:219], v224 offset:2048
v_mfma_f32_16x16x32_bf16 v[132:135], v[220:223], v[4:7], 0
buffer_load_dwordx4 v[40:43], v224, s[4:7], s33 offen offset:2048 sc1
v_mfma_f32_16x16x32_bf16 v[148:151], v[192:195], v[4:7], 0
ds_read_b128 v[220:223], v225 offset:51200
v_mfma_f32_16x16x32_bf16 v[144:147], v[192:195], v[0:3], 0
v_mfma_f32_16x16x32_bf16 v[160:163], v[196:199], v[0:3], 0
ds_read_b128 v[192:195], v224 offset:52224
v_mfma_f32_16x16x32_bf16 v[164:167], v[196:199], v[4:7], 0
s_waitcnt lgkmcnt(4)
v_mfma_f32_16x16x32_bf16 v[140:143], v[200:203], v[4:7], 0
ds_read_b128 v[196:199], v224 offset:3072
v_mfma_f32_16x16x32_bf16 v[136:139], v[200:203], v[0:3], 0
buffer_load_dwordx4 v[44:47], v224, s[4:7], s33 offen offset:3072 sc1
v_mfma_f32_16x16x32_bf16 v[152:155], v[204:207], v[0:3], 0
ds_read_b128 v[200:203], v225 offset:52224
s_add_u32 s33, s44, 12288
v_mfma_f32_16x16x32_bf16 v[156:159], v[204:207], v[4:7], 0
buffer_load_dwordx4 v[48:51], v224, s[4:7], s33 offen offset:0 sc1
v_mfma_f32_16x16x32_bf16 v[172:175], v[208:211], v[4:7], 0
ds_read_b128 v[204:207], v224 offset:53248
v_mfma_f32_16x16x32_bf16 v[168:171], v[208:211], v[0:3], 0
s_waitcnt vmcnt(9) lgkmcnt(4)
v_mfma_f32_16x16x32_bf16 v[128:131], v[212:215], v[8:11], v[128:131]
ds_read_b128 v[208:211], v224 offset:4096
v_mfma_f32_16x16x32_bf16 v[132:135], v[212:215], v[12:15], v[132:135]
buffer_load_dwordx4 v[52:55], v224, s[4:7], s33 offen offset:1024 sc1
v_mfma_f32_16x16x32_bf16 v[148:151], v[216:219], v[12:15], v[148:151]
ds_read_b128 v[212:215], v225 offset:53248
v_mfma_f32_16x16x32_bf16 v[144:147], v[216:219], v[8:11], v[144:147]
v_mfma_f32_16x16x32_bf16 v[160:163], v[220:223], v[8:11], v[160:163]
ds_read_b128 v[216:219], v224 offset:54272
v_mfma_f32_16x16x32_bf16 v[164:167], v[220:223], v[12:15], v[164:167]
s_waitcnt lgkmcnt(4)
v_mfma_f32_16x16x32_bf16 v[140:143], v[192:195], v[12:15], v[140:143]
ds_read_b128 v[220:223], v224 offset:5120
v_mfma_f32_16x16x32_bf16 v[136:139], v[192:195], v[8:11], v[136:139]
buffer_load_dwordx4 v[56:59], v224, s[4:7], s33 offen offset:2048 sc1
v_mfma_f32_16x16x32_bf16 v[152:155], v[196:199], v[8:11], v[152:155]
ds_read_b128 v[192:195], v225 offset:54272
v_mfma_f32_16x16x32_bf16 v[156:159], v[196:199], v[12:15], v[156:159]
v_mfma_f32_16x16x32_bf16 v[172:175], v[200:203], v[12:15], v[172:175]
ds_read_b128 v[196:199], v224 offset:55296
v_mfma_f32_16x16x32_bf16 v[168:171], v[200:203], v[8:11], v[168:171]
s_waitcnt vmcnt(9) lgkmcnt(4)
v_mfma_f32_16x16x32_bf16 v[128:131], v[204:207], v[16:19], v[128:131]
ds_read_b128 v[200:203], v224 offset:6144
v_mfma_f32_16x16x32_bf16 v[132:135], v[204:207], v[20:23], v[132:135]
buffer_load_dwordx4 v[60:63], v224, s[4:7], s33 offen offset:3072 sc1
v_mfma_f32_16x16x32_bf16 v[148:151], v[208:211], v[20:23], v[148:151]
ds_read_b128 v[204:207], v225 offset:55296
s_add_u32 s33, s44, 16384
v_mfma_f32_16x16x32_bf16 v[144:147], v[208:211], v[16:19], v[144:147]
buffer_load_dwordx4 v[64:67], v224, s[4:7], s33 offen offset:0 sc1
v_mfma_f32_16x16x32_bf16 v[160:163], v[212:215], v[16:19], v[160:163]
ds_read_b128 v[208:211], v224 offset:56320
v_mfma_f32_16x16x32_bf16 v[164:167], v[212:215], v[20:23], v[164:167]
s_waitcnt lgkmcnt(4)
v_mfma_f32_16x16x32_bf16 v[140:143], v[216:219], v[20:23], v[140:143]
ds_read_b128 v[212:215], v224 offset:7168
v_mfma_f32_16x16x32_bf16 v[136:139], v[216:219], v[16:19], v[136:139]
buffer_load_dwordx4 v[68:71], v224, s[4:7], s33 offen offset:1024 sc1
v_mfma_f32_16x16x32_bf16 v[152:155], v[220:223], v[16:19], v[152:155]
ds_read_b128 v[216:219], v225 offset:56320
s_waitcnt vmcnt(10)
v_mfma_f32_16x16x32_bf16 v[156:159], v[220:223], v[20:23], v[156:159]
v_and_b32 v231, v0, v4
v_bitop3_b32 v231, v231, v8, v12 bitop3:0x80
v_mfma_f32_16x16x32_bf16 v[172:175], v[192:195], v[20:23], v[172:175]
ds_read_b128 v[220:223], v224 offset:57344
v_bitop3_b32 v231, v231, v16, v20 bitop3:0x80
v_mfma_f32_16x16x32_bf16 v[168:171], v[192:195], v[16:19], v[168:171]
v_bitop3_b32 v231, v231, v24, v28 bitop3:0x80
s_waitcnt lgkmcnt(4)
v_mfma_f32_16x16x32_bf16 v[128:131], v[196:199], v[24:27], v[128:131]
ds_read_b128 v[192:195], v224 offset:8192
v_and_b32 v231, 1, v231
v_mfma_f32_16x16x32_bf16 v[132:135], v[196:199], v[28:31], v[132:135]
buffer_load_dwordx4 v[72:75], v224, s[4:7], s33 offen offset:2048 sc1
v_cmp_ne_u32 s[66:67], 1, v231
v_mfma_f32_16x16x32_bf16 v[148:151], v[200:203], v[28:31], v[148:151]
ds_read_b128 v[196:199], v225 offset:57344
v_mfma_f32_16x16x32_bf16 v[144:147], v[200:203], v[24:27], v[144:147]
v_mfma_f32_16x16x32_bf16 v[160:163], v[204:207], v[24:27], v[160:163]
ds_read_b128 v[200:203], v224 offset:58368
v_mfma_f32_16x16x32_bf16 v[164:167], v[204:207], v[28:31], v[164:167]
s_cmp_lg_u64 s[66:67], 0
s_cbranch_scc1 VR_101
VJ_102:
s_waitcnt lgkmcnt(4)
v_mfma_f32_16x16x32_bf16 v[140:143], v[208:211], v[28:31], v[140:143]
ds_read_b128 v[204:207], v224 offset:9216
s_waitcnt vmcnt(7)
v_mfma_f32_16x16x32_bf16 v[136:139], v[208:211], v[24:27], v[136:139]
buffer_load_dwordx4 v[76:79], v224, s[4:7], s33 offen offset:3072 sc1
v_mfma_f32_16x16x32_bf16 v[152:155], v[212:215], v[24:27], v[152:155]
ds_read_b128 v[208:211], v225 offset:58368
s_add_u32 s33, s44, 20480
v_mfma_f32_16x16x32_bf16 v[156:159], v[212:215], v[28:31], v[156:159]
buffer_load_dwordx4 v[80:83], v224, s[4:7], s33 offen offset:0 sc1
v_and_b32 v231, v32, v36
v_bitop3_b32 v231, v231, v40, v44 bitop3:0x80
v_and_b32 v231, 1, v231
v_cmp_ne_u32 s[66:67], 1, v231
v_mfma_f32_16x16x32_bf16 v[172:175], v[216:219], v[28:31], v[172:175]
ds_read_b128 v[212:215], v224 offset:59392
v_mfma_f32_16x16x32_bf16 v[168:171], v[216:219], v[24:27], v[168:171]
s_cmp_lg_u64 s[66:67], 0
s_cbranch_scc1 VR_103
VJ_104:
s_waitcnt lgkmcnt(4)
v_mfma_f32_16x16x32_bf16 v[128:131], v[220:223], v[32:35], v[128:131]
ds_read_b128 v[216:219], v224 offset:10240
v_mfma_f32_16x16x32_bf16 v[132:135], v[220:223], v[36:39], v[132:135]
buffer_load_dwordx4 v[84:87], v224, s[4:7], s33 offen offset:1024 sc1
v_mfma_f32_16x16x32_bf16 v[148:151], v[192:195], v[36:39], v[148:151]
ds_read_b128 v[220:223], v225 offset:59392
v_mfma_f32_16x16x32_bf16 v[144:147], v[192:195], v[32:35], v[144:147]
v_mfma_f32_16x16x32_bf16 v[160:163], v[196:199], v[32:35], v[160:163]
ds_read_b128 v[192:195], v224 offset:60416
v_mfma_f32_16x16x32_bf16 v[164:167], v[196:199], v[36:39], v[164:167]
s_waitcnt lgkmcnt(4)
v_mfma_f32_16x16x32_bf16 v[140:143], v[200:203], v[36:39], v[140:143]
ds_read_b128 v[196:199], v224 offset:11264
v_mfma_f32_16x16x32_bf16 v[136:139], v[200:203], v[32:35], v[136:139]
buffer_load_dwordx4 v[88:91], v224, s[4:7], s33 offen offset:2048 sc1
v_mfma_f32_16x16x32_bf16 v[152:155], v[204:207], v[32:35], v[152:155]
ds_read_b128 v[200:203], v225 offset:60416
v_mfma_f32_16x16x32_bf16 v[156:159], v[204:207], v[36:39], v[156:159]
v_mfma_f32_16x16x32_bf16 v[172:175], v[208:211], v[36:39], v[172:175]
ds_read_b128 v[204:207], v224 offset:61440
v_mfma_f32_16x16x32_bf16 v[168:171], v[208:211], v[32:35], v[168:171]
s_waitcnt lgkmcnt(4)
v_mfma_f32_16x16x32_bf16 v[128:131], v[212:215], v[40:43], v[128:131]
ds_read_b128 v[208:211], v224 offset:12288
v_mfma_f32_16x16x32_bf16 v[132:135], v[212:215], v[44:47], v[132:135]
buffer_load_dwordx4 v[92:95], v224, s[4:7], s33 offen offset:3072 sc1
v_mfma_f32_16x16x32_bf16 v[148:151], v[216:219], v[44:47], v[148:151]
ds_read_b128 v[212:215], v225 offset:61440
s_add_u32 s33, s44, 24576
v_mfma_f32_16x16x32_bf16 v[144:147], v[216:219], v[40:43], v[144:147]
buffer_load_dwordx4 v[96:99], v224, s[4:7], s33 offen offset:0 sc1
v_mfma_f32_16x16x32_bf16 v[160:163], v[220:223], v[40:43], v[160:163]
ds_read_b128 v[216:219], v224 offset:62464
s_waitcnt vmcnt(7)
v_mfma_f32_16x16x32_bf16 v[164:167], v[220:223], v[44:47], v[164:167]
v_and_b32 v231, v48, v52
s_waitcnt lgkmcnt(4)
v_mfma_f32_16x16x32_bf16 v[140:143], v[192:195], v[44:47], v[140:143]
ds_read_b128 v[220:223], v224 offset:13312
v_bitop3_b32 v231, v231, v56, v60 bitop3:0x80
v_mfma_f32_16x16x32_bf16 v[136:139], v[192:195], v[40:43], v[136:139]
buffer_load_dwordx4 v[100:103], v224, s[4:7], s33 offen offset:1024 sc1
v_mfma_f32_16x16x32_bf16 v[152:155], v[196:199], v[40:43], v[152:155]
ds_read_b128 v[192:195], v225 offset:62464
v_bitop3_b32 v231, v231, v64, v68 bitop3:0x80
v_mfma_f32_16x16x32_bf16 v[156:159], v[196:199], v[44:47], v[156:159]
v_and_b32 v231, 1, v231
v_cmp_ne_u32 s[66:67], 1, v231
v_mfma_f32_16x16x32_bf16 v[172:175], v[200:203], v[44:47], v[172:175]
ds_read_b128 v[196:199], v224 offset:63488
v_mfma_f32_16x16x32_bf16 v[168:171], v[200:203], v[40:43], v[168:171]
s_cmp_lg_u64 s[66:67], 0
s_cbranch_scc1 VR_105
VJ_106:
s_waitcnt lgkmcnt(4)
v_mfma_f32_16x16x32_bf16 v[128:131], v[204:207], v[48:51], v[128:131]
ds_read_b128 v[200:203], v224 offset:14336
v_mfma_f32_16x16x32_bf16 v[132:135], v[204:207], v[52:55], v[132:135]
buffer_load_dwordx4 v[104:107], v224, s[4:7], s33 offen offset:2048 sc1
v_mfma_f32_16x16x32_bf16 v[148:151], v[208:211], v[52:55], v[148:151]
ds_read_b128 v[204:207], v225 offset:63488
v_mfma_f32_16x16x32_bf16 v[144:147], v[208:211], v[48:51], v[144:147]
v_mfma_f32_16x16x32_bf16 v[160:163], v[212:215], v[48:51], v[160:163]
ds_read_b128 v[208:211], v224 offset:64512
v_mfma_f32_16x16x32_bf16 v[164:167], v[212:215], v[52:55], v[164:167]
s_waitcnt lgkmcnt(4)
v_mfma_f32_16x16x32_bf16 v[140:143], v[216:219], v[52:55], v[140:143]
ds_read_b128 v[212:215], v224 offset:15360
v_mfma_f32_16x16x32_bf16 v[136:139], v[216:219], v[48:51], v[136:139]
buffer_load_dwordx4 v[108:111], v224, s[4:7], s33 offen offset:3072 sc1
v_mfma_f32_16x16x32_bf16 v[152:155], v[220:223], v[48:51], v[152:155]
ds_read_b128 v[216:219], v225 offset:64512
v_mfma_f32_16x16x32_bf16 v[156:159], v[220:223], v[52:55], v[156:159]
buffer_load_dwordx4 v[176:179], v245, s[4:7], s27 offen offset:0 sc1
v_mfma_f32_16x16x32_bf16 v[172:175], v[192:195], v[52:55], v[172:175]
ds_read_b128 v[220:223], v225 offset:16384
v_mfma_f32_16x16x32_bf16 v[168:171], v[192:195], v[48:51], v[168:171]
s_waitcnt lgkmcnt(4)
v_mfma_f32_16x16x32_bf16 v[128:131], v[196:199], v[56:59], v[128:131]
ds_read_b128 v[192:195], v224 offset:16384
v_mfma_f32_16x16x32_bf16 v[132:135], v[196:199], v[60:63], v[132:135]
buffer_load_dwordx4 v[180:183], v245, s[4:7], s27 offen offset:512 sc1
v_mfma_f32_16x16x32_bf16 v[148:151], v[200:203], v[60:63], v[148:151]
ds_read_b128 v[196:199], v225 offset:32768
v_mfma_f32_16x16x32_bf16 v[144:147], v[200:203], v[56:59], v[144:147]
v_mfma_f32_16x16x32_bf16 v[160:163], v[204:207], v[56:59], v[160:163]
ds_read_b128 v[200:203], v225 offset:17408
s_add_u32 s33, s44, 28672
v_mfma_f32_16x16x32_bf16 v[164:167], v[204:207], v[60:63], v[164:167]
s_waitcnt lgkmcnt(4)
v_mfma_f32_16x16x32_bf16 v[140:143], v[208:211], v[60:63], v[140:143]
ds_read_b128 v[204:207], v224 offset:17408
v_mfma_f32_16x16x32_bf16 v[136:139], v[208:211], v[56:59], v[136:139]
buffer_load_dwordx4 v[112:115], v224, s[4:7], s33 offen offset:0 sc1
v_mfma_f32_16x16x32_bf16 v[152:155], v[212:215], v[56:59], v[152:155]
ds_read_b128 v[208:211], v225 offset:33792
v_mfma_f32_16x16x32_bf16 v[156:159], v[212:215], v[60:63], v[156:159]
v_mfma_f32_16x16x32_bf16 v[172:175], v[216:219], v[60:63], v[172:175]
s_barrier
ds_read_b128 v[212:215], v225 offset:18432
v_mfma_f32_16x16x32_bf16 v[168:171], v[216:219], v[56:59], v[168:171]
s_waitcnt lgkmcnt(4)
v_mfma_f32_16x16x32_bf16 v[128:131], v[220:223], v[64:67], v[128:131]
ds_read_b128 v[216:219], v224 offset:18432
v_mfma_f32_16x16x32_bf16 v[132:135], v[220:223], v[68:71], v[132:135]
buffer_load_dwordx4 v[116:119], v224, s[4:7], s33 offen offset:1024 sc1
v_mfma_f32_16x16x32_bf16 v[148:151], v[192:195], v[68:71], v[148:151]
ds_read_b128 v[220:223], v225 offset:34816
s_add_u32 m0, s41, 32768
v_mfma_f32_16x16x32_bf16 v[144:147], v[192:195], v[64:67], v[144:147]
buffer_load_dwordx4 v[120:123], v224, s[4:7], s33 offen offset:2048 sc1
v_mfma_f32_16x16x32_bf16 v[160:163], v[196:199], v[64:67], v[160:163]
ds_read_b128 v[192:195], v225 offset:19456
s_waitcnt vmcnt(7)
v_mfma_f32_16x16x32_bf16 v[164:167], v[196:199], v[68:71], v[164:167]
v_and_b32 v231, v72, v76
s_waitcnt lgkmcnt(4)
v_mfma_f32_16x16x32_bf16 v[140:143], v[200:203], v[68:71], v[140:143]
ds_read_b128 v[196:199], v224 offset:19456
v_bitop3_b32 v231, v231, v80, v84 bitop3:0x80
v_mfma_f32_16x16x32_bf16 v[136:139], v[200:203], v[64:67], v[136:139]
buffer_load_dwordx4 v[124:127], v224, s[4:7], s33 offen offset:3072 sc1
v_mfma_f32_16x16x32_bf16 v[152:155], v[204:207], v[64:67], v[152:155]
ds_read_b128 v[200:203], v225 offset:35840
v_bitop3_b32 v231, v231, v88, v92 bitop3:0x80
v_mfma_f32_16x16x32_bf16 v[156:159], v[204:207], v[68:71], v[156:159]
v_bitop3_b32 v231, v231, v96, v100 bitop3:0x80
s_add_u32 s34, s40, 262144
v_and_b32 v231, 1, v231
buffer_load_dwordx4 v224, s[4:7], s34 offen offset:0 sc1 lds
v_cmp_ne_u32 s[66:67], 1, v231
v_mfma_f32_16x16x32_bf16 v[172:175], v[208:211], v[68:71], v[172:175]
ds_read_b128 v[204:207], v225 offset:20480
v_mfma_f32_16x16x32_bf16 v[168:171], v[208:211], v[64:67], v[168:171]
s_cmp_lg_u64 s[66:67], 0
s_cbranch_scc1 VR_107
VJ_108:
s_waitcnt lgkmcnt(4)
v_mfma_f32_16x16x32_bf16 v[128:131], v[212:215], v[72:75], v[128:131]
ds_read_b128 v[208:211], v224 offset:20480
v_mfma_f32_16x16x32_bf16 v[132:135], v[212:215], v[76:79], v[132:135]
buffer_load_dwordx4 v224, s[4:7], s34 offen offset:1024 sc1 lds
v_mfma_f32_16x16x32_bf16 v[148:151], v[216:219], v[76:79], v[148:151]
ds_read_b128 v[212:215], v225 offset:36864
v_mfma_f32_16x16x32_bf16 v[144:147], v[216:219], v[72:75], v[144:147]
v_mfma_f32_16x16x32_bf16 v[160:163], v[220:223], v[72:75], v[160:163]
ds_read_b128 v[216:219], v225 offset:21504
v_and_b32 v254, 0xf0, v224
v_mfma_f32_16x16x32_bf16 v[164:167], v[220:223], v[76:79], v[164:167]
v_bfe_u32 v255, v240, 4, 1
s_waitcnt lgkmcnt(4)
v_mfma_f32_16x16x32_bf16 v[140:143], v[192:195], v[76:79], v[140:143]
ds_read_b128 v[220:223], v224 offset:21504
v_lshl_add_u32 v254, v255, 3, v254
v_mfma_f32_16x16x32_bf16 v[136:139], v[192:195], v[72:75], v[136:139]
s_mov_b32 exec_hi, 0
buffer_load_dword v227, v239, s[4:7], s45 offen offset:2048 sc1
s_mov_b32 exec_hi, -1
v_mfma_f32_16x16x32_bf16 v[152:155], v[196:199], v[72:75], v[152:155]
ds_read_b128 v[192:195], v225 offset:37888
v_lshrrev_b32 v255, 5, v240
v_mfma_f32_16x16x32_bf16 v[156:159], v[196:199], v[76:79], v[156:159]
buffer_load_dwordx4 v224, s[4:7], s34 offen offset:2048 sc1 lds
v_mfma_f32_16x16x32_bf16 v[172:175], v[200:203], v[76:79], v[172:175]
ds_read_b128 v[196:199], v225 offset:22528
v_lshl_add_u32 v254, v255, 8, v254
v_mfma_f32_16x16x32_bf16 v[168:171], v[200:203], v[72:75], v[168:171]
s_and_b32 s32, s22, 1
s_waitcnt lgkmcnt(4)
v_mfma_f32_16x16x32_bf16 v[128:131], v[204:207], v[80:83], v[128:131]
ds_read_b128 v[200:203], v224 offset:22528
s_add_u32 s53, s25, 1
v_mfma_f32_16x16x32_bf16 v[132:135], v[204:207], v[84:87], v[132:135]
v_mov_b32 v228, s53
s_mul_i32 s32, s32, 5632
v_mfma_f32_16x16x32_bf16 v[148:151], v[208:211], v[84:87], v[148:151]
ds_read_b128 v[204:207], v225 offset:38912
s_sub_u32 s32, s45, s32
v_mfma_f32_16x16x32_bf16 v[144:147], v[208:211], v[80:83], v[144:147]
s_add_u32 s32, s32, 5120
v_mfma_f32_16x16x32_bf16 v[160:163], v[212:215], v[80:83], v[160:163]
ds_read_b128 v[208:211], v225 offset:23552
v_mfma_f32_16x16x32_bf16 v[164:167], v[212:215], v[84:87], v[164:167]
s_waitcnt lgkmcnt(4)
v_mfma_f32_16x16x32_bf16 v[140:143], v[216:219], v[84:87], v[140:143]
ds_read_b128 v[212:215], v224 offset:23552
v_mfma_f32_16x16x32_bf16 v[136:139], v[216:219], v[80:83], v[136:139]
buffer_load_dwordx4 v224, s[4:7], s34 offen offset:3072 sc1 lds
v_mfma_f32_16x16x32_bf16 v[152:155], v[220:223], v[80:83], v[152:155]
ds_read_b128 v[216:219], v225 offset:39936
v_mfma_f32_16x16x32_bf16 v[156:159], v[220:223], v[84:87], v[156:159]
s_cmp_eq_u32 s29, 1
s_cselect_b32 s32, s32, 1073741824
v_mfma_f32_16x16x32_bf16 v[172:175], v[192:195], v[84:87], v[172:175]
ds_read_b128 v[220:223], v225 offset:24576
s_add_u32 m0, s41, 65536
v_mfma_f32_16x16x32_bf16 v[168:171], v[192:195], v[80:83], v[168:171]
s_add_u32 s34, s36, 131072
s_waitcnt lgkmcnt(4)
v_mfma_f32_16x16x32_bf16 v[128:131], v[196:199], v[88:91], v[128:131]
ds_read_b128 v[192:195], v224 offset:24576
v_mfma_f32_16x16x32_bf16 v[132:135], v[196:199], v[92:95], v[132:135]
buffer_load_dwordx4 v224, s[4:7], s34 offen offset:0 sc1 lds
v_mfma_f32_16x16x32_bf16 v[148:151], v[200:203], v[92:95], v[148:151]
ds_read_b128 v[196:199], v225 offset:40960
v_mfma_f32_16x16x32_bf16 v[144:147], v[200:203], v[88:91], v[144:147]
v_mfma_f32_16x16x32_bf16 v[160:163], v[204:207], v[88:91], v[160:163]
ds_read_b128 v[200:203], v225 offset:25600
v_mfma_f32_16x16x32_bf16 v[164:167], v[204:207], v[92:95], v[164:167]
s_waitcnt lgkmcnt(4)
v_mfma_f32_16x16x32_bf16 v[140:143], v[208:211], v[92:95], v[140:143]
ds_read_b128 v[204:207], v224 offset:25600
v_mfma_f32_16x16x32_bf16 v[136:139], v[208:211], v[88:91], v[136:139]
v_mfma_f32_16x16x32_bf16 v[152:155], v[212:215], v[88:91], v[152:155]
ds_read_b128 v[208:211], v225 offset:41984
v_mfma_f32_16x16x32_bf16 v[156:159], v[212:215], v[92:95], v[156:159]
buffer_load_dwordx4 v224, s[4:7], s34 offen offset:1024 sc1 lds
v_mfma_f32_16x16x32_bf16 v[172:175], v[216:219], v[92:95], v[172:175]
ds_read_b128 v[212:215], v225 offset:26624
v_mfma_f32_16x16x32_bf16 v[168:171], v[216:219], v[88:91], v[168:171]
s_waitcnt lgkmcnt(4)
v_mfma_f32_16x16x32_bf16 v[128:131], v[220:223], v[96:99], v[128:131]
ds_read_b128 v[216:219], v224 offset:26624
v_mfma_f32_16x16x32_bf16 v[132:135], v[220:223], v[100:103], v[132:135]
s_waitcnt vmcnt(11)
v_xor_b32 v184, 3, v177
v_xor_b32 v185, 3, v179
v_xor_b32 v186, 3, v181
v_xor_b32 v187, 3, v183
v_or3_b32 v184, v184, v185, v186
v_or_b32 v184, v184, v187
v_and_b32 v184, 3, v184
v_cmp_ne_u32 vcc, 0, v184
s_cbranch_vccnz TR_111
TJ_113:
v_mfma_f32_16x16x32_bf16 v[148:151], v[192:195], v[100:103], v[148:151]
ds_read_b128 v[220:223], v225 offset:43008
v_add_f32 v176, v176, v180
v_mfma_f32_16x16x32_bf16 v[144:147], v[192:195], v[96:99], v[144:147]
v_add_f32 v177, v177, v181
v_add_f32 v178, v178, v182
v_mfma_f32_16x16x32_bf16 v[160:163], v[196:199], v[96:99], v[160:163]
ds_read_b128 v[192:195], v225 offset:27648
s_waitcnt vmcnt(7)
v_mfma_f32_16x16x32_bf16 v[164:167], v[196:199], v[100:103], v[164:167]
v_and_b32 v231, v104, v108
s_waitcnt lgkmcnt(4)
v_mfma_f32_16x16x32_bf16 v[140:143], v[200:203], v[100:103], v[140:143]
ds_read_b128 v[196:199], v224 offset:27648
v_bitop3_b32 v231, v231, v112, v116 bitop3:0x80
v_mfma_f32_16x16x32_bf16 v[136:139], v[200:203], v[96:99], v[136:139]
v_bitop3_b32 v231, v231, v120, v124 bitop3:0x80
v_add_f32 v179, v179, v183
v_mfma_f32_16x16x32_bf16 v[152:155], v[204:207], v[96:99], v[152:155]
ds_read_b128 v[200:203], v225 offset:44032
v_and_b32 v231, 1, v231
v_mfma_f32_16x16x32_bf16 v[156:159], v[204:207], v[100:103], v[156:159]
v_cmp_ne_u32 s[66:67], 1, v231
buffer_load_dwordx4 v224, s[4:7], s34 offen offset:2048 sc1 lds
v_mfma_f32_16x16x32_bf16 v[172:175], v[208:211], v[100:103], v[172:175]
ds_read_b128 v[204:207], v225 offset:28672
v_add_f32_dpp v176, v176, v176 quad_perm:[1,0,3,2] row_mask:0xf bank_mask:0xf
v_mfma_f32_16x16x32_bf16 v[168:171], v[208:211], v[96:99], v[168:171]
s_cmp_lg_u64 s[66:67], 0
s_cbranch_scc1 VR_109
VJ_110:
s_waitcnt lgkmcnt(4)
v_mfma_f32_16x16x32_bf16 v[128:131], v[212:215], v[104:107], v[128:131]
ds_read_b128 v[208:211], v224 offset:28672
v_add_f32_dpp v177, v177, v177 quad_perm:[1,0,3,2] row_mask:0xf bank_mask:0xf
v_mfma_f32_16x16x32_bf16 v[132:135], v[212:215], v[108:111], v[132:135]
buffer_load_dwordx4 v224, s[4:7], s34 offen offset:3072 sc1 lds
v_mfma_f32_16x16x32_bf16 v[148:151], v[216:219], v[108:111], v[148:151]
ds_read_b128 v[212:215], v225 offset:45056
v_add_f32_dpp v178, v178, v178 quad_perm:[1,0,3,2] row_mask:0xf bank_mask:0xf
v_mfma_f32_16x16x32_bf16 v[144:147], v[216:219], v[104:107], v[144:147]
v_add_f32_dpp v179, v179, v179 quad_perm:[1,0,3,2] row_mask:0xf bank_mask:0xf
v_cndmask_b32 v176, v176, v178, s[64:65]
v_mfma_f32_16x16x32_bf16 v[160:163], v[220:223], v[104:107], v[160:163]
ds_read_b128 v[216:219], v225 offset:29696
v_cndmask_b32 v177, v177, v179, s[64:65]
v_mfma_f32_16x16x32_bf16 v[164:167], v[220:223], v[108:111], v[164:167]
v_mov_b32 v178, v176
s_waitcnt lgkmcnt(4)
v_mfma_f32_16x16x32_bf16 v[140:143], v[192:195], v[108:111], v[140:143]
ds_read_b128 v[220:223], v224 offset:29696
s_add_u32 m0, s41, 49152
v_mfma_f32_16x16x32_bf16 v[136:139], v[192:195], v[104:107], v[136:139]
s_add_u32 s34, s36, 147456
v_mov_b32 v179, v177
v_mfma_f32_16x16x32_bf16 v[152:155], v[196:199], v[104:107], v[152:155]
ds_read_b128 v[192:195], v225 offset:46080
s_mov_b32 s35, 0x3b000000
v_mfma_f32_16x16x32_bf16 v[156:159], v[196:199], v[108:111], v[156:159]
buffer_load_dwordx4 v224, s[4:7], s34 offen offset:0 sc1 lds
v_mfma_f32_16x16x32_bf16 v[172:175], v[200:203], v[108:111], v[172:175]
ds_read_b128 v[196:199], v225 offset:30720
v_permlane32_swap_b32 v176, v178
v_mfma_f32_16x16x32_bf16 v[168:171], v[200:203], v[104:107], v[168:171]
v_permlane32_swap_b32 v177, v179
s_waitcnt lgkmcnt(4)
v_mfma_f32_16x16x32_bf16 v[128:131], v[204:207], v[112:115], v[128:131]
ds_read_b128 v[200:203], v224 offset:30720
v_add_f32 v176, v176, v178
v_mfma_f32_16x16x32_bf16 v[132:135], v[204:207], v[116:119], v[132:135]
v_add_f32 v177, v177, v179
v_mul_f32 v176, 0xbb000000, v176
v_mfma_f32_16x16x32_bf16 v[148:151], v[208:211], v[116:119], v[148:151]
ds_read_b128 v[204:207], v225 offset:47104
v_mul_f32 v178, v176, v176
v_mfma_f32_16x16x32_bf16 v[144:147], v[208:211], v[112:115], v[144:147]
v_fma_f32 v177, v177, s35, -v178
v_cvt_pk_bf16_f32 v179, v176, v176
v_mfma_f32_16x16x32_bf16 v[160:163], v[212:215], v[112:115], v[160:163]
ds_read_b128 v[208:211], v225 offset:31744
v_max_f32 v177, 0, v177
v_mfma_f32_16x16x32_bf16 v[164:167], v[212:215], v[116:119], v[164:167]
v_and_b32 v180, 0xffff0000, v179
s_waitcnt lgkmcnt(4)
v_mfma_f32_16x16x32_bf16 v[140:143], v[216:219], v[116:119], v[140:143]
ds_read_b128 v[212:215], v224 offset:31744
v_add_f32 v177, 0x3727c5ac, v177
v_mfma_f32_16x16x32_bf16 v[136:139], v[216:219], v[112:115], v[136:139]
buffer_load_dwordx4 v224, s[4:7], s34 offen offset:1024 sc1 lds
v_mfma_f32_16x16x32_bf16 v[152:155], v[220:223], v[112:115], v[152:155]
ds_read_b128 v[216:219], v225 offset:48128
v_sub_f32 v180, v176, v180
v_mfma_f32_16x16x32_bf16 v[156:159], v[220:223], v[116:119], v[156:159]
v_rcp_f32 v236, v177
v_mfma_f32_16x16x32_bf16 v[172:175], v[192:195], v[116:119], v[172:175]
ds_read_b32 v220, v226 offset:1024
v_cvt_pk_bf16_f32 v180, v180, v180
v_mfma_f32_16x16x32_bf16 v[168:171], v[192:195], v[112:115], v[168:171]
s_lshl_b32 s35, s20, 7
s_waitcnt lgkmcnt(4)
v_mfma_f32_16x16x32_bf16 v[128:131], v[196:199], v[120:123], v[128:131]
ds_read_b32 v192, v226 offset:896
v_mov_b32 v229, 0
v_mfma_f32_16x16x32_bf16 v[132:135], v[196:199], v[124:127], v[132:135]
buffer_load_dwordx4 v224, s[4:7], s34 offen offset:2048 sc1 lds
v_mfma_f32_16x16x32_bf16 v[148:151], v[200:203], v[124:127], v[148:151]
ds_read_b32 v196, v226 offset:768
v_add_u32 v181, s35, v226
v_mfma_f32_16x16x32_bf16 v[144:147], v[200:203], v[120:123], v[144:147]
v_cndmask_b32 v232, v179, v180, s[56:57]
v_mfma_f32_16x16x32_bf16 v[160:163], v[204:207], v[120:123], v[160:163]
ds_read_b32 v200, v226 offset:1088
v_mfma_f32_16x16x32_bf16 v[164:167], v[204:207], v[124:127], v[164:167]
s_waitcnt lgkmcnt(4)
v_mfma_f32_16x16x32_bf16 v[140:143], v[208:211], v[124:127], v[140:143]
ds_read_b32 v204, v226 offset:960
v_mfma_f32_16x16x32_bf16 v[136:139], v[208:211], v[120:123], v[136:139]
ds_write_b32 v181, v236 offset:1344
v_mfma_f32_16x16x32_bf16 v[152:155], v[212:215], v[120:123], v[152:155]
ds_read_b32 v208, v226 offset:832
v_mov_b32 v251, 0
v_mfma_f32_16x16x32_bf16 v[156:159], v[212:215], v[124:127], v[156:159]
buffer_load_dwordx4 v224, s[4:7], s34 offen offset:3072 sc1 lds
v_mov_b32 v252, 0
v_mov_b32 v253, 0
v_permlane16_swap_b32 v232, v229
v_mov_b32 v250, v229
v_mfma_f32_16x16x32_bf16 v[172:175], v[216:219], v[124:127], v[172:175]
s_waitcnt vmcnt(8)
s_barrier
ds_read_b128 v[212:215], v224 offset:32768
v_mfma_f32_16x16x32_bf16 v[168:171], v[216:219], v[120:123], v[168:171]
s_waitcnt lgkmcnt(5)
v_mfma_f32_16x16x32_bf16 v[128:131], v[220:223], v[232:235], v[128:131]
ds_read_b128 v[216:219], v224 offset:33792
v_mfma_f32_16x16x32_bf16 v[132:135], v[220:223], v[250:253], v[132:135]
v_mfma_f32_16x16x32_bf16 v[148:151], v[192:195], v[250:253], v[148:151]
ds_read_b128 v[220:223], v224 offset:34816
v_mfma_f32_16x16x32_bf16 v[144:147], v[192:195], v[232:235], v[144:147]
v_mfma_f32_16x16x32_bf16 v[160:163], v[196:199], v[232:235], v[160:163]
ds_read_b128 v[192:195], v224 offset:35840
s_add_u32 m0, s41, 0
v_mfma_f32_16x16x32_bf16 v[164:167], v[196:199], v[250:253], v[164:167]
s_waitcnt lgkmcnt(4)
s_add_u32 s34, s36, 98304
v_mfma_f32_16x16x32_bf16 v[140:143], v[200:203], v[250:253], v[140:143]
ds_read_b128 v[196:199], v224 offset:36864
v_mfma_f32_16x16x32_bf16 v[136:139], v[200:203], v[232:235], v[136:139]
v_mfma_f32_16x16x32_bf16 v[152:155], v[204:207], v[232:235], v[152:155]
ds_read_b128 v[200:203], v224 offset:37888
v_mfma_f32_16x16x32_bf16 v[156:159], v[204:207], v[250:253], v[156:159]
buffer_load_dwordx4 v224, s[4:7], s34 offen offset:0 sc1 lds
v_mfma_f32_16x16x32_bf16 v[172:175], v[208:211], v[250:253], v[172:175]
ds_read_b128 v[204:207], v224 offset:38912
v_mfma_f32_16x16x32_bf16 v[168:171], v[208:211], v[232:235], v[168:171]
s_waitcnt lgkmcnt(4)
v_mfma_f32_16x16x32_bf16 v[176:179], v[212:215], v[0:3], 0
ds_read_b128 v[208:211], v224 offset:39936
v_mfma_f32_16x16x32_bf16 v[180:183], v[212:215], v[4:7], 0
v_mfma_f32_16x16x32_bf16 v[180:183], v[216:219], v[12:15], v[180:183]
s_branch L_SK8
L_ST8:
s_setpc_b64 s[10:11]
L_SK8:
ds_read_b128 v[212:215], v224 offset:40960
v_max_f32 v128, 0, v128
v_mfma_f32_16x16x32_bf16 v[176:179], v[216:219], v[8:11], v[176:179]
v_max_f32 v129, 0, v129
v_max_f32 v130, 0, v130
v_mfma_f32_16x16x32_bf16 v[176:179], v[220:223], v[16:19], v[176:179]
ds_read_b128 v[216:219], v224 offset:41984
v_max_f32 v131, 0, v131
v_mfma_f32_16x16x32_bf16 v[180:183], v[220:223], v[20:23], v[180:183]
v_max_f32 v132, 0, v132
s_waitcnt lgkmcnt(4)
v_mfma_f32_16x16x32_bf16 v[180:183], v[192:195], v[28:31], v[180:183]
ds_read_b128 v[220:223], v224 offset:43008
v_max_f32 v133, 0, v133
v_mfma_f32_16x16x32_bf16 v[176:179], v[192:195], v[24:27], v[176:179]
v_max_f32 v134, 0, v134
v_max_f32 v135, 0, v135
v_mfma_f32_16x16x32_bf16 v[176:179], v[196:199], v[32:35], v[176:179]
ds_read_b128 v[192:195], v224 offset:44032
v_mul_f32 v128, v128, v136
v_mfma_f32_16x16x32_bf16 v[180:183], v[196:199], v[36:39], v[180:183]
buffer_load_dwordx4 v224, s[4:7], s34 offen offset:1024 sc1 lds
v_mfma_f32_16x16x32_bf16 v[180:183], v[200:203], v[44:47], v[180:183]
ds_read_b128 v[196:199], v224 offset:45056
v_mul_f32 v129, v129, v137
v_mfma_f32_16x16x32_bf16 v[176:179], v[200:203], v[40:43], v[176:179]
v_mul_f32 v130, v130, v138
s_waitcnt lgkmcnt(4)
v_mfma_f32_16x16x32_bf16 v[176:179], v[204:207], v[48:51], v[176:179]
ds_read_b128 v[200:203], v224 offset:46080
v_mul_f32 v131, v131, v139
v_mfma_f32_16x16x32_bf16 v[180:183], v[204:207], v[52:55], v[180:183]
v_mul_f32 v132, v132, v140
v_mul_f32 v133, v133, v141
v_mfma_f32_16x16x32_bf16 v[180:183], v[208:211], v[60:63], v[180:183]
ds_read_b128 v[204:207], v224 offset:47104
v_mul_f32 v134, v134, v142
v_mfma_f32_16x16x32_bf16 v[176:179], v[208:211], v[56:59], v[176:179]
v_mul_f32 v135, v135, v143
v_cvt_pk_bf16_f32 v136, v128, v129
v_mfma_f32_16x16x32_bf16 v[176:179], v[212:215], v[64:67], v[176:179]
ds_read_b128 v[208:211], v224 offset:48128
v_cvt_pk_bf16_f32 v138, v132, v133
v_mfma_f32_16x16x32_bf16 v[180:183], v[212:215], v[68:71], v[180:183]
v_cvt_pk_bf16_f32 v137, v130, v131
s_waitcnt lgkmcnt(4)
v_mfma_f32_16x16x32_bf16 v[180:183], v[216:219], v[76:79], v[180:183]
ds_read_b32 v212, v226 offset:1152
v_cvt_pk_bf16_f32 v139, v134, v135
v_mfma_f32_16x16x32_bf16 v[176:179], v[216:219], v[72:75], v[176:179]
buffer_load_dwordx4 v224, s[4:7], s34 offen offset:2048 sc1 lds
v_mfma_f32_16x16x32_bf16 v[176:179], v[220:223], v[80:83], v[176:179]
s_waitcnt vmcnt(3)
s_barrier
ds_read_b128 v[216:219], v225 offset:0
v_mfma_f32_16x16x32_bf16 v[180:183], v[220:223], v[84:87], v[180:183]
s_add_u32 s31, s45, 4096
v_permlane16_swap_b32 v136, v138
v_mfma_f32_16x16x32_bf16 v[180:183], v[192:195], v[92:95], v[180:183]
ds_read_b128 v[220:223], v225 offset:1024
v_permlane16_swap_b32 v137, v139
v_mfma_f32_16x16x32_bf16 v[176:179], v[192:195], v[88:91], v[176:179]
s_waitcnt lgkmcnt(4)
v_mfma_f32_16x16x32_bf16 v[176:179], v[196:199], v[96:99], v[176:179]
ds_read_b128 v[192:195], v225 offset:2048
v_mfma_f32_16x16x32_bf16 v[180:183], v[196:199], v[100:103], v[180:183]
buffer_store_dwordx4 v[136:139], v224, s[4:7], s31 offen offset:0 nt
v_mfma_f32_16x16x32_bf16 v[180:183], v[200:203], v[108:111], v[180:183]
ds_read_b128 v[196:199], v225 offset:3072
v_max_f32 v144, 0, v144
v_mfma_f32_16x16x32_bf16 v[176:179], v[200:203], v[104:107], v[176:179]
v_max_f32 v145, 0, v145
v_max_f32 v146, 0, v146
v_mfma_f32_16x16x32_bf16 v[176:179], v[204:207], v[112:115], v[176:179]
ds_read_b128 v[200:203], v225 offset:4096
v_max_f32 v147, 0, v147
v_mfma_f32_16x16x32_bf16 v[180:183], v[204:207], v[116:119], v[180:183]
v_max_f32 v148, 0, v148
s_waitcnt lgkmcnt(4)
v_mfma_f32_16x16x32_bf16 v[180:183], v[208:211], v[124:127], v[180:183]
ds_read_b128 v[204:207], v225 offset:5120
v_max_f32 v149, 0, v149
v_mfma_f32_16x16x32_bf16 v[176:179], v[208:211], v[120:123], v[176:179]
buffer_load_dwordx4 v224, s[4:7], s34 offen offset:3072 sc1 lds
v_mfma_f32_16x16x32_bf16 v[176:179], v[212:215], v[232:235], v[176:179]
ds_read_b128 v[208:211], v225 offset:6144
v_max_f32 v150, 0, v150
v_mfma_f32_16x16x32_bf16 v[180:183], v[212:215], v[250:253], v[180:183]
v_max_f32 v151, 0, v151
s_waitcnt lgkmcnt(4)
v_mfma_f32_16x16x32_bf16 v[132:135], v[216:219], v[4:7], 0
ds_read_b128 v[212:215], v225 offset:7168
v_mul_f32 v144, v144, v152
v_mfma_f32_16x16x32_bf16 v[128:131], v[216:219], v[0:3], 0
v_mul_f32 v145, v145, v153
v_mul_f32 v146, v146, v154
v_mfma_f32_16x16x32_bf16 v[136:139], v[220:223], v[0:3], 0
ds_read_b128 v[216:219], v225 offset:8192
s_add_u32 m0, s41, 114688
v_mfma_f32_16x16x32_bf16 v[140:143], v[220:223], v[4:7], 0
s_add_u32 s34, s36, 114688
v_mul_f32 v147, v147, v155
v_mfma_f32_16x16x32_bf16 v[132:135], v[192:195], v[12:15], v[132:135]
ds_read_b128 v[220:223], v225 offset:9216
v_mul_f32 v148, v148, v156
v_mfma_f32_16x16x32_bf16 v[128:131], v[192:195], v[8:11], v[128:131]
v_mul_f32 v149, v149, v157
s_waitcnt lgkmcnt(4)
v_mfma_f32_16x16x32_bf16 v[136:139], v[196:199], v[8:11], v[136:139]
ds_read_b128 v[192:195], v225 offset:10240
v_mul_f32 v150, v150, v158
v_mfma_f32_16x16x32_bf16 v[140:143], v[196:199], v[12:15], v[140:143]
buffer_load_dwordx4 v224, s[4:7], s34 offen offset:0 sc1 lds
v_mfma_f32_16x16x32_bf16 v[132:135], v[200:203], v[20:23], v[132:135]
ds_read_b128 v[196:199], v225 offset:11264
v_mul_f32 v151, v151, v159
v_mfma_f32_16x16x32_bf16 v[128:131], v[200:203], v[16:19], v[128:131]
v_cvt_pk_bf16_f32 v152, v144, v145
v_cvt_pk_bf16_f32 v154, v148, v149
v_mfma_f32_16x16x32_bf16 v[136:139], v[204:207], v[16:19], v[136:139]
ds_read_b128 v[200:203], v225 offset:12288
v_cvt_pk_bf16_f32 v153, v146, v147
v_mfma_f32_16x16x32_bf16 v[140:143], v[204:207], v[20:23], v[140:143]
v_cvt_pk_bf16_f32 v155, v150, v151
v_permlane16_swap_b32 v152, v154
s_nop 0
v_permlane16_swap_b32 v153, v155
buffer_store_dwordx4 v[152:155], v224, s[4:7], s45 offen offset:3072 nt
s_waitcnt lgkmcnt(4)
v_mfma_f32_16x16x32_bf16 v[132:135], v[208:211], v[28:31], v[132:135]
ds_read_b128 v[204:207], v225 offset:13312
v_max_f32 v160, 0, v160
v_mfma_f32_16x16x32_bf16 v[128:131], v[208:211], v[24:27], v[128:131]
v_max_f32 v161, 0, v161
v_max_f32 v162, 0, v162
v_mfma_f32_16x16x32_bf16 v[136:139], v[212:215], v[24:27], v[136:139]
ds_read_b128 v[208:211], v225 offset:14336
v_max_f32 v163, 0, v163
v_mfma_f32_16x16x32_bf16 v[140:143], v[212:215], v[28:31], v[140:143]
buffer_load_dwordx4 v224, s[4:7], s34 offen offset:1024 sc1 lds
v_mfma_f32_16x16x32_bf16 v[132:135], v[216:219], v[36:39], v[132:135]
ds_read_b128 v[212:215], v225 offset:15360
v_max_f32 v164, 0, v164
v_mfma_f32_16x16x32_bf16 v[128:131], v[216:219], v[32:35], v[128:131]
v_max_f32 v165, 0, v165
s_waitcnt lgkmcnt(4)
v_mfma_f32_16x16x32_bf16 v[136:139], v[220:223], v[32:35], v[136:139]
ds_read_b128 v[216:219], v224 offset:49152
v_max_f32 v166, 0, v166
v_mfma_f32_16x16x32_bf16 v[140:143], v[220:223], v[36:39], v[140:143]
v_max_f32 v167, 0, v167
v_mul_f32 v160, v160, v168
v_mfma_f32_16x16x32_bf16 v[132:135], v[192:195], v[44:47], v[132:135]
ds_read_b128 v[220:223], v224 offset:50176
v_mul_f32 v161, v161, v169
v_mfma_f32_16x16x32_bf16 v[128:131], v[192:195], v[40:43], v[128:131]
v_mul_f32 v162, v162, v170
v_mul_f32 v163, v163, v171
v_mfma_f32_16x16x32_bf16 v[136:139], v[196:199], v[40:43], v[136:139]
ds_read_b128 v[192:195], v224 offset:51200
v_mul_f32 v164, v164, v172
v_mfma_f32_16x16x32_bf16 v[140:143], v[196:199], v[44:47], v[140:143]
v_mul_f32 v165, v165, v173
s_waitcnt lgkmcnt(4)
v_mfma_f32_16x16x32_bf16 v[132:135], v[200:203], v[52:55], v[132:135]
ds_read_b128 v[196:199], v224 offset:52224
v_mul_f32 v166, v166, v174
v_mfma_f32_16x16x32_bf16 v[128:131], v[200:203], v[48:51], v[128:131]
buffer_load_dwordx4 v224, s[4:7], s34 offen offset:2048 sc1 lds
v_mfma_f32_16x16x32_bf16 v[136:139], v[204:207], v[48:51], v[136:139]
ds_read_b128 v[200:203], v224 offset:53248
v_mul_f32 v167, v167, v175
v_mfma_f32_16x16x32_bf16 v[140:143], v[204:207], v[52:55], v[140:143]
v_cvt_pk_bf16_f32 v168, v160, v161
v_cvt_pk_bf16_f32 v170, v164, v165
v_mfma_f32_16x16x32_bf16 v[132:135], v[208:211], v[60:63], v[132:135]
ds_read_b128 v[204:207], v224 offset:54272
v_cvt_pk_bf16_f32 v169, v162, v163
v_mfma_f32_16x16x32_bf16 v[128:131], v[208:211], v[56:59], v[128:131]
v_cvt_pk_bf16_f32 v171, v166, v167
s_waitcnt lgkmcnt(4)
v_mfma_f32_16x16x32_bf16 v[136:139], v[212:215], v[56:59], v[136:139]
ds_read_b128 v[208:211], v224 offset:55296
v_permlane16_swap_b32 v168, v170
v_mfma_f32_16x16x32_bf16 v[140:143], v[212:215], v[60:63], v[140:143]
v_permlane16_swap_b32 v169, v171
v_mfma_f32_16x16x32_bf16 v[132:135], v[216:219], v[68:71], v[132:135]
ds_read_b128 v[212:215], v224 offset:56320
v_mfma_f32_16x16x32_bf16 v[128:131], v[216:219], v[64:67], v[128:131]
buffer_store_dwordx4 v[168:171], v224, s[4:7], s45 offen offset:2048 nt
v_mfma_f32_16x16x32_bf16 v[136:139], v[220:223], v[64:67], v[136:139]
ds_read_b128 v[216:219], v224 offset:57344
v_permlane32_swap_b32 v176, v180
v_mfma_f32_16x16x32_bf16 v[140:143], v[220:223], v[68:71], v[140:143]
v_permlane32_swap_b32 v177, v181
s_waitcnt lgkmcnt(4)
v_mfma_f32_16x16x32_bf16 v[132:135], v[192:195], v[76:79], v[132:135]
ds_read_b128 v[220:223], v224 offset:58368
v_permlane32_swap_b32 v178, v182
v_mfma_f32_16x16x32_bf16 v[128:131], v[192:195], v[72:75], v[128:131]
buffer_load_dwordx4 v224, s[4:7], s34 offen offset:3072 sc1 lds
v_mfma_f32_16x16x32_bf16 v[136:139], v[196:199], v[72:75], v[136:139]
ds_read_b128 v[192:195], v224 offset:59392
v_permlane32_swap_b32 v179, v183
v_mfma_f32_16x16x32_bf16 v[140:143], v[196:199], v[76:79], v[140:143]
v_max_f32 v176, 0, v176
v_max_f32 v177, 0, v177
v_mfma_f32_16x16x32_bf16 v[132:135], v[200:203], v[84:87], v[132:135]
ds_read_b128 v[196:199], v224 offset:60416
v_max_f32 v178, 0, v178
v_mfma_f32_16x16x32_bf16 v[128:131], v[200:203], v[80:83], v[128:131]
v_max_f32 v179, 0, v179
s_waitcnt lgkmcnt(4)
v_mfma_f32_16x16x32_bf16 v[136:139], v[204:207], v[80:83], v[136:139]
ds_read_b128 v[200:203], v224 offset:61440
v_mul_f32 v176, v176, v180
v_mfma_f32_16x16x32_bf16 v[140:143], v[204:207], v[84:87], v[140:143]
v_mul_f32 v177, v177, v181
v_mul_f32 v178, v178, v182
v_mfma_f32_16x16x32_bf16 v[132:135], v[208:211], v[92:95], v[132:135]
ds_read_b128 v[204:207], v224 offset:62464
v_mul_f32 v179, v179, v183
v_mfma_f32_16x16x32_bf16 v[128:131], v[208:211], v[88:91], v[128:131]
s_cmp_lg_u32 s26, 0
s_waitcnt vmcnt(4)
s_cbranch_scc0 SS_114
buffer_store_dword v228, v241, s[4:7], s49 offen offset:32
SJ_115:
v_mfma_f32_16x16x32_bf16 v[136:139], v[212:215], v[88:91], v[136:139]
ds_read_b128 v[208:211], v224 offset:63488
v_cvt_pk_bf16_f32 v180, v176, v177
v_mfma_f32_16x16x32_bf16 v[140:143], v[212:215], v[92:95], v[140:143]
v_cvt_pk_bf16_f32 v181, v178, v179
s_waitcnt lgkmcnt(4)
v_mfma_f32_16x16x32_bf16 v[132:135], v[216:219], v[100:103], v[132:135]
ds_read_b128 v[212:215], v224 offset:64512
v_mfma_f32_16x16x32_bf16 v[128:131], v[216:219], v[96:99], v[128:131]
buffer_store_dwordx2 v[180:181], v254, s[4:7], s32 offen nt
v_mfma_f32_16x16x32_bf16 v[136:139], v[220:223], v[96:99], v[136:139]
ds_read_b32 v216, v226 offset:640
v_lshrrev_b32 v229, 5, v240
v_mfma_f32_16x16x32_bf16 v[140:143], v[220:223], v[100:103], v[140:143]
v_mul_u32_u24 v229, 12288, v229
v_bfe_u32 v230, v240, 4, 1
v_mfma_f32_16x16x32_bf16 v[132:135], v[192:195], v[108:111], v[132:135]
ds_read_b32 v220, v226 offset:704
v_lshl_add_u32 v229, v230, 9, v229
v_mfma_f32_16x16x32_bf16 v[128:131], v[192:195], v[104:107], v[128:131]
v_and_b32 v230, 0xf0, v224
s_waitcnt lgkmcnt(4)
v_mfma_f32_16x16x32_bf16 v[136:139], v[196:199], v[104:107], v[136:139]
s_barrier
ds_read_b128 v[192:195], v224 offset:0
v_mfma_f32_16x16x32_bf16 v[140:143], v[196:199], v[108:111], v[140:143]
s_bfe_u32 s35, s41, 0x90004
v_add3_u32 v229, v229, v230, s35
v_mfma_f32_16x16x32_bf16 v[132:135], v[200:203], v[116:119], v[132:135]
ds_read_b128 v[196:199], v224 offset:1024
v_xor_b32 v230, 0x100, v229
v_mfma_f32_16x16x32_bf16 v[128:131], v[200:203], v[112:115], v[128:131]
v_mfma_f32_16x16x32_bf16 v[136:139], v[204:207], v[112:115], v[136:139]
ds_read_b128 v[200:203], v224 offset:2048
v_mfma_f32_16x16x32_bf16 v[140:143], v[204:207], v[116:119], v[140:143]
s_waitcnt lgkmcnt(4)
v_mfma_f32_16x16x32_bf16 v[132:135], v[208:211], v[124:127], v[132:135]
ds_read_b128 v[204:207], v224 offset:3072
v_mfma_f32_16x16x32_bf16 v[128:131], v[208:211], v[120:123], v[128:131]
v_mfma_f32_16x16x32_bf16 v[136:139], v[212:215], v[120:123], v[136:139]
ds_read_b128 v[208:211], v224 offset:4096
v_mfma_f32_16x16x32_bf16 v[140:143], v[212:215], v[124:127], v[140:143]
v_mfma_f32_16x16x32_bf16 v[132:135], v[216:219], v[250:253], v[132:135]
ds_read_b128 v[212:215], v224 offset:5120
v_mfma_f32_16x16x32_bf16 v[128:131], v[216:219], v[232:235], v[128:131]
s_waitcnt lgkmcnt(4)
v_mfma_f32_16x16x32_bf16 v[136:139], v[220:223], v[232:235], v[136:139]
ds_read_b128 v[216:219], v224 offset:6144
v_mfma_f32_16x16x32_bf16 v[140:143], v[220:223], v[250:253], v[140:143]
s_waitcnt lgkmcnt(4)
v_mfma_f32_16x16x32_bf16 v[148:151], v[192:195], v[4:7], 0
ds_read_b128 v[220:223], v224 offset:7168
v_mfma_f32_16x16x32_bf16 v[144:147], v[192:195], v[0:3], 0
buffer_load_dword v227, v226, s[4:7], s51 offen sc1
v_mfma_f32_16x16x32_bf16 v[152:155], v[196:199], v[0:3], 0
ds_read_b128 v[192:195], v224 offset:8192
v_mfma_f32_16x16x32_bf16 v[156:159], v[196:199], v[4:7], 0
v_mfma_f32_16x16x32_bf16 v[148:151], v[200:203], v[12:15], v[148:151]
ds_read_b128 v[196:199], v224 offset:9216
v_max_f32 v128, 0, v128
v_mfma_f32_16x16x32_bf16 v[144:147], v[200:203], v[8:11], v[144:147]
v_max_f32 v129, 0, v129
s_waitcnt lgkmcnt(4)
v_mfma_f32_16x16x32_bf16 v[152:155], v[204:207], v[8:11], v[152:155]
ds_read_b128 v[200:203], v224 offset:10240
v_max_f32 v130, 0, v130
v_mfma_f32_16x16x32_bf16 v[156:159], v[204:207], v[12:15], v[156:159]
v_max_f32 v131, 0, v131
v_max_f32 v132, 0, v132
v_mfma_f32_16x16x32_bf16 v[148:151], v[208:211], v[20:23], v[148:151]
ds_read_b128 v[204:207], v224 offset:11264
v_max_f32 v133, 0, v133
v_mfma_f32_16x16x32_bf16 v[144:147], v[208:211], v[16:19], v[144:147]
v_max_f32 v134, 0, v134
v_max_f32 v135, 0, v135
v_mfma_f32_16x16x32_bf16 v[152:155], v[212:215], v[16:19], v[152:155]
ds_read_b128 v[208:211], v224 offset:12288
v_mul_f32 v128, v128, v136
v_mfma_f32_16x16x32_bf16 v[156:159], v[212:215], v[20:23], v[156:159]
v_mul_f32 v129, v129, v137
s_waitcnt lgkmcnt(4)
v_mfma_f32_16x16x32_bf16 v[148:151], v[216:219], v[28:31], v[148:151]
ds_read_b128 v[212:215], v224 offset:13312
v_mul_f32 v130, v130, v138
v_mfma_f32_16x16x32_bf16 v[144:147], v[216:219], v[24:27], v[144:147]
v_mul_f32 v131, v131, v139
v_mul_f32 v132, v132, v140
v_mfma_f32_16x16x32_bf16 v[152:155], v[220:223], v[24:27], v[152:155]
ds_read_b128 v[216:219], v224 offset:14336
v_mul_f32 v133, v133, v141
v_mfma_f32_16x16x32_bf16 v[156:159], v[220:223], v[28:31], v[156:159]
v_mul_f32 v134, v134, v142
v_mul_f32 v135, v135, v143
v_mfma_f32_16x16x32_bf16 v[148:151], v[192:195], v[36:39], v[148:151]
ds_read_b128 v[220:223], v224 offset:15360
v_cvt_pk_bf16_f32 v136, v128, v129
v_mfma_f32_16x16x32_bf16 v[144:147], v[192:195], v[32:35], v[144:147]
s_waitcnt vmcnt(0)
v_cmp_ne_u32 s[66:67], s53, v227
s_waitcnt lgkmcnt(4)
v_mfma_f32_16x16x32_bf16 v[152:155], v[196:199], v[32:35], v[152:155]
s_barrier
ds_read_b128 v[192:195], v225 offset:49152
v_mfma_f32_16x16x32_bf16 v[156:159], v[196:199], v[36:39], v[156:159]
s_and_b32 s66, s66, 65280
s_cmp_ge_u32 s66, s26
s_cbranch_scc1 CR_89
CJ_92:
v_mfma_f32_16x16x32_bf16 v[148:151], v[200:203], v[44:47], v[148:151]
ds_read_b128 v[196:199], v225 offset:50176
s_add_u32 s33, s46, 102400
v_mfma_f32_16x16x32_bf16 v[144:147], v[200:203], v[40:43], v[144:147]
buffer_load_dwordx4 v[0:3], v229, s[4:7], s33 offen sc1
v_mfma_f32_16x16x32_bf16 v[152:155], v[204:207], v[40:43], v[152:155]
ds_read_b128 v[200:203], v225 offset:51200
s_add_u32 s33, s46, 4096
v_mfma_f32_16x16x32_bf16 v[156:159], v[204:207], v[44:47], v[156:159]
v_cvt_pk_bf16_f32 v138, v132, v133
s_waitcnt lgkmcnt(4)
v_mfma_f32_16x16x32_bf16 v[148:151], v[208:211], v[52:55], v[148:151]
ds_read_b128 v[204:207], v225 offset:52224
v_cvt_pk_bf16_f32 v137, v130, v131
v_mfma_f32_16x16x32_bf16 v[144:147], v[208:211], v[48:51], v[144:147]
buffer_load_dwordx4 v[4:7], v229, s[4:7], s33 offen sc1
v_mfma_f32_16x16x32_bf16 v[152:155], v[212:215], v[48:51], v[152:155]
ds_read_b128 v[208:211], v225 offset:53248
s_add_u32 s33, s46, 102400
v_mfma_f32_16x16x32_bf16 v[156:159], v[212:215], v[52:55], v[156:159]
s_cmp_lg_u32 s26, 0
s_cbranch_scc0 SS_116
buffer_store_dword v228, v241, s[4:7], s49 offen offset:64
SJ_117:
v_mfma_f32_16x16x32_bf16 v[148:151], v[216:219], v[60:63], v[148:151]
ds_read_b128 v[212:215], v225 offset:54272
v_cvt_pk_bf16_f32 v139, v134, v135
v_mfma_f32_16x16x32_bf16 v[144:147], v[216:219], v[56:59], v[144:147]
v_permlane16_swap_b32 v136, v138
s_waitcnt lgkmcnt(4)
v_mfma_f32_16x16x32_bf16 v[152:155], v[220:223], v[56:59], v[152:155]
ds_read_b128 v[216:219], v225 offset:55296
v_permlane16_swap_b32 v137, v139
v_mfma_f32_16x16x32_bf16 v[156:159], v[220:223], v[60:63], v[156:159]
buffer_load_dwordx4 v[8:11], v230, s[4:7], s33 offen sc1
v_mfma_f32_16x16x32_bf16 v[148:151], v[192:195], v[68:71], v[148:151]
ds_read_b128 v[220:223], v225 offset:56320
s_add_u32 s33, s46, 4096
v_mfma_f32_16x16x32_bf16 v[144:147], v[192:195], v[64:67], v[144:147]
buffer_load_dwordx4 v[12:15], v230, s[4:7], s33 offen sc1
buffer_store_dwordx4 v[136:139], v224, s[4:7], s45 offen offset:1024 nt
v_mfma_f32_16x16x32_bf16 v[152:155], v[196:199], v[64:67], v[152:155]
ds_read_b128 v[192:195], v225 offset:57344
v_mfma_f32_16x16x32_bf16 v[156:159], v[196:199], v[68:71], v[156:159]
s_waitcnt lgkmcnt(4)
v_mfma_f32_16x16x32_bf16 v[148:151], v[200:203], v[76:79], v[148:151]
ds_read_b128 v[196:199], v225 offset:58368
s_add_u32 s33, s46, 108544
v_mfma_f32_16x16x32_bf16 v[144:147], v[200:203], v[72:75], v[144:147]
v_mfma_f32_16x16x32_bf16 v[152:155], v[204:207], v[72:75], v[152:155]
ds_read_b128 v[200:203], v225 offset:59392
v_mfma_f32_16x16x32_bf16 v[156:159], v[204:207], v[76:79], v[156:159]
buffer_load_dwordx4 v[16:19], v229, s[4:7], s33 offen sc1
v_mfma_f32_16x16x32_bf16 v[148:151], v[208:211], v[84:87], v[148:151]
ds_read_b128 v[204:207], v225 offset:60416
s_add_u32 s33, s46, 10240
v_mfma_f32_16x16x32_bf16 v[144:147], v[208:211], v[80:83], v[144:147]
s_waitcnt lgkmcnt(4)
v_mfma_f32_16x16x32_bf16 v[152:155], v[212:215], v[80:83], v[152:155]
ds_read_b128 v[208:211], v225 offset:61440
v_mfma_f32_16x16x32_bf16 v[156:159], v[212:215], v[84:87], v[156:159]
buffer_load_dwordx4 v[20:23], v229, s[4:7], s33 offen sc1
v_mfma_f32_16x16x32_bf16 v[148:151], v[216:219], v[92:95], v[148:151]
ds_read_b128 v[212:215], v225 offset:62464
s_add_u32 s33, s46, 108544
v_mfma_f32_16x16x32_bf16 v[144:147], v[216:219], v[88:91], v[144:147]
v_mfma_f32_16x16x32_bf16 v[152:155], v[220:223], v[88:91], v[152:155]
ds_read_b128 v[216:219], v225 offset:63488
v_mfma_f32_16x16x32_bf16 v[156:159], v[220:223], v[92:95], v[156:159]
s_waitcnt lgkmcnt(4)
v_mfma_f32_16x16x32_bf16 v[148:151], v[192:195], v[100:103], v[148:151]
ds_read_b128 v[220:223], v225 offset:64512
v_mfma_f32_16x16x32_bf16 v[144:147], v[192:195], v[96:99], v[144:147]
buffer_load_dwordx4 v[24:27], v230, s[4:7], s33 offen sc1
v_mfma_f32_16x16x32_bf16 v[152:155], v[196:199], v[96:99], v[152:155]
ds_read_b32 v192, v226 offset:512
s_add_u32 s33, s46, 10240
v_mfma_f32_16x16x32_bf16 v[156:159], v[196:199], v[100:103], v[156:159]
buffer_load_dwordx4 v[28:31], v230, s[4:7], s33 offen sc1
v_mfma_f32_16x16x32_bf16 v[148:151], v[200:203], v[108:111], v[148:151]
ds_read_b32 v196, v226 offset:576
v_mfma_f32_16x16x32_bf16 v[144:147], v[200:203], v[104:107], v[144:147]
s_waitcnt lgkmcnt(4)
v_mfma_f32_16x16x32_bf16 v[152:155], v[204:207], v[104:107], v[152:155]
buffer_load_dword v227, v226, s[4:7], s51 offen sc1
v_mfma_f32_16x16x32_bf16 v[156:159], v[204:207], v[108:111], v[156:159]
s_add_u32 s33, s46, 101376
v_mfma_f32_16x16x32_bf16 v[148:151], v[208:211], v[116:119], v[148:151]
buffer_load_dwordx4 v[32:35], v229, s[4:7], s33 offen sc1
v_mfma_f32_16x16x32_bf16 v[144:147], v[208:211], v[112:115], v[144:147]
v_mfma_f32_16x16x32_bf16 v[152:155], v[212:215], v[112:115], v[152:155]
s_add_u32 s33, s46, 3072
v_mfma_f32_16x16x32_bf16 v[156:159], v[212:215], v[116:119], v[156:159]
s_waitcnt lgkmcnt(1)
v_mfma_f32_16x16x32_bf16 v[148:151], v[216:219], v[124:127], v[148:151]
buffer_load_dwordx4 v[36:39], v229, s[4:7], s33 offen sc1
v_mfma_f32_16x16x32_bf16 v[144:147], v[216:219], v[120:123], v[144:147]
v_mfma_f32_16x16x32_bf16 v[152:155], v[220:223], v[120:123], v[152:155]
s_add_u32 s33, s46, 101376
v_mfma_f32_16x16x32_bf16 v[156:159], v[220:223], v[124:127], v[156:159]
v_mfma_f32_16x16x32_bf16 v[148:151], v[192:195], v[250:253], v[148:151]
buffer_load_dwordx4 v[40:43], v230, s[4:7], s33 offen sc1
v_mfma_f32_16x16x32_bf16 v[144:147], v[192:195], v[232:235], v[144:147]
s_waitcnt lgkmcnt(0)
v_mfma_f32_16x16x32_bf16 v[152:155], v[196:199], v[232:235], v[152:155]
v_mfma_f32_16x16x32_bf16 v[156:159], v[196:199], v[250:253], v[156:159]
s_nop 4
v_max_f32 v144, 0, v144
v_max_f32 v145, 0, v145
v_max_f32 v146, 0, v146
v_max_f32 v147, 0, v147
v_max_f32 v148, 0, v148
v_max_f32 v149, 0, v149
v_max_f32_e64 v150, 0, v150
v_max_f32 v151, 0, v151
v_pk_mul_f32 v[144:145], v[144:145], v[152:153]
v_pk_mul_f32 v[146:147], v[146:147], v[154:155]
v_pk_mul_f32 v[148:149], v[148:149], v[156:157]
v_pk_mul_f32 v[150:151], v[150:151], v[158:159]
v_cvt_pk_bf16_f32 v152, v144, v145
v_cvt_pk_bf16_f32 v154, v148, v149
v_cvt_pk_bf16_f32 v153, v146, v147
v_cvt_pk_bf16_f32 v155, v150, v151
v_permlane16_swap_b32 v152, v154
s_nop 0
v_permlane16_swap_b32 v153, v155
buffer_store_dwordx4 v[152:155], v224, s[4:7], s45 offen offset:0 nt
s_waitcnt vmcnt(14)
v_mfma_f32_16x16x32_bf16 v[160:163], a[192:195], v[0:3], 0
s_add_u32 s33, s46, 3072
v_mfma_f32_16x16x32_bf16 v[164:167], a[196:199], v[0:3], 0
v_mfma_f32_16x16x32_bf16 v[176:179], a[200:203], v[0:3], 0
buffer_load_dwordx4 v[44:47], v230, s[4:7], s33 offen sc1
v_mfma_f32_16x16x32_bf16 v[180:183], a[204:207], v[0:3], 0
s_waitcnt vmcnt(14)
v_mfma_f32_16x16x32_bf16 v[148:151], a[204:207], v[4:7], 0
v_xor_b32 v247, 2048, v242
v_xor_b32 v248, 4096, v242
v_mfma_f32_16x16x32_bf16 v[144:147], a[200:203], v[4:7], 0
v_xor_b32 v249, 6144, v242
v_and_b32 v246, 15, v240
v_mfma_f32_16x16x32_bf16 v[132:135], a[196:199], v[4:7], 0
s_add_u32 s33, s46, 107520
v_mfma_f32_16x16x32_bf16 v[128:131], a[192:195], v[4:7], 0
s_waitcnt vmcnt(12)
v_mfma_f32_16x16x32_bf16 v[168:171], a[192:195], v[8:11], 0
buffer_load_dwordx4 v[48:51], v229, s[4:7], s33 offen sc1
v_mfma_f32_16x16x32_bf16 v[172:175], a[196:199], v[8:11], 0
s_lshl_b32 s30, s24, 8
s_bfe_u32 s35, s41, 0x70006
s_add_u32 s30, s30, s35
s_add_u32 s30, s30, 161280
v_lshl_add_u32 v246, v246, 2, s30
v_mfma_f32_16x16x32_bf16 v[184:187], a[200:203], v[8:11], 0
s_add_u32 s33, s46, 9216
ds_read_b32 v254, v246 offset:1344
v_mfma_f32_16x16x32_bf16 v[188:191], a[204:207], v[8:11], 0
ds_read_b32 v255, v246 offset:1472
s_waitcnt vmcnt(12)
v_mfma_f32_16x16x32_bf16 v[156:159], a[204:207], v[12:15], 0
buffer_load_dwordx4 v[52:55], v229, s[4:7], s33 offen sc1
v_mfma_f32_16x16x32_bf16 v[152:155], a[200:203], v[12:15], 0
v_accvgpr_read_b32 v217, a248
v_accvgpr_read_b32 v219, a249
v_mfma_f32_16x16x32_bf16 v[140:143], a[196:199], v[12:15], 0
s_add_u32 s33, s46, 107520
v_accvgpr_read_b32 v221, a250
v_mfma_f32_16x16x32_bf16 v[136:139], a[192:195], v[12:15], 0
s_waitcnt vmcnt(7)
v_cmp_ne_u32 s[66:67], s53, v227
v_mfma_f32_16x16x32_bf16 v[160:163], a[208:211], v[16:19], v[160:163]
s_and_b32 s66, s66, 16711680
s_cmp_ge_u32 s66, s26
s_cbranch_scc1 CR_93
CJ_96:
v_mfma_f32_16x16x32_bf16 v[164:167], a[212:215], v[16:19], v[164:167]
buffer_load_dwordx4 v[56:59], v230, s[4:7], s33 offen sc1
v_mfma_f32_16x16x32_bf16 v[176:179], a[216:219], v[16:19], v[176:179]
s_add_u32 s33, s46, 9216
v_accvgpr_read_b32 v223, a251
v_mfma_f32_16x16x32_bf16 v[180:183], a[220:223], v[16:19], v[180:183]
v_lshlrev_b32 v216, 16, v217
v_mfma_f32_16x16x32_bf16 v[148:151], a[220:223], v[20:23], v[148:151]
buffer_load_dwordx4 v[60:63], v230, s[4:7], s33 offen sc1
v_mfma_f32_16x16x32_bf16 v[144:147], a[216:219], v[20:23], v[144:147]
s_cmp_lg_u32 s26, 0
s_waitcnt vmcnt(5)
s_cbranch_scc0 SS_118
buffer_store_dword v228, v241, s[4:7], s49 offen offset:96
SJ_119:
v_mfma_f32_16x16x32_bf16 v[132:135], a[212:215], v[20:23], v[132:135]
v_and_b32 v217, 0xffff0000, v217
v_lshlrev_b32 v218, 16, v219
v_mfma_f32_16x16x32_bf16 v[128:131], a[208:211], v[20:23], v[128:131]
v_and_b32 v219, 0xffff0000, v219
v_mfma_f32_16x16x32_bf16 v[168:171], a[208:211], v[24:27], v[168:171]
s_add_u32 s33, s46, 100352
v_lshlrev_b32 v220, 16, v221
v_mfma_f32_16x16x32_bf16 v[172:175], a[212:215], v[24:27], v[172:175]
v_and_b32 v221, 0xffff0000, v221
v_lshlrev_b32 v222, 16, v223
v_mfma_f32_16x16x32_bf16 v[184:187], a[216:219], v[24:27], v[184:187]
buffer_load_dwordx4 v[64:67], v229, s[4:7], s33 offen sc1
v_mfma_f32_16x16x32_bf16 v[188:191], a[220:223], v[24:27], v[188:191]
v_and_b32 v223, 0xffff0000, v223
v_mfma_f32_16x16x32_bf16 v[156:159], a[220:223], v[28:31], v[156:159]
s_add_u32 s33, s46, 2048
v_mfma_f32_16x16x32_bf16 v[152:155], a[216:219], v[28:31], v[152:155]
v_mfma_f32_16x16x32_bf16 v[140:143], a[212:215], v[28:31], v[140:143]
buffer_load_dwordx4 v[68:71], v229, s[4:7], s33 offen sc1
v_mfma_f32_16x16x32_bf16 v[136:139], a[208:211], v[28:31], v[136:139]
v_mfma_f32_16x16x32_bf16 v[160:163], a[160:163], v[32:35], v[160:163]
s_add_u32 s33, s46, 100352
v_mfma_f32_16x16x32_bf16 v[164:167], a[164:167], v[32:35], v[164:167]
v_mfma_f32_16x16x32_bf16 v[176:179], a[168:171], v[32:35], v[176:179]
buffer_load_dwordx4 v[72:75], v230, s[4:7], s33 offen sc1
v_mfma_f32_16x16x32_bf16 v[180:183], a[172:175], v[32:35], v[180:183]
v_mfma_f32_16x16x32_bf16 v[148:151], a[172:175], v[36:39], v[148:151]
s_add_u32 s33, s46, 2048
v_mfma_f32_16x16x32_bf16 v[144:147], a[168:171], v[36:39], v[144:147]
v_mfma_f32_16x16x32_bf16 v[132:135], a[164:167], v[36:39], v[132:135]
buffer_load_dwordx4 v[76:79], v230, s[4:7], s33 offen sc1
v_mfma_f32_16x16x32_bf16 v[128:131], a[160:163], v[36:39], v[128:131]
v_mfma_f32_16x16x32_bf16 v[168:171], a[160:163], v[40:43], v[168:171]
v_mfma_f32_16x16x32_bf16 v[172:175], a[164:167], v[40:43], v[172:175]
v_mfma_f32_16x16x32_bf16 v[184:187], a[168:171], v[40:43], v[184:187]
s_add_u32 s33, s46, 106496
v_mfma_f32_16x16x32_bf16 v[188:191], a[172:175], v[40:43], v[188:191]
s_waitcnt vmcnt(9)
v_mfma_f32_16x16x32_bf16 v[156:159], a[172:175], v[44:47], v[156:159]
buffer_load_dwordx4 v[80:83], v229, s[4:7], s33 offen sc1
v_mfma_f32_16x16x32_bf16 v[152:155], a[168:171], v[44:47], v[152:155]
v_mfma_f32_16x16x32_bf16 v[140:143], a[164:167], v[44:47], v[140:143]
buffer_load_dword v227, v226, s[4:7], s51 offen sc1
v_mfma_f32_16x16x32_bf16 v[136:139], a[160:163], v[44:47], v[136:139]
s_add_u32 s33, s46, 8192
s_waitcnt vmcnt(10)
v_mfma_f32_16x16x32_bf16 v[160:163], a[176:179], v[48:51], v[160:163]
buffer_load_dwordx4 v[84:87], v229, s[4:7], s33 offen sc1
v_mfma_f32_16x16x32_bf16 v[164:167], a[180:183], v[48:51], v[164:167]
v_mfma_f32_16x16x32_bf16 v[176:179], a[184:187], v[48:51], v[176:179]
s_add_u32 s33, s46, 106496
v_mfma_f32_16x16x32_bf16 v[180:183], a[188:191], v[48:51], v[180:183]
s_waitcnt vmcnt(10)
v_mfma_f32_16x16x32_bf16 v[148:151], a[188:191], v[52:55], v[148:151]
buffer_load_dwordx4 v[88:91], v230, s[4:7], s33 offen sc1
v_mfma_f32_16x16x32_bf16 v[144:147], a[184:187], v[52:55], v[144:147]
v_mfma_f32_16x16x32_bf16 v[132:135], a[180:183], v[52:55], v[132:135]
s_add_u32 s33, s46, 8192
v_mfma_f32_16x16x32_bf16 v[128:131], a[176:179], v[52:55], v[128:131]
s_waitcnt vmcnt(10)
v_mfma_f32_16x16x32_bf16 v[168:171], a[176:179], v[56:59], v[168:171]
buffer_load_dwordx4 v[92:95], v230, s[4:7], s33 offen sc1
v_mfma_f32_16x16x32_bf16 v[172:175], a[180:183], v[56:59], v[172:175]
v_mfma_f32_16x16x32_bf16 v[184:187], a[184:187], v[56:59], v[184:187]
v_mfma_f32_16x16x32_bf16 v[188:191], a[188:191], v[56:59], v[188:191]
s_waitcnt vmcnt(10)
v_mfma_f32_16x16x32_bf16 v[156:159], a[188:191], v[60:63], v[156:159]
s_add_u32 s33, s46, 5120
v_mfma_f32_16x16x32_bf16 v[152:155], a[184:187], v[60:63], v[152:155]
s_branch L_SK9
L_ST9:
s_setpc_b64 s[10:11]
L_SK9:
v_mfma_f32_16x16x32_bf16 v[140:143], a[180:183], v[60:63], v[140:143]
buffer_load_dwordx4 v[96:99], v229, s[4:7], s33 offen sc1
v_mfma_f32_16x16x32_bf16 v[136:139], a[176:179], v[60:63], v[136:139]
s_waitcnt vmcnt(9)
v_mfma_f32_16x16x32_bf16 v[160:163], a[128:131], v[64:67], v[160:163]
s_add_u32 s33, s46, 5120
s_waitcnt vmcnt(4)
v_mfma_f32_16x16x32_bf16 v[164:167], a[132:135], v[64:67], v[164:167]
v_cmp_ne_u32 s[66:67], s53, v227
v_mfma_f32_16x16x32_bf16 v[176:179], a[136:139], v[64:67], v[176:179]
s_and_b32 s66, s66, 4278190080
s_cmp_ge_u32 s66, s26
s_cbranch_scc1 CR_97
CJ_100:
v_mfma_f32_16x16x32_bf16 v[180:183], a[140:143], v[64:67], v[180:183]
v_mfma_f32_16x16x32_bf16 v[148:151], a[140:143], v[68:71], v[148:151]
buffer_load_dwordx4 v[100:103], v230, s[4:7], s33 offen sc1
v_mfma_f32_16x16x32_bf16 v[144:147], a[136:139], v[68:71], v[144:147]
s_add_u32 s33, s46, 1024
v_mfma_f32_16x16x32_bf16 v[132:135], a[132:135], v[68:71], v[132:135]
buffer_load_dwordx4 v[104:107], v229, s[4:7], s33 offen sc1
v_mfma_f32_16x16x32_bf16 v[128:131], a[128:131], v[68:71], v[128:131]
v_mfma_f32_16x16x32_bf16 v[168:171], a[128:131], v[72:75], v[168:171]
s_add_u32 s33, s46, 1024
v_mfma_f32_16x16x32_bf16 v[172:175], a[132:135], v[72:75], v[172:175]
v_mfma_f32_16x16x32_bf16 v[184:187], a[136:139], v[72:75], v[184:187]
buffer_load_dwordx4 v[108:111], v230, s[4:7], s33 offen sc1
v_mfma_f32_16x16x32_bf16 v[188:191], a[140:143], v[72:75], v[188:191]
v_mfma_f32_16x16x32_bf16 v[156:159], a[140:143], v[76:79], v[156:159]
v_mfma_f32_16x16x32_bf16 v[152:155], a[136:139], v[76:79], v[152:155]
v_mfma_f32_16x16x32_bf16 v[140:143], a[132:135], v[76:79], v[140:143]
s_add_u32 s33, s46, 7168
v_mfma_f32_16x16x32_bf16 v[136:139], a[128:131], v[76:79], v[136:139]
v_mfma_f32_16x16x32_bf16 v[160:163], a[144:147], v[80:83], v[160:163]
buffer_load_dwordx4 v[112:115], v229, s[4:7], s33 offen sc1
v_mfma_f32_16x16x32_bf16 v[164:167], a[148:151], v[80:83], v[164:167]
v_mfma_f32_16x16x32_bf16 v[176:179], a[152:155], v[80:83], v[176:179]
s_add_u32 s33, s46, 7168
v_mfma_f32_16x16x32_bf16 v[180:183], a[156:159], v[80:83], v[180:183]
s_waitcnt vmcnt(7)
v_mfma_f32_16x16x32_bf16 v[148:151], a[156:159], v[84:87], v[148:151]
buffer_load_dwordx4 v[116:119], v230, s[4:7], s33 offen sc1
v_mfma_f32_16x16x32_bf16 v[144:147], a[152:155], v[84:87], v[144:147]
v_mfma_f32_16x16x32_bf16 v[132:135], a[148:151], v[84:87], v[132:135]
s_add_u32 s33, s46, 0
v_mfma_f32_16x16x32_bf16 v[128:131], a[144:147], v[84:87], v[128:131]
s_waitcnt vmcnt(7)
v_mfma_f32_16x16x32_bf16 v[168:171], a[144:147], v[88:91], v[168:171]
buffer_load_dwordx4 v[120:123], v229, s[4:7], s33 offen sc1
v_mfma_f32_16x16x32_bf16 v[172:175], a[148:151], v[88:91], v[172:175]
v_mfma_f32_16x16x32_bf16 v[184:187], a[152:155], v[88:91], v[184:187]
s_add_u32 s33, s46, 0
v_mfma_f32_16x16x32_bf16 v[188:191], a[156:159], v[88:91], v[188:191]
s_waitcnt vmcnt(7)
v_mfma_f32_16x16x32_bf16 v[156:159], a[156:159], v[92:95], v[156:159]
buffer_load_dwordx4 v[124:127], v230, s[4:7], s33 offen sc1
v_mfma_f32_16x16x32_bf16 v[152:155], a[152:155], v[92:95], v[152:155]
v_mfma_f32_16x16x32_bf16 v[140:143], a[148:151], v[92:95], v[140:143]
s_add_u32 s33, s46, 6144
v_mfma_f32_16x16x32_bf16 v[136:139], a[144:147], v[92:95], v[136:139]
s_waitcnt vmcnt(7)
v_mfma_f32_16x16x32_bf16 v[128:131], a[224:227], v[96:99], v[128:131]
buffer_load_dwordx4 v[0:3], v229, s[4:7], s33 offen sc1
v_mfma_f32_16x16x32_bf16 v[132:135], a[228:231], v[96:99], v[132:135]
s_add_u32 s33, s46, 6144
v_mfma_f32_16x16x32_bf16 v[144:147], a[232:235], v[96:99], v[144:147]
buffer_load_dwordx4 v[4:7], v230, s[4:7], s33 offen sc1
v_mfma_f32_16x16x32_bf16 v[148:151], a[236:239], v[96:99], v[148:151]
s_waitcnt vmcnt(8)
v_mfma_f32_16x16x32_bf16 v[156:159], a[236:239], v[100:103], v[156:159]
s_add_u32 s33, s46, 103424
v_mfma_f32_16x16x32_bf16 v[152:155], a[232:235], v[100:103], v[152:155]
v_mfma_f32_16x16x32_bf16 v[140:143], a[228:231], v[100:103], v[140:143]
buffer_load_dwordx4 v[8:11], v229, s[4:7], s33 offen sc1
v_mfma_f32_16x16x32_bf16 v[136:139], a[224:227], v[100:103], v[136:139]
s_waitcnt vmcnt(8)
v_mfma_f32_16x16x32_bf16 v[128:131], a[96:99], v[104:107], v[128:131]
s_add_u32 s33, s46, 103424
v_mfma_f32_16x16x32_bf16 v[132:135], a[100:103], v[104:107], v[132:135]
v_mfma_f32_16x16x32_bf16 v[144:147], a[104:107], v[104:107], v[144:147]
buffer_load_dwordx4 v[12:15], v230, s[4:7], s33 offen sc1
v_mfma_f32_16x16x32_bf16 v[148:151], a[108:111], v[104:107], v[148:151]
s_waitcnt vmcnt(8)
v_mfma_f32_16x16x32_bf16 v[156:159], a[108:111], v[108:111], v[156:159]
s_add_u32 s33, s46, 99328
v_mfma_f32_16x16x32_bf16 v[152:155], a[104:107], v[108:111], v[152:155]
v_mfma_f32_16x16x32_bf16 v[140:143], a[100:103], v[108:111], v[140:143]
buffer_load_dwordx4 v[16:19], v229, s[4:7], s33 offen sc1
v_mfma_f32_16x16x32_bf16 v[136:139], a[96:99], v[108:111], v[136:139]
s_add_u32 s33, s46, 99328
s_waitcnt vmcnt(8)
v_mfma_f32_16x16x32_bf16 v[128:131], a[112:115], v[112:115], v[128:131]
buffer_load_dwordx4 v[20:23], v230, s[4:7], s33 offen sc1
v_mfma_f32_16x16x32_bf16 v[132:135], a[116:119], v[112:115], v[132:135]
v_mfma_f32_16x16x32_bf16 v[144:147], a[120:123], v[112:115], v[144:147]
s_add_u32 s33, s46, 105472
v_mfma_f32_16x16x32_bf16 v[148:151], a[124:127], v[112:115], v[148:151]
s_waitcnt vmcnt(8)
v_mfma_f32_16x16x32_bf16 v[156:159], a[124:127], v[116:119], v[156:159]
buffer_load_dwordx4 v[24:27], v229, s[4:7], s33 offen sc1
v_mfma_f32_16x16x32_bf16 v[152:155], a[120:123], v[116:119], v[152:155]
v_mfma_f32_16x16x32_bf16 v[140:143], a[116:119], v[116:119], v[140:143]
s_add_u32 s33, s46, 105472
v_mfma_f32_16x16x32_bf16 v[136:139], a[112:115], v[116:119], v[136:139]
s_waitcnt vmcnt(8)
v_mfma_f32_16x16x32_bf16 v[128:131], a[64:67], v[120:123], v[128:131]
buffer_load_dwordx4 v[28:31], v230, s[4:7], s33 offen sc1
v_mfma_f32_16x16x32_bf16 v[132:135], a[68:71], v[120:123], v[132:135]
v_mfma_f32_16x16x32_bf16 v[144:147], a[72:75], v[120:123], v[144:147]
s_add_u32 s33, s46, 98304
v_mfma_f32_16x16x32_bf16 v[148:151], a[76:79], v[120:123], v[148:151]
s_waitcnt vmcnt(8)
v_mfma_f32_16x16x32_bf16 v[156:159], a[76:79], v[124:127], v[156:159]
buffer_load_dwordx4 v[32:35], v229, s[4:7], s33 offen sc1
v_mfma_f32_16x16x32_bf16 v[152:155], a[72:75], v[124:127], v[152:155]
s_add_u32 s33, s46, 98304
v_mfma_f32_16x16x32_bf16 v[140:143], a[68:71], v[124:127], v[140:143]
buffer_load_dwordx4 v[36:39], v230, s[4:7], s33 offen sc1
v_mfma_f32_16x16x32_bf16 v[136:139], a[64:67], v[124:127], v[136:139]
s_waitcnt vmcnt(9)
v_mfma_f32_16x16x32_bf16 v[128:131], a[80:83], v[0:3], v[128:131]
s_add_u32 s33, s46, 104448
v_mfma_f32_16x16x32_bf16 v[132:135], a[84:87], v[0:3], v[132:135]
v_mfma_f32_16x16x32_bf16 v[144:147], a[88:91], v[0:3], v[144:147]
buffer_load_dwordx4 v[40:43], v229, s[4:7], s33 offen sc1
v_mfma_f32_16x16x32_bf16 v[148:151], a[92:95], v[0:3], v[148:151]
s_waitcnt vmcnt(9)
v_mfma_f32_16x16x32_bf16 v[156:159], a[92:95], v[4:7], v[156:159]
s_add_u32 s33, s46, 104448
v_mfma_f32_16x16x32_bf16 v[152:155], a[88:91], v[4:7], v[152:155]
v_mfma_f32_16x16x32_bf16 v[140:143], a[84:87], v[4:7], v[140:143]
buffer_load_dwordx4 v[44:47], v230, s[4:7], s33 offen sc1
v_mfma_f32_16x16x32_bf16 v[136:139], a[80:83], v[4:7], v[136:139]
s_waitcnt vmcnt(9)
v_mfma_f32_16x16x32_bf16 v[160:163], a[224:227], v[8:11], v[160:163]
v_mfma_f32_16x16x32_bf16 v[164:167], a[228:231], v[8:11], v[164:167]
s_add_u32 s53, s25, 4
v_mfma_f32_16x16x32_bf16 v[176:179], a[232:235], v[8:11], v[176:179]
v_mfma_f32_16x16x32_bf16 v[180:183], a[236:239], v[8:11], v[180:183]
s_nop 1
ds_write_b128 v247, v[136:139] offset:0
v_mov_b32 v228, s53
s_waitcnt vmcnt(8)
v_mfma_f32_16x16x32_bf16 v[188:191], a[236:239], v[12:15], v[188:191]
v_mfma_f32_16x16x32_bf16 v[184:187], a[232:235], v[12:15], v[184:187]
ds_write_b128 v247, v[140:143] offset:1024
v_mfma_f32_16x16x32_bf16 v[172:175], a[228:231], v[12:15], v[172:175]
v_mfma_f32_16x16x32_bf16 v[168:171], a[224:227], v[12:15], v[168:171]
ds_write_b128 v248, v[144:147] offset:8192
s_waitcnt vmcnt(7)
v_mfma_f32_16x16x32_bf16 v[160:163], a[96:99], v[16:19], v[160:163]
v_mfma_f32_16x16x32_bf16 v[164:167], a[100:103], v[16:19], v[164:167]
ds_write_b128 v248, v[148:151] offset:9216
v_mfma_f32_16x16x32_bf16 v[176:179], a[104:107], v[16:19], v[176:179]
v_mfma_f32_16x16x32_bf16 v[180:183], a[108:111], v[16:19], v[180:183]
ds_write_b128 v249, v[152:155] offset:16384
s_waitcnt vmcnt(6)
v_mfma_f32_16x16x32_bf16 v[184:187], a[104:107], v[20:23], v[184:187]
v_mfma_f32_16x16x32_bf16 v[188:191], a[108:111], v[20:23], v[188:191]
ds_write_b128 v249, v[156:159] offset:17408
s_waitcnt vmcnt(5)
v_mfma_f32_16x16x32_bf16 v[176:179], a[120:123], v[24:27], v[176:179]
v_mfma_f32_16x16x32_bf16 v[180:183], a[124:127], v[24:27], v[180:183]
s_waitcnt vmcnt(4)
v_mfma_f32_16x16x32_bf16 v[184:187], a[120:123], v[28:31], v[184:187]
v_mfma_f32_16x16x32_bf16 v[188:191], a[124:127], v[28:31], v[188:191]
s_waitcnt lgkmcnt(0)
s_barrier
ds_read_b128 v[192:195], v242 offset:0
ds_read_b128 v[196:199], v242 offset:1024
s_waitcnt vmcnt(3)
v_mfma_f32_16x16x32_bf16 v[176:179], a[72:75], v[32:35], v[176:179]
v_mfma_f32_16x16x32_bf16 v[180:183], a[76:79], v[32:35], v[180:183]
ds_read_b128 v[200:203], v242 offset:8192
ds_read_b128 v[204:207], v242 offset:9216
s_waitcnt vmcnt(2)
v_mfma_f32_16x16x32_bf16 v[184:187], a[72:75], v[36:39], v[184:187]
v_mfma_f32_16x16x32_bf16 v[188:191], a[76:79], v[36:39], v[188:191]
ds_read_b128 v[208:211], v242 offset:16384
ds_read_b128 v[212:215], v242 offset:17408
s_waitcnt vmcnt(1)
v_mfma_f32_16x16x32_bf16 v[176:179], a[88:91], v[40:43], v[176:179]
v_mfma_f32_16x16x32_bf16 v[180:183], a[92:95], v[40:43], v[180:183]
s_waitcnt vmcnt(0)
v_mfma_f32_16x16x32_bf16 v[184:187], a[88:91], v[44:47], v[184:187]
v_mfma_f32_16x16x32_bf16 v[188:191], a[92:95], v[44:47], v[188:191]
s_and_b32 s30, s21, 1
s_or_b32 s30, s30, s20
s_xor_b32 s31, s22, 11
s_or_b32 s30, s30, s31
s_cbranch_scc1 WB_120
buffer_wbl2 sc1
WB_120:
v_mfma_f32_16x16x32_bf16 v[168:171], a[96:99], v[20:23], v[168:171]
v_mfma_f32_16x16x32_bf16 v[172:175], a[100:103], v[20:23], v[172:175]
v_mfma_f32_16x16x32_bf16 v[160:163], a[112:115], v[24:27], v[160:163]
v_mfma_f32_16x16x32_bf16 v[164:167], a[116:119], v[24:27], v[164:167]
s_waitcnt lgkmcnt(0)
s_barrier
v_mfma_f32_16x16x32_bf16 v[168:171], a[112:115], v[28:31], v[168:171]
v_mfma_f32_16x16x32_bf16 v[172:175], a[116:119], v[28:31], v[172:175]
ds_write_b128 v248, v[176:179] offset:8192
v_mfma_f32_16x16x32_bf16 v[160:163], a[64:67], v[32:35], v[160:163]
v_mfma_f32_16x16x32_bf16 v[164:167], a[68:71], v[32:35], v[164:167]
ds_write_b128 v248, v[180:183] offset:9216
v_mfma_f32_16x16x32_bf16 v[168:171], a[64:67], v[36:39], v[168:171]
v_mfma_f32_16x16x32_bf16 v[172:175], a[68:71], v[36:39], v[172:175]
v_mfma_f32_16x16x32_bf16 v[160:163], a[80:83], v[40:43], v[160:163]
v_mfma_f32_16x16x32_bf16 v[164:167], a[84:87], v[40:43], v[164:167]
ds_write_b128 v249, v[184:187] offset:16384
v_mfma_f32_16x16x32_bf16 v[168:171], a[80:83], v[44:47], v[168:171]
v_mfma_f32_16x16x32_bf16 v[172:175], a[84:87], v[44:47], v[172:175]
ds_write_b128 v249, v[188:191] offset:17408
v_add_f32 v128, v128, v192
v_add_f32 v129, v129, v193
v_add_f32 v130, v130, v194
v_add_f32 v131, v131, v195
v_add_f32 v132, v132, v196
v_add_f32 v133, v133, v197
v_add_f32 v134, v134, v198
v_add_f32 v135, v135, v199
ds_write_b128 v247, v[168:171] offset:0
v_pk_add_f32 v[128:129], v[128:129], v[200:201]
v_pk_add_f32 v[130:131], v[130:131], v[202:203]
v_pk_add_f32 v[132:133], v[132:133], v[204:205]
v_pk_add_f32 v[134:135], v[134:135], v[206:207]
v_pk_add_f32 v[128:129], v[128:129], v[208:209]
v_pk_add_f32 v[130:131], v[130:131], v[210:211]
v_pk_add_f32 v[132:133], v[132:133], v[212:213]
v_pk_add_f32 v[134:135], v[134:135], v[214:215]
v_pk_fma_f32 v[128:129], v[128:129], v[254:255], v[216:217] op_sel_hi:[1,0,1]
v_pk_fma_f32 v[130:131], v[130:131], v[254:255], v[218:219] op_sel_hi:[1,0,1]
v_pk_fma_f32 v[132:133], v[132:133], v[254:255], v[220:221] op_sel_hi:[1,0,1]
v_pk_fma_f32 v[134:135], v[134:135], v[254:255], v[222:223] op_sel_hi:[1,0,1]
v_cvt_pk_bf16_f32 v136, v128, v129
v_cvt_pk_bf16_f32 v137, v130, v131
ds_write_b128 v247, v[172:175] offset:1024
v_cvt_pk_bf16_f32 v138, v132, v133
v_cvt_pk_bf16_f32 v139, v134, v135
s_add_u32 s31, s39, 0
buffer_store_dwordx4 v[136:139], v244, s[16:19], s31 offen
v_accvgpr_read_b32 v217, a252
v_accvgpr_read_b32 v219, a253
v_accvgpr_read_b32 v221, a254
v_accvgpr_read_b32 v223, a255
v_lshlrev_b32 v216, 16, v217
v_and_b32 v217, 0xffff0000, v217
v_lshlrev_b32 v218, 16, v219
v_and_b32 v219, 0xffff0000, v219
v_lshlrev_b32 v220, 16, v221
v_and_b32 v221, 0xffff0000, v221
v_lshlrev_b32 v222, 16, v223
v_and_b32 v223, 0xffff0000, v223
s_waitcnt lgkmcnt(0)
s_barrier
ds_read_b128 v[192:195], v242 offset:0
ds_read_b128 v[196:199], v242 offset:1024
ds_read_b128 v[200:203], v242 offset:8192
ds_read_b128 v[204:207], v242 offset:9216
ds_read_b128 v[208:211], v242 offset:16384
ds_read_b128 v[212:215], v242 offset:17408
s_waitcnt lgkmcnt(4)
v_pk_add_f32 v[160:161], v[160:161], v[192:193]
v_pk_add_f32 v[162:163], v[162:163], v[194:195]
v_pk_add_f32 v[164:165], v[164:165], v[196:197]
v_pk_add_f32 v[166:167], v[166:167], v[198:199]
s_waitcnt lgkmcnt(2)
v_pk_add_f32 v[160:161], v[160:161], v[200:201]
v_pk_add_f32 v[162:163], v[162:163], v[202:203]
v_pk_add_f32 v[164:165], v[164:165], v[204:205]
v_pk_add_f32 v[166:167], v[166:167], v[206:207]
s_waitcnt lgkmcnt(0)
v_pk_add_f32 v[160:161], v[160:161], v[208:209]
v_pk_add_f32 v[162:163], v[162:163], v[210:211]
v_pk_add_f32 v[164:165], v[164:165], v[212:213]
v_pk_add_f32 v[166:167], v[166:167], v[214:215]
v_pk_fma_f32 v[160:161], v[160:161], v[254:255], v[216:217] op_sel:[0,1,0] op_sel_hi:[1,1,1]
v_pk_fma_f32 v[162:163], v[162:163], v[254:255], v[218:219] op_sel:[0,1,0] op_sel_hi:[1,1,1]
v_pk_fma_f32 v[164:165], v[164:165], v[254:255], v[220:221] op_sel:[0,1,0] op_sel_hi:[1,1,1]
v_pk_fma_f32 v[166:167], v[166:167], v[254:255], v[222:223] op_sel:[0,1,0] op_sel_hi:[1,1,1]
v_cvt_pk_bf16_f32 v168, v160, v161
v_cvt_pk_bf16_f32 v169, v162, v163
v_cvt_pk_bf16_f32 v170, v164, v165
v_cvt_pk_bf16_f32 v171, v166, v167
s_add_u32 s31, s39, 32768
buffer_store_dwordx4 v[168:171], v244, s[16:19], s31 offen
s_or_b32 s30, s21, s22
s_or_b32 s30, s30, s20
s_cselect_b32 s30, 1073741824, 0
v_mov_b32 v228, s25
s_mov_b64 exec, 1
buffer_store_dword v228, off, s[4:7], s30 sc1
L_END:
s_endpgm
L_F0R:
L_F0:
buffer_load_dword v183, v229, s[4:7], s32 offen sc1
s_waitcnt vmcnt(0)
v_and_b32 v184, -16, v183
v_cmp_ne_u32 vcc, s53, v184
s_cbranch_vccz L_F0X
s_sub_i32 s59, s59, 1
s_cmp_lt_i32 s59, 0
s_cbranch_scc0 L_F0
s_branch L_F0X
L_GW0:
s_setpc_b64 s[10:11]
GR_1:
s_sub_i32 s59, s59, 1
s_cmp_lt_i32 s59, 0
s_cbranch_scc1 GK_3
buffer_load_dwordx4 v[32:35], v255, s[4:7], s48 offen sc1
v_max_u32 v40, v0, v2
v_cmp_eq_u32 vcc, -1, v40
s_cbranch_vccz GS_4
s_add_u32 s33, s32, 1024
s_and_b32 s33, s33, 0x1c00
s_add_u32 s33, s33, s47
buffer_load_dwordx4 v[0:3], v224, s[4:7], s33 offen sc1
GS_4:
v_max_u32 v40, v4, v6
v_cmp_eq_u32 vcc, -1, v40
s_cbranch_vccz GS_5
s_add_u32 s33, s32, 2048
s_and_b32 s33, s33, 0x1c00
s_add_u32 s33, s33, s47
buffer_load_dwordx4 v[4:7], v224, s[4:7], s33 offen sc1
GS_5:
v_max_u32 v40, v8, v10
v_cmp_eq_u32 vcc, -1, v40
s_cbranch_vccz GS_6
s_add_u32 s33, s32, 3072
s_and_b32 s33, s33, 0x1c00
s_add_u32 s33, s33, s47
buffer_load_dwordx4 v[8:11], v224, s[4:7], s33 offen sc1
GS_6:
v_max_u32 v40, v12, v14
v_cmp_eq_u32 vcc, -1, v40
s_cbranch_vccz GS_7
s_add_u32 s33, s32, 4096
s_and_b32 s33, s33, 0x1c00
s_add_u32 s33, s33, s47
buffer_load_dwordx4 v[12:15], v224, s[4:7], s33 offen sc1
GS_7:
v_max_u32 v40, v16, v18
v_cmp_eq_u32 vcc, -1, v40
s_cbranch_vccz GS_8
s_add_u32 s33, s32, 5120
s_and_b32 s33, s33, 0x1c00
s_add_u32 s33, s33, s47
buffer_load_dwordx4 v[16:19], v224, s[4:7], s33 offen sc1
GS_8:
v_max_u32 v40, v20, v22
v_cmp_eq_u32 vcc, -1, v40
s_cbranch_vccz GS_9
s_add_u32 s33, s32, 6144
s_and_b32 s33, s33, 0x1c00
s_add_u32 s33, s33, s47
buffer_load_dwordx4 v[20:23], v224, s[4:7], s33 offen sc1
GS_9:
v_max_u32 v40, v24, v26
v_cmp_eq_u32 vcc, -1, v40
s_cbranch_vccz GS_10
s_add_u32 s33, s32, 7168
s_and_b32 s33, s33, 0x1c00
s_add_u32 s33, s33, s47
buffer_load_dwordx4 v[24:27], v224, s[4:7], s33 offen sc1
GS_10:
v_max_u32 v40, v28, v30
v_cmp_eq_u32 vcc, -1, v40
s_cbranch_vccz GS_11
s_add_u32 s33, s32, 8192
s_and_b32 s33, s33, 0x1c00
s_add_u32 s33, s33, s47
buffer_load_dwordx4 v[28:31], v224, s[4:7], s33 offen sc1
GS_11:
s_waitcnt vmcnt(0)
s_branch GJ_2
CR_26:
v_cmp_ne_u32 s[66:67], s53, v227
s_nop 0
s_and_b32 s66, s66, 65280
s_cbranch_scc0 CQ_28
CL_27:
buffer_load_dword v227, v226, s[4:7], s51 offen sc1
s_sub_i32 s59, s59, 1
s_cmp_lt_i32 s59, 0
s_cbranch_scc1 CQ_28
s_waitcnt vmcnt(0)
v_cmp_ne_u32 s[66:67], s53, v227
s_nop 0
s_and_b32 s66, s66, 65280
s_cbranch_scc1 CL_27
CQ_28:
s_cmp_lg_u32 s26, 0
s_cbranch_scc1 CJ_29
s_waitcnt vmcnt(0)
buffer_inv sc1
s_waitcnt vmcnt(0)
s_branch CJ_29
CR_30:
v_cmp_ne_u32 s[66:67], s53, v227
s_nop 0
s_and_b32 s66, s66, 16711680
s_cbranch_scc0 CQ_32
CL_31:
buffer_load_dword v227, v226, s[4:7], s51 offen sc1
s_sub_i32 s59, s59, 1
s_cmp_lt_i32 s59, 0
s_cbranch_scc1 CQ_32
s_waitcnt vmcnt(0)
v_cmp_ne_u32 s[66:67], s53, v227
s_nop 0
s_and_b32 s66, s66, 16711680
s_cbranch_scc1 CL_31
CQ_32:
s_cmp_lg_u32 s26, 0
s_cbranch_scc1 CJ_33
s_waitcnt vmcnt(0)
buffer_inv sc1
s_waitcnt vmcnt(0)
s_branch CJ_33
CR_34:
v_cmp_ne_u32 s[66:67], s53, v227
s_nop 0
s_and_b32 s66, s66, 4278190080
s_cbranch_scc0 CQ_36
CL_35:
buffer_load_dword v227, v226, s[4:7], s51 offen sc1
s_sub_i32 s59, s59, 1
s_cmp_lt_i32 s59, 0
s_cbranch_scc1 CQ_36
s_waitcnt vmcnt(0)
v_cmp_ne_u32 s[66:67], s53, v227
s_nop 0
s_and_b32 s66, s66, 4278190080
s_cbranch_scc1 CL_35
CQ_36:
s_cmp_lg_u32 s26, 0
s_cbranch_scc1 CJ_37
s_waitcnt vmcnt(0)
buffer_inv sc1
s_waitcnt vmcnt(0)
s_branch CJ_37
TR_38:
TL_39:
buffer_load_dwordx4 v[176:179], v245, s[4:7], s27 offen offset:0 sc1
buffer_load_dwordx4 v[180:183], v245, s[4:7], s27 offen offset:512 sc1
s_waitcnt vmcnt(0)
v_xor_b32 v184, 1, v177
v_xor_b32 v185, 1, v179
v_xor_b32 v186, 1, v181
v_xor_b32 v187, 1, v183
v_or3_b32 v184, v184, v185, v186
v_or_b32 v184, v184, v187
v_and_b32 v184, 3, v184
v_cmp_ne_u32 vcc, 0, v184
s_cbranch_vccz TJ_40
s_sub_i32 s59, s59, 1
s_cmp_lt_i32 s59, 0
s_cbranch_scc0 TL_39
s_branch TJ_40
TR_57:
TL_58:
buffer_load_dwordx4 v[176:179], v245, s[4:7], s27 offen offset:0 sc1
buffer_load_dwordx4 v[180:183], v245, s[4:7], s27 offen offset:512 sc1
s_waitcnt vmcnt(0)
v_xor_b32 v184, 2, v177
v_xor_b32 v185, 2, v179
v_xor_b32 v186, 2, v181
v_xor_b32 v187, 2, v183
v_or3_b32 v184, v184, v185, v186
v_or_b32 v184, v184, v187
v_and_b32 v184, 3, v184
v_cmp_ne_u32 vcc, 0, v184
s_cbranch_vccz TJ_59
s_sub_i32 s59, s59, 1
s_cmp_lt_i32 s59, 0
s_cbranch_scc0 TL_58
s_branch TJ_59
L_GW1:
s_setpc_b64 s[10:11]
GR_60:
s_sub_i32 s59, s59, 1
s_cmp_lt_i32 s59, 0
s_cbranch_scc1 GK_62
buffer_load_dwordx4 v[32:35], v255, s[4:7], s48 offen sc1
v_max_u32 v40, v0, v2
v_cmp_eq_u32 vcc, -1, v40
s_cbranch_vccz GS_63
s_add_u32 s33, s32, 1024
s_and_b32 s33, s33, 0x1c00
s_add_u32 s33, s33, s47
buffer_load_dwordx4 v[0:3], v224, s[4:7], s33 offen sc1
GS_63:
v_max_u32 v40, v4, v6
v_cmp_eq_u32 vcc, -1, v40
s_cbranch_vccz GS_64
s_add_u32 s33, s32, 2048
s_and_b32 s33, s33, 0x1c00
s_add_u32 s33, s33, s47
buffer_load_dwordx4 v[4:7], v224, s[4:7], s33 offen sc1
GS_64:
v_max_u32 v40, v8, v10
v_cmp_eq_u32 vcc, -1, v40
s_cbranch_vccz GS_65
s_add_u32 s33, s32, 3072
s_and_b32 s33, s33, 0x1c00
s_add_u32 s33, s33, s47
buffer_load_dwordx4 v[8:11], v224, s[4:7], s33 offen sc1
GS_65:
v_max_u32 v40, v12, v14
v_cmp_eq_u32 vcc, -1, v40
s_cbranch_vccz GS_66
s_add_u32 s33, s32, 4096
s_and_b32 s33, s33, 0x1c00
s_add_u32 s33, s33, s47
buffer_load_dwordx4 v[12:15], v224, s[4:7], s33 offen sc1
GS_66:
v_max_u32 v40, v16, v18
v_cmp_eq_u32 vcc, -1, v40
s_cbranch_vccz GS_67
s_add_u32 s33, s32, 5120
s_and_b32 s33, s33, 0x1c00
s_add_u32 s33, s33, s47
buffer_load_dwordx4 v[16:19], v224, s[4:7], s33 offen sc1
GS_67:
v_max_u32 v40, v20, v22
v_cmp_eq_u32 vcc, -1, v40
s_cbranch_vccz GS_68
s_add_u32 s33, s32, 6144
s_and_b32 s33, s33, 0x1c00
s_add_u32 s33, s33, s47
buffer_load_dwordx4 v[20:23], v224, s[4:7], s33 offen sc1
GS_68:
v_max_u32 v40, v24, v26
v_cmp_eq_u32 vcc, -1, v40
s_cbranch_vccz GS_69
s_add_u32 s33, s32, 7168
s_and_b32 s33, s33, 0x1c00
s_add_u32 s33, s33, s47
buffer_load_dwordx4 v[24:27], v224, s[4:7], s33 offen sc1
GS_69:
v_max_u32 v40, v28, v30
v_cmp_eq_u32 vcc, -1, v40
s_cbranch_vccz GS_70
s_add_u32 s33, s32, 8192
s_and_b32 s33, s33, 0x1c00
s_add_u32 s33, s33, s47
buffer_load_dwordx4 v[28:31], v224, s[4:7], s33 offen sc1
GS_70:
s_waitcnt vmcnt(0)
s_branch GJ_61
CR_89:
v_cmp_ne_u32 s[66:67], s53, v227
s_nop 0
s_and_b32 s66, s66, 65280
s_cbranch_scc0 CQ_91
CL_90:
buffer_load_dword v227, v226, s[4:7], s51 offen sc1
s_sub_i32 s59, s59, 1
s_cmp_lt_i32 s59, 0
s_cbranch_scc1 CQ_91
s_waitcnt vmcnt(0)
v_cmp_ne_u32 s[66:67], s53, v227
s_nop 0
s_and_b32 s66, s66, 65280
s_cbranch_scc1 CL_90
CQ_91:
s_cmp_lg_u32 s26, 0
s_cbranch_scc1 CJ_92
s_waitcnt vmcnt(0)
buffer_inv sc1
s_waitcnt vmcnt(0)
s_branch CJ_92
CR_93:
v_cmp_ne_u32 s[66:67], s53, v227
s_nop 0
s_and_b32 s66, s66, 16711680
s_cbranch_scc0 CQ_95
CL_94:
buffer_load_dword v227, v226, s[4:7], s51 offen sc1
s_sub_i32 s59, s59, 1
s_cmp_lt_i32 s59, 0
s_cbranch_scc1 CQ_95
s_waitcnt vmcnt(0)
v_cmp_ne_u32 s[66:67], s53, v227
s_nop 0
s_and_b32 s66, s66, 16711680
s_cbranch_scc1 CL_94
CQ_95:
s_cmp_lg_u32 s26, 0
s_cbranch_scc1 CJ_96
s_waitcnt vmcnt(0)
buffer_inv sc1
s_waitcnt vmcnt(0)
s_branch CJ_96
CR_97:
v_cmp_ne_u32 s[66:67], s53, v227
s_nop 0
s_and_b32 s66, s66, 4278190080
s_cbranch_scc0 CQ_99
CL_98:
buffer_load_dword v227, v226, s[4:7], s51 offen sc1
s_sub_i32 s59, s59, 1
s_cmp_lt_i32 s59, 0
s_cbranch_scc1 CQ_99
s_waitcnt vmcnt(0)
v_cmp_ne_u32 s[66:67], s53, v227
s_nop 0
s_and_b32 s66, s66, 4278190080
s_cbranch_scc1 CL_98
CQ_99:
s_cmp_lg_u32 s26, 0
s_cbranch_scc1 CJ_100
s_waitcnt vmcnt(0)
buffer_inv sc1
s_waitcnt vmcnt(0)
s_branch CJ_100
TR_111:
TL_112:
buffer_load_dwordx4 v[176:179], v245, s[4:7], s27 offen offset:0 sc1
buffer_load_dwordx4 v[180:183], v245, s[4:7], s27 offen offset:512 sc1
s_waitcnt vmcnt(0)
v_xor_b32 v184, 3, v177
v_xor_b32 v185, 3, v179
v_xor_b32 v186, 3, v181
v_xor_b32 v187, 3, v183
v_or3_b32 v184, v184, v185, v186
v_or_b32 v184, v184, v187
v_and_b32 v184, 3, v184
v_cmp_ne_u32 vcc, 0, v184
s_cbranch_vccz TJ_113
s_sub_i32 s59, s59, 1
s_cmp_lt_i32 s59, 0
s_cbranch_scc0 TL_112
s_branch TJ_113
L_WARM:
SS_12:
s_waitcnt vmcnt(0)
buffer_wbl2 sc1
s_waitcnt vmcnt(0)
buffer_store_dword v228, off, s[4:7], s49 offset:0 sc1
s_branch SJ_13
AS_16:
s_waitcnt vmcnt(0)
buffer_inv sc1
s_waitcnt vmcnt(0)
s_branch AJ_17
SS_18:
s_waitcnt vmcnt(0)
buffer_wbl2 sc1
s_waitcnt vmcnt(0)
buffer_store_dword v228, v239, s[4:7], s50 offen sc1
s_branch SJ_19
SS_20:
buffer_store_dwordx2 v[192:193], v237, s[4:7], s38 offen sc1
s_branch SJ_21
AS_24:
s_waitcnt vmcnt(0)
buffer_inv sc1
s_waitcnt vmcnt(0)
s_branch AJ_25
SS_41:
s_waitcnt vmcnt(0)
buffer_wbl2 sc1
s_waitcnt vmcnt(0)
buffer_store_dword v228, v241, s[4:7], s49 offen offset:32 sc1
s_branch SJ_42
SS_43:
s_waitcnt vmcnt(0)
buffer_wbl2 sc1
s_waitcnt vmcnt(0)
buffer_store_dword v228, v241, s[4:7], s49 offen offset:64 sc1
s_branch SJ_44
SS_45:
s_waitcnt vmcnt(0)
buffer_wbl2 sc1
s_waitcnt vmcnt(0)
buffer_store_dword v228, v241, s[4:7], s49 offen offset:96 sc1
s_branch SJ_46
SS_47:
s_waitcnt vmcnt(0)
buffer_wbl2 sc1
s_waitcnt vmcnt(0)
buffer_store_dword v228, v239, s[4:7], s50 offen sc1
s_branch SJ_48
SS_49:
buffer_store_dwordx2 v[192:193], v237, s[4:7], s38 offen sc1
s_branch SJ_50
AS_53:
s_waitcnt vmcnt(0)
buffer_inv sc1
s_waitcnt vmcnt(0)
s_branch AJ_54
VR_55:
s_sub_i32 s59, s59, 1
s_cmp_lt_i32 s59, 0
s_cbranch_scc1 VJ_56
s_waitcnt vmcnt(0) lgkmcnt(0)
s_waitcnt vmcnt(0)
s_branch L_P1R
SS_71:
s_waitcnt vmcnt(0)
buffer_wbl2 sc1
s_waitcnt vmcnt(0)
buffer_store_dword v228, off, s[4:7], s49 offset:0 sc1
s_branch SJ_72
AS_75:
s_waitcnt vmcnt(0)
buffer_inv sc1
s_waitcnt vmcnt(0)
s_branch AJ_76
VR_77:
s_sub_i32 s59, s59, 1
s_cmp_lt_i32 s59, 0
s_cbranch_scc1 VJ_78
s_add_u32 s30, s46, 0
buffer_load_dwordx4 v[0:3], v230, s[4:7], s30 offen sc1
s_add_u32 s30, s46, 6144
buffer_load_dwordx4 v[4:7], v230, s[4:7], s30 offen sc1
s_add_u32 s30, s46, 12288
buffer_load_dwordx4 v[8:11], v230, s[4:7], s30 offen sc1
s_add_u32 s30, s46, 18432
buffer_load_dwordx4 v[12:15], v230, s[4:7], s30 offen sc1
s_add_u32 s30, s46, 0
buffer_load_dwordx4 v[16:19], v229, s[4:7], s30 offen sc1
s_add_u32 s30, s46, 6144
buffer_load_dwordx4 v[20:23], v229, s[4:7], s30 offen sc1
s_add_u32 s30, s46, 12288
buffer_load_dwordx4 v[24:27], v229, s[4:7], s30 offen sc1
s_add_u32 s30, s46, 18432
buffer_load_dwordx4 v[28:31], v229, s[4:7], s30 offen sc1
s_waitcnt vmcnt(0)
v_mfma_f32_16x16x32_bf16 v[136:139], a[0:3], v[0:3], 0
v_mfma_f32_16x16x32_bf16 v[140:143], a[4:7], v[0:3], 0
v_mfma_f32_16x16x32_bf16 v[152:155], a[8:11], v[0:3], 0
v_mfma_f32_16x16x32_bf16 v[156:159], a[12:15], v[0:3], 0
v_mfma_f32_16x16x32_bf16 v[136:139], a[16:19], v[4:7], v[136:139]
v_mfma_f32_16x16x32_bf16 v[140:143], a[20:23], v[4:7], v[140:143]
v_mfma_f32_16x16x32_bf16 v[152:155], a[24:27], v[4:7], v[152:155]
v_mfma_f32_16x16x32_bf16 v[156:159], a[28:31], v[4:7], v[156:159]
v_mfma_f32_16x16x32_bf16 v[136:139], a[32:35], v[8:11], v[136:139]
v_mfma_f32_16x16x32_bf16 v[140:143], a[36:39], v[8:11], v[140:143]
v_mfma_f32_16x16x32_bf16 v[152:155], a[40:43], v[8:11], v[152:155]
v_mfma_f32_16x16x32_bf16 v[156:159], a[44:47], v[8:11], v[156:159]
v_mfma_f32_16x16x32_bf16 v[136:139], a[48:51], v[12:15], v[136:139]
v_mfma_f32_16x16x32_bf16 v[140:143], a[52:55], v[12:15], v[140:143]
v_mfma_f32_16x16x32_bf16 v[152:155], a[56:59], v[12:15], v[152:155]
v_mfma_f32_16x16x32_bf16 v[156:159], a[60:63], v[12:15], v[156:159]
v_mfma_f32_16x16x32_bf16 v[128:131], a[0:3], v[16:19], 0
v_mfma_f32_16x16x32_bf16 v[132:135], a[4:7], v[16:19], 0
v_mfma_f32_16x16x32_bf16 v[144:147], a[8:11], v[16:19], 0
v_mfma_f32_16x16x32_bf16 v[148:151], a[12:15], v[16:19], 0
v_mfma_f32_16x16x32_bf16 v[128:131], a[16:19], v[20:23], v[128:131]
v_mfma_f32_16x16x32_bf16 v[132:135], a[20:23], v[20:23], v[132:135]
v_mfma_f32_16x16x32_bf16 v[144:147], a[24:27], v[20:23], v[144:147]
v_mfma_f32_16x16x32_bf16 v[148:151], a[28:31], v[20:23], v[148:151]
v_mfma_f32_16x16x32_bf16 v[128:131], a[32:35], v[24:27], v[128:131]
v_mfma_f32_16x16x32_bf16 v[132:135], a[36:39], v[24:27], v[132:135]
v_mfma_f32_16x16x32_bf16 v[144:147], a[40:43], v[24:27], v[144:147]
v_mfma_f32_16x16x32_bf16 v[148:151], a[44:47], v[24:27], v[148:151]
v_mfma_f32_16x16x32_bf16 v[128:131], a[48:51], v[28:31], v[128:131]
v_mfma_f32_16x16x32_bf16 v[132:135], a[52:55], v[28:31], v[132:135]
v_mfma_f32_16x16x32_bf16 v[144:147], a[56:59], v[28:31], v[144:147]
v_mfma_f32_16x16x32_bf16 v[148:151], a[60:63], v[28:31], v[148:151]
ds_write_b128 v247, v[136:139] offset:0
ds_write_b128 v247, v[140:143] offset:1024
ds_write_b128 v249, v[152:155] offset:16384
ds_write_b128 v249, v[156:159] offset:17408
s_waitcnt lgkmcnt(0)
v_and_b32 v231, v0, v4
v_bitop3_b32 v231, v231, v8, v12 bitop3:0x80
v_bitop3_b32 v231, v231, v16, v20 bitop3:0x80
v_bitop3_b32 v231, v231, v24, v28 bitop3:0x80
v_and_b32 v231, 1, v231
v_cmp_ne_u32 s[66:67], 1, v231
s_nop 0
s_cmp_lg_u64 s[66:67], 0
s_cbranch_scc1 VR_77
s_branch VJ_78
VR_79:
s_sub_i32 s59, s59, 1
s_cmp_lt_i32 s59, 0
s_cbranch_scc1 VJ_80
s_add_u32 s30, s46, 98304
buffer_load_dwordx4 v[32:35], v230, s[4:7], s30 offen sc1
s_add_u32 s30, s46, 104448
buffer_load_dwordx4 v[36:39], v230, s[4:7], s30 offen sc1
s_add_u32 s30, s46, 110592
buffer_load_dwordx4 v[40:43], v230, s[4:7], s30 offen sc1
s_add_u32 s30, s46, 116736
buffer_load_dwordx4 v[44:47], v230, s[4:7], s30 offen sc1
s_add_u32 s30, s46, 98304
buffer_load_dwordx4 v[48:51], v229, s[4:7], s30 offen sc1
s_add_u32 s30, s46, 104448
buffer_load_dwordx4 v[52:55], v229, s[4:7], s30 offen sc1
s_add_u32 s30, s46, 110592
buffer_load_dwordx4 v[56:59], v229, s[4:7], s30 offen sc1
s_add_u32 s30, s46, 116736
buffer_load_dwordx4 v[60:63], v229, s[4:7], s30 offen sc1
s_waitcnt vmcnt(0)
v_mfma_f32_16x16x32_bf16 v[168:171], a[0:3], v[32:35], 0
v_mfma_f32_16x16x32_bf16 v[172:175], a[4:7], v[32:35], 0
v_mfma_f32_16x16x32_bf16 v[184:187], a[8:11], v[32:35], 0
v_mfma_f32_16x16x32_bf16 v[188:191], a[12:15], v[32:35], 0
v_mfma_f32_16x16x32_bf16 v[168:171], a[16:19], v[36:39], v[168:171]
v_mfma_f32_16x16x32_bf16 v[172:175], a[20:23], v[36:39], v[172:175]
v_mfma_f32_16x16x32_bf16 v[184:187], a[24:27], v[36:39], v[184:187]
v_mfma_f32_16x16x32_bf16 v[188:191], a[28:31], v[36:39], v[188:191]
v_mfma_f32_16x16x32_bf16 v[168:171], a[32:35], v[40:43], v[168:171]
v_mfma_f32_16x16x32_bf16 v[172:175], a[36:39], v[40:43], v[172:175]
v_mfma_f32_16x16x32_bf16 v[184:187], a[40:43], v[40:43], v[184:187]
v_mfma_f32_16x16x32_bf16 v[188:191], a[44:47], v[40:43], v[188:191]
v_mfma_f32_16x16x32_bf16 v[168:171], a[48:51], v[44:47], v[168:171]
v_mfma_f32_16x16x32_bf16 v[172:175], a[52:55], v[44:47], v[172:175]
v_mfma_f32_16x16x32_bf16 v[184:187], a[56:59], v[44:47], v[184:187]
v_mfma_f32_16x16x32_bf16 v[188:191], a[60:63], v[44:47], v[188:191]
v_mfma_f32_16x16x32_bf16 v[160:163], a[0:3], v[48:51], 0
v_mfma_f32_16x16x32_bf16 v[164:167], a[4:7], v[48:51], 0
v_mfma_f32_16x16x32_bf16 v[176:179], a[8:11], v[48:51], 0
v_mfma_f32_16x16x32_bf16 v[180:183], a[12:15], v[48:51], 0
v_mfma_f32_16x16x32_bf16 v[160:163], a[16:19], v[52:55], v[160:163]
v_mfma_f32_16x16x32_bf16 v[164:167], a[20:23], v[52:55], v[164:167]
v_mfma_f32_16x16x32_bf16 v[176:179], a[24:27], v[52:55], v[176:179]
v_mfma_f32_16x16x32_bf16 v[180:183], a[28:31], v[52:55], v[180:183]
v_mfma_f32_16x16x32_bf16 v[160:163], a[32:35], v[56:59], v[160:163]
v_mfma_f32_16x16x32_bf16 v[164:167], a[36:39], v[56:59], v[164:167]
v_mfma_f32_16x16x32_bf16 v[176:179], a[40:43], v[56:59], v[176:179]
v_mfma_f32_16x16x32_bf16 v[180:183], a[44:47], v[56:59], v[180:183]
v_mfma_f32_16x16x32_bf16 v[160:163], a[48:51], v[60:63], v[160:163]
v_mfma_f32_16x16x32_bf16 v[164:167], a[52:55], v[60:63], v[164:167]
v_mfma_f32_16x16x32_bf16 v[176:179], a[56:59], v[60:63], v[176:179]
v_mfma_f32_16x16x32_bf16 v[180:183], a[60:63], v[60:63], v[180:183]
ds_write_b128 v247, v[168:171] offset:0
ds_write_b128 v247, v[172:175] offset:1024
ds_write_b128 v249, v[184:187] offset:16384
ds_write_b128 v249, v[188:191] offset:17408
s_waitcnt lgkmcnt(0)
v_and_b32 v231, v32, v36
v_bitop3_b32 v231, v231, v40, v44 bitop3:0x80
v_bitop3_b32 v231, v231, v48, v52 bitop3:0x80
v_bitop3_b32 v231, v231, v56, v60 bitop3:0x80
v_and_b32 v231, 1, v231
v_cmp_ne_u32 s[66:67], 1, v231
s_nop 0
s_cmp_lg_u64 s[66:67], 0
s_cbranch_scc1 VR_79
s_branch VJ_80
SS_81:
s_waitcnt vmcnt(0)
buffer_wbl2 sc1
s_waitcnt vmcnt(0)
buffer_store_dword v228, v239, s[4:7], s50 offen sc1
s_branch SJ_82
SS_83:
buffer_store_dwordx2 v[192:193], v237, s[4:7], s38 offen sc1
s_branch SJ_84
AS_87:
s_waitcnt vmcnt(0)
buffer_inv sc1
s_waitcnt vmcnt(0)
s_branch AJ_88
VR_101:
s_sub_i32 s59, s59, 1
s_cmp_lt_i32 s59, 0
s_cbranch_scc1 VJ_102
s_waitcnt vmcnt(0) lgkmcnt(0)
s_add_u32 s30, s44, 0
buffer_load_dwordx4 v[0:3], v224, s[4:7], s30 offen sc1
s_add_u32 s30, s44, 1024
buffer_load_dwordx4 v[4:7], v224, s[4:7], s30 offen sc1
s_add_u32 s30, s44, 2048
buffer_load_dwordx4 v[8:11], v224, s[4:7], s30 offen sc1
s_add_u32 s30, s44, 3072
buffer_load_dwordx4 v[12:15], v224, s[4:7], s30 offen sc1
s_add_u32 s30, s44, 4096
buffer_load_dwordx4 v[16:19], v224, s[4:7], s30 offen sc1
s_add_u32 s30, s44, 5120
buffer_load_dwordx4 v[20:23], v224, s[4:7], s30 offen sc1
s_add_u32 s30, s44, 6144
buffer_load_dwordx4 v[24:27], v224, s[4:7], s30 offen sc1
s_add_u32 s30, s44, 7168
buffer_load_dwordx4 v[28:31], v224, s[4:7], s30 offen sc1
s_add_u32 s30, s44, 8192
buffer_load_dwordx4 v[32:35], v224, s[4:7], s30 offen sc1
s_add_u32 s30, s44, 9216
buffer_load_dwordx4 v[36:39], v224, s[4:7], s30 offen sc1
s_waitcnt vmcnt(0)
s_add_u32 s33, s44, 8192
s_branch L_P3R1
VR_103:
s_sub_i32 s59, s59, 1
s_cmp_lt_i32 s59, 0
s_cbranch_scc1 VJ_104
s_add_u32 s30, s44, 8192
buffer_load_dwordx4 v[32:35], v224, s[4:7], s30 offen sc1
s_add_u32 s30, s44, 9216
buffer_load_dwordx4 v[36:39], v224, s[4:7], s30 offen sc1
s_add_u32 s30, s44, 10240
buffer_load_dwordx4 v[40:43], v224, s[4:7], s30 offen sc1
s_add_u32 s30, s44, 11264
buffer_load_dwordx4 v[44:47], v224, s[4:7], s30 offen sc1
s_waitcnt vmcnt(0)
v_and_b32 v231, v32, v36
v_bitop3_b32 v231, v231, v40, v44 bitop3:0x80
v_and_b32 v231, 1, v231
v_cmp_ne_u32 s[66:67], 1, v231
s_nop 0
s_cmp_lg_u64 s[66:67], 0
s_cbranch_scc1 VR_103
s_branch VJ_104
VR_105:
s_sub_i32 s59, s59, 1
s_cmp_lt_i32 s59, 0
s_cbranch_scc1 VJ_106
s_add_u32 s30, s44, 12288
buffer_load_dwordx4 v[48:51], v224, s[4:7], s30 offen sc1
s_add_u32 s30, s44, 13312
buffer_load_dwordx4 v[52:55], v224, s[4:7], s30 offen sc1
s_add_u32 s30, s44, 14336
buffer_load_dwordx4 v[56:59], v224, s[4:7], s30 offen sc1
s_add_u32 s30, s44, 15360
buffer_load_dwordx4 v[60:63], v224, s[4:7], s30 offen sc1
s_add_u32 s30, s44, 16384
buffer_load_dwordx4 v[64:67], v224, s[4:7], s30 offen sc1
s_add_u32 s30, s44, 17408
buffer_load_dwordx4 v[68:71], v224, s[4:7], s30 offen sc1
s_waitcnt vmcnt(0)
v_and_b32 v231, v48, v52
v_bitop3_b32 v231, v231, v56, v60 bitop3:0x80
v_bitop3_b32 v231, v231, v64, v68 bitop3:0x80
v_and_b32 v231, 1, v231
v_cmp_ne_u32 s[66:67], 1, v231
s_nop 0
s_cmp_lg_u64 s[66:67], 0
s_cbranch_scc1 VR_105
s_branch VJ_106
VR_107:
s_sub_i32 s59, s59, 1
s_cmp_lt_i32 s59, 0
s_cbranch_scc1 VJ_108
s_add_u32 s30, s44, 18432
buffer_load_dwordx4 v[72:75], v224, s[4:7], s30 offen sc1
s_add_u32 s30, s44, 19456
buffer_load_dwordx4 v[76:79], v224, s[4:7], s30 offen sc1
s_add_u32 s30, s44, 20480
buffer_load_dwordx4 v[80:83], v224, s[4:7], s30 offen sc1
s_add_u32 s30, s44, 21504
buffer_load_dwordx4 v[84:87], v224, s[4:7], s30 offen sc1
s_add_u32 s30, s44, 22528
buffer_load_dwordx4 v[88:91], v224, s[4:7], s30 offen sc1
s_add_u32 s30, s44, 23552
buffer_load_dwordx4 v[92:95], v224, s[4:7], s30 offen sc1
s_add_u32 s30, s44, 24576
buffer_load_dwordx4 v[96:99], v224, s[4:7], s30 offen sc1
s_add_u32 s30, s44, 25600
buffer_load_dwordx4 v[100:103], v224, s[4:7], s30 offen sc1
s_waitcnt vmcnt(0)
v_and_b32 v231, v72, v76
v_bitop3_b32 v231, v231, v80, v84 bitop3:0x80
v_bitop3_b32 v231, v231, v88, v92 bitop3:0x80
v_bitop3_b32 v231, v231, v96, v100 bitop3:0x80
v_and_b32 v231, 1, v231
v_cmp_ne_u32 s[66:67], 1, v231
s_nop 0
s_cmp_lg_u64 s[66:67], 0
s_cbranch_scc1 VR_107
s_branch VJ_108
VR_109:
s_sub_i32 s59, s59, 1
s_cmp_lt_i32 s59, 0
s_cbranch_scc1 VJ_110
s_add_u32 s30, s44, 26624
buffer_load_dwordx4 v[104:107], v224, s[4:7], s30 offen sc1
s_add_u32 s30, s44, 27648
buffer_load_dwordx4 v[108:111], v224, s[4:7], s30 offen sc1
s_add_u32 s30, s44, 28672
buffer_load_dwordx4 v[112:115], v224, s[4:7], s30 offen sc1
s_add_u32 s30, s44, 29696
buffer_load_dwordx4 v[116:119], v224, s[4:7], s30 offen sc1
s_add_u32 s30, s44, 30720
buffer_load_dwordx4 v[120:123], v224, s[4:7], s30 offen sc1
s_add_u32 s30, s44, 31744
buffer_load_dwordx4 v[124:127], v224, s[4:7], s30 offen sc1
s_waitcnt vmcnt(0)
v_and_b32 v231, v104, v108
v_bitop3_b32 v231, v231, v112, v116 bitop3:0x80
v_bitop3_b32 v231, v231, v120, v124 bitop3:0x80
v_and_b32 v231, 1, v231
v_cmp_ne_u32 s[66:67], 1, v231
s_nop 0
s_cmp_lg_u64 s[66:67], 0
s_cbranch_scc1 VR_109
s_branch VJ_110
SS_114:
s_waitcnt vmcnt(0)
buffer_wbl2 sc1
s_waitcnt vmcnt(0)
buffer_store_dword v228, v241, s[4:7], s49 offen offset:32 sc1
s_branch SJ_115
SS_116:
s_waitcnt vmcnt(0)
buffer_wbl2 sc1
s_waitcnt vmcnt(0)
buffer_store_dword v228, v241, s[4:7], s49 offen offset:64 sc1
s_branch SJ_117
SS_118:
s_waitcnt vmcnt(0)
buffer_wbl2 sc1
s_waitcnt vmcnt(0)
buffer_store_dword v228, v241, s[4:7], s49 offen offset:96 sc1
s_branch SJ_119
.section .rodata,"a"
.p2align 6
.amdhsa_kernel interleave_layers__linear_kernel_hedgehog__glu_gated_reglu__prompt_kernel
  .amdhsa_next_free_vgpr 512
  .amdhsa_next_free_sgpr 102
  .amdhsa_accum_offset 256
  .amdhsa_group_segment_fixed_size 0
  .amdhsa_kernarg_size 88
  .amdhsa_user_sgpr_count 2
  .amdhsa_user_sgpr_kernarg_segment_ptr 1
  .amdhsa_system_sgpr_workgroup_id_x 1
.end_amdhsa_kernel
```
